```python
import torch

def _softmax(x, axis=-1):
    return torch.softmax(x, dim=axis)
def _gelu(x):
    return torch.nn.functional.gelu(x, approximate="tanh")
def _silu(x):
    return torch.nn.functional.silu(x)
def _sigmoid(x):
    return torch.sigmoid(x)
def _layernorm(x, axis=-1, eps=1e-5):
    m = x.mean(dim=axis, keepdim=True)
    v = x.var(dim=axis, keepdim=True, unbiased=False)
    return (x - m) / torch.sqrt(v + eps)
def _scatter_add(tgt, idx, src, axis=0):
    return tgt.clone().index_add_(axis, idx, src)
def _segment_sum(src, seg, n):
    out = torch.zeros((n,) + src.shape[1:], dtype=src.dtype)
    return out.index_add_(0, seg, src)
def _pad(x, pw):
    flat = tuple(v for pair in reversed(pw) for v in pair)
    return torch.nn.functional.pad(x, flat)

kernel_name = 'parallel_sum__linear_kernel_hedgehog__glu_gated_geglu__prompt'

def setup_inputs():

    _w = (lambda a: (lambda t: t.to(torch.bfloat16) if t.is_floating_point() else t)(torch.as_tensor(a)))
    def _A_setup():
        B, S, D, H = 1, 2048, 640, 32
        Dh = D // H
        return {
            "x": _w((lambda *s: torch.randn(*s, dtype=torch.bfloat16) * 0.05)(B, S, D)),
            "wqkv": _w((lambda *s: torch.randn(*s, dtype=torch.bfloat16) * 0.2)(D, 3 * D)),
            "w_phi": _w((lambda *s: torch.randn(*s, dtype=torch.bfloat16) * 0.2)(H, Dh, Dh) * (Dh ** -0.5)),
            "wo": _w((lambda *s: torch.randn(*s, dtype=torch.bfloat16) * 0.05)(D, D)),
        }
    _A_in = _A_setup()

    def _B_setup():
        B, S, Dm, Df = 1, 2048, 640, 1536
        return {
            "x": _w((lambda *s: torch.randn(*s, dtype=torch.bfloat16) * 0.05)(B, S, Dm)),
            "w_gate": _w((lambda *s: torch.randn(*s, dtype=torch.bfloat16) * 0.4)(Dm, Df) * (Dm ** -0.5)),
            "w_up": _w((lambda *s: torch.randn(*s, dtype=torch.bfloat16) * 0.4)(Dm, Df) * (Dm ** -0.5)),
            "w_down": _w((lambda *s: torch.randn(*s, dtype=torch.bfloat16) * 0.4)(Df, Dm) * (Df ** -0.5)),
        }
    _B_in = _B_setup()

    return {
        "A_x": _A_in["x"],
        "A_wqkv": _A_in["wqkv"],
        "A_w_phi": _A_in["w_phi"],
        "A_wo": _A_in["wo"],
        "B_x": _B_in["x"],
        "B_w_gate": _B_in["w_gate"],
        "B_w_up": _B_in["w_up"],
        "B_w_down": _B_in["w_down"],
    }

def reference(A_x, A_wqkv, A_w_phi, A_wo, B_x, B_w_gate, B_w_up, B_w_down):
    def _A_ref(x, wqkv, w_phi, wo):
        B, S, D = x.shape
        H = 32; Dh = D // H
        qkv = (lambda x, *d: x.permute(*d))((x @ wqkv).reshape(B, S, 3, H, Dh), 2, 0, 3, 1, 4)
        q, k, v = qkv[0], qkv[1], qkv[2]
        pq = torch.einsum("bhsd,hdf->bhsf", q, w_phi)
        pk = torch.einsum("bhsd,hdf->bhsf", k, w_phi)
        phi_q = torch.concatenate([_softmax(pq, axis=-1), _softmax(-pq, axis=-1)], axis=-1)
        phi_k = torch.concatenate([_softmax(pk, axis=-1), _softmax(-pk, axis=-1)], axis=-1)
        kv = torch.einsum("bhsf,bhsd->bhfd", phi_k, v)
        z  = torch.einsum("bhsf->bhf", phi_k)
        num = torch.einsum("bhqf,bhfd->bhqd", phi_q, kv)
        den = torch.einsum("bhqf,bhf->bhq", phi_q, z)[..., None] + 1e-6
        o = num / den
        return (lambda x, *d: x.permute(*d))(o, 0, 2, 1, 3).reshape(B, S, D) @ wo

    def _B_ref(x, w_gate, w_up, w_down):
        g = torch.einsum("bsd,df->bsf", x, w_gate)
        u = torch.einsum("bsd,df->bsf", x, w_up)
        h = _gelu(g) * u
        return torch.einsum("bsf,fd->bsd", h, w_down)

    x = A_x
    xn = _layernorm(x, axis=-1)
    return x + _A_ref(xn, A_wqkv, A_w_phi, A_wo) + _B_ref(xn, B_w_gate, B_w_up, B_w_down)
```

```asm
; @launch kernel=k1_kernel grid=(256,1,1) block=(512,1,1) lds=163840
; @launch kernel=k2_kernel grid=(256,1,1) block=(256,1,1) lds=81920
.amdgcn_target "amdgcn-amd-amdhsa--gfx950"
.text
.globl k1_kernel
.p2align 8
.type k1_kernel,@function
k1_kernel:
    s_load_dwordx16 s[4:19], s[0:1], 0
    s_load_dwordx4 s[20:23], s[0:1], 64
    s_load_dwordx2 s[24:25], s[0:1], 80
    s_cmp_ge_u32 s2, 256
    s_cbranch_scc1 Lk1_exit
    s_waitcnt lgkmcnt(0)
    s_cmp_ge_u32 s2, 128
    s_cbranch_scc1 Lk1_qkv
    s_lshr_b32 s51, s2, 3
    s_and_b32 s52, s2, 7
    v_mov_b32 v209, v0
    v_and_b32 v207, 63, v0
    v_lshrrev_b32 v208, 6, v0
    s_nop 0
    v_readfirstlane_b32 s47, v208
    s_lshl_b32 s46, s47, 10
    s_mov_b32 s28, s4
    s_and_b32 s29, s5, 0xffff
    s_mov_b32 s30, 0x280000
    s_mov_b32 s31, 0x00020000
    v_lshrrev_b32 v210, 3, v207
    v_and_b32 v211, 7, v207
    v_xor_b32 v212, v211, v210
    s_lshl_b32 s48, s51, 7
    v_lshl_add_u32 v213, v208, 3, v210
    v_add_u32 v213, s48, v213
    s_movk_i32 s49, 1280
    v_mul_lo_u32 v213, v213, s49
    v_lshl_add_u32 v195, v212, 4, v213
    v_add_u32 v196, 81920, v195
    v_and_b32 v213, 3, v208
    v_bfe_u32 v214, v210, 1, 1
    v_and_b32 v215, 1, v213
    v_lshl_add_u32 v214, v215, 1, v214
    v_lshlrev_b32 v214, 1, v214
    v_xor_b32 v214, v211, v214
    v_lshl_add_u32 v215, v213, 3, v210
    s_movk_i32 s49, 3072
    v_mul_lo_u32 v215, v215, s49
    v_lshl_add_u32 v215, v214, 4, v215
    v_lshrrev_b32 v216, 2, v208
    v_lshl_add_u32 v215, v216, 7, v215
    s_mul_i32 s48, s52, 384
    v_add_u32 v192, s48, v215
    v_mov_b32 v217, 256
    v_mov_b32 v218, 0xffffff80
    v_cmp_eq_u32 vcc, 0, v216
    s_nop 1
    v_cndmask_b32 v217, v218, v217, vcc
    v_add_u32 v193, v217, v192
    v_add_u32 v194, 128, v192
    s_mov_b32 s32, s14
    s_and_b32 s33, s15, 0xffff
    s_mov_b32 s34, 0x1e0000
    s_mov_b32 s35, 0x00020000
    s_mov_b32 s36, s16
    s_and_b32 s37, s17, 0xffff
    s_mov_b32 s38, 0x1e0000
    s_mov_b32 s39, 0x00020000
    s_mov_b32 s40, s14
    s_and_b32 s41, s15, 0xffff
    s_mov_b32 s42, 0x1e0000
    s_mov_b32 s43, 0x00020000
    s_cmp_lt_u32 s47, 4
    s_cselect_b32 s40, s40, s36
    s_cselect_b32 s41, s41, s37
    s_mov_b32 s44, 0
    s_mov_b32 s45, 0
    s_add_u32 m0, s46, 0x18000
    s_nop 0
    buffer_load_dwordx4 v195, s[28:31], s44 offen lds
    s_add_u32 m0, s46, 0x1a000
    s_nop 0
    buffer_load_dwordx4 v196, s[28:31], s44 offen lds
    s_add_u32 s44, s44, 128
    s_add_u32 m0, s46, 0x0
    s_nop 0
    buffer_load_dwordx4 v192, s[32:35], s45 offen lds
    s_add_u32 m0, s46, 0x2000
    s_nop 0
    buffer_load_dwordx4 v193, s[40:43], s45 offen lds
    s_add_u32 m0, s46, 0x4000
    s_nop 0
    buffer_load_dwordx4 v194, s[36:39], s45 offen lds
    s_add_u32 s45, s45, 98304
    s_add_u32 m0, s46, 0x1c000
    s_nop 0
    buffer_load_dwordx4 v195, s[28:31], s44 offen lds
    s_add_u32 m0, s46, 0x1e000
    s_nop 0
    buffer_load_dwordx4 v196, s[28:31], s44 offen lds
    s_add_u32 s44, s44, 128
    s_add_u32 m0, s46, 0x6000
    s_nop 0
    buffer_load_dwordx4 v192, s[32:35], s45 offen lds
    s_add_u32 m0, s46, 0x8000
    s_nop 0
    buffer_load_dwordx4 v193, s[40:43], s45 offen lds
    s_add_u32 m0, s46, 0xa000
    s_nop 0
    buffer_load_dwordx4 v194, s[36:39], s45 offen lds
    s_add_u32 s45, s45, 98304
    s_add_u32 m0, s46, 0xc000
    s_nop 0
    buffer_load_dwordx4 v192, s[32:35], s45 offen lds
    s_add_u32 m0, s46, 0xe000
    s_nop 0
    buffer_load_dwordx4 v193, s[40:43], s45 offen lds
    s_add_u32 m0, s46, 0x10000
    s_nop 0
    buffer_load_dwordx4 v194, s[36:39], s45 offen lds
    s_add_u32 s45, s45, 98304
    v_and_b32 v210, 15, v207
    v_lshrrev_b32 v211, 4, v207
    v_lshrrev_b32 v213, 2, v208
    v_and_b32 v214, 3, v208
    v_and_b32 v215, 7, v210
    v_mul_u32_u24 v216, 8192, v213
    v_lshl_add_u32 v216, v210, 7, v216
    v_add_u32 v216, 98304, v216
    v_add_u32 v217, 0, v211
    v_xor_b32 v217, v217, v215
    v_lshl_add_u32 v197, v217, 4, v216
    v_add_u32 v217, 4, v211
    v_xor_b32 v217, v217, v215
    v_lshl_add_u32 v198, v217, 4, v216
    v_bfe_u32 v215, v210, 3, 1
    v_and_b32 v216, 1, v211
    v_lshl_add_u32 v215, v216, 1, v215
    v_lshrrev_b32 v216, 2, v210
    v_lshl_add_u32 v216, v211, 3, v216
    v_lshlrev_b32 v216, 7, v216
    v_and_b32 v217, 3, v210
    v_lshl_add_u32 v216, v217, 3, v216
    v_mul_u32_u24 v217, 3, v214
    v_add_u32 v218, 0, v217
    v_and_b32 v219, 3, v218
    v_xor_b32 v219, v219, v215
    v_lshl_add_u32 v219, v219, 5, v216
    v_lshrrev_b32 v218, 2, v218
    v_lshl_add_u32 v199, v218, 12, v219
    v_add_u32 v200, 0x10000, v199
    v_add_u32 v218, 1, v217
    v_and_b32 v219, 3, v218
    v_xor_b32 v219, v219, v215
    v_lshl_add_u32 v219, v219, 5, v216
    v_lshrrev_b32 v218, 2, v218
    v_lshl_add_u32 v201, v218, 12, v219
    v_add_u32 v202, 0x10000, v201
    v_add_u32 v218, 2, v217
    v_and_b32 v219, 3, v218
    v_xor_b32 v219, v219, v215
    v_lshl_add_u32 v219, v219, 5, v216
    v_lshrrev_b32 v218, 2, v218
    v_lshl_add_u32 v203, v218, 12, v219
    v_add_u32 v204, 0x10000, v203
    v_add_u32 v218, 3, v217
    v_and_b32 v219, 3, v218
    v_xor_b32 v219, v219, v215
    v_lshl_add_u32 v219, v219, 5, v216
    v_lshrrev_b32 v218, 2, v218
    v_lshl_add_u32 v205, v218, 12, v219
    v_add_u32 v206, 0x10000, v205
    s_mov_b32 s60, s22
    s_and_b32 s61, s23, 0xffff
    s_mov_b32 s62, 0x100
    s_mov_b32 s63, 0x00020000
    s_cmp_lg_u32 s2, 220
    s_cbranch_scc1 LGU_pp_nf
    s_add_u32 s56, s24, 0x1130000
    s_addc_u32 s57, s25, 0
    s_and_b32 s57, s57, 0xffff
    s_mov_b32 s58, 0x1000
    s_mov_b32 s59, 0x00020000
    v_lshlrev_b32 v1, 4, v209
    v_mov_b32 v8, 0
    v_mov_b32 v9, 0
    v_mov_b32 v10, 0
    v_mov_b32 v11, 0
    buffer_store_dwordx4 v[8:11], v1, s[56:59], 0 offen
LGU_pp_nf:
    s_cmp_ge_u32 s2, 220
    s_cbranch_scc1 LGU_pp_done
    s_cmp_ge_u32 s2, 206
    s_cbranch_scc1 LGU_pp_zero
    s_cmp_ge_u32 s2, 78
    s_cbranch_scc1 LGU_pp_stats
    s_mov_b32 s56, s6
    s_and_b32 s57, s7, 0xffff
    s_mov_b32 s58, 0x258000
    s_mov_b32 s59, 0x00020000
    s_movk_i32 s54, 3840
    s_lshl_b32 s55, s2, 7
    s_cmp_lt_u32 s2, 30
    s_cbranch_scc1 LGU_pp_cs
    s_mov_b32 s56, s14
    s_and_b32 s57, s15, 0xffff
    s_mov_b32 s58, 0x1e0000
    s_mov_b32 s59, 0x00020000
    s_movk_i32 s54, 3072
    s_sub_u32 s55, s55, 3840
    s_cmp_lt_u32 s2, 54
    s_cbranch_scc1 LGU_pp_cs
    s_mov_b32 s56, s16
    s_and_b32 s57, s17, 0xffff
    s_mov_b32 s58, 0x1e0000
    s_mov_b32 s59, 0x00020000
    s_sub_u32 s55, s55, 3072
LGU_pp_cs:
    v_and_b32 v1, 7, v209
    v_lshrrev_b32 v2, 3, v209
    v_mul_lo_u32 v2, v2, s54
    v_lshl_add_u32 v2, v1, 4, v2
    v_add_u32 v2, s55, v2
    s_lshl_b32 s54, s54, 6
    s_mov_b32 s55, 0
    buffer_load_dwordx4 v[214:217], v2, s[56:59], s55 offen
    s_add_u32 s55, s55, s54
    buffer_load_dwordx4 v[218:221], v2, s[56:59], s55 offen
    s_add_u32 s55, s55, s54
    buffer_load_dwordx4 v[222:225], v2, s[56:59], s55 offen
    s_add_u32 s55, s55, s54
    buffer_load_dwordx4 v[226:229], v2, s[56:59], s55 offen
    s_add_u32 s55, s55, s54
    buffer_load_dwordx4 v[230:233], v2, s[56:59], s55 offen
    s_add_u32 s55, s55, s54
    buffer_load_dwordx4 v[234:237], v2, s[56:59], s55 offen
    s_add_u32 s55, s55, s54
    buffer_load_dwordx4 v[238:241], v2, s[56:59], s55 offen
    s_add_u32 s55, s55, s54
    buffer_load_dwordx4 v[242:245], v2, s[56:59], s55 offen
    s_add_u32 s55, s55, s54
    buffer_load_dwordx4 v[246:249], v2, s[56:59], s55 offen
    s_add_u32 s55, s55, s54
    buffer_load_dwordx4 v[250:253], v2, s[56:59], s55 offen
    s_branch LGU_pp_done
LGU_pp_stats:
    s_sub_u32 s54, s2, 78
    s_lshl_b32 s54, s54, 4
    v_lshrrev_b32 v1, 5, v209
    v_add_u32 v1, s54, v1
    v_and_b32 v2, 31, v209
    v_mul_u32_u24 v3, 40, v2
    s_movk_i32 s55, 1280
    v_mul_lo_u32 v4, v1, s55
    v_add_u32 v3, v3, v4
    s_waitcnt vmcnt(9)
    buffer_load_dwordx4 v[214:217], v3, s[28:31], 0 offen
    s_waitcnt vmcnt(9)
    buffer_load_dwordx4 v[218:221], v3, s[28:31], 0 offen offset:16
    s_waitcnt vmcnt(9)
    buffer_load_dwordx2 v[222:223], v3, s[28:31], 0 offen offset:32
    s_branch LGU_pp_done
LGU_pp_zero:
    s_add_u32 s56, s24, 0x1100000
    s_addc_u32 s57, s25, 0
    s_and_b32 s57, s57, 0xffff
    s_mov_b32 s58, 0x1a400
    s_mov_b32 s59, 0x00020000
    s_sub_u32 s54, s2, 206
    s_mul_i32 s54, s54, 7680
    v_lshlrev_b32 v1, 4, v209
    v_add_u32 v1, s54, v1
    v_mov_b32 v3, 0x7fffff00
    v_cmp_gt_u32 vcc, 480, v209
    s_nop 1
    v_cndmask_b32 v1, v3, v1, vcc
    v_mov_b32 v8, 0
    v_mov_b32 v9, 0
    v_mov_b32 v10, 0
    v_mov_b32 v11, 0
    buffer_store_dwordx4 v[8:11], v1, s[56:59], 0 offen sc1
LGU_pp_done:
    v_mov_b32 v0, 0
    v_mov_b32 v1, 0
    v_mov_b32 v2, 0
    v_mov_b32 v3, 0
    v_mov_b32 v4, 0
    v_mov_b32 v5, 0
    v_mov_b32 v6, 0
    v_mov_b32 v7, 0
    v_mov_b32 v8, 0
    v_mov_b32 v9, 0
    v_mov_b32 v10, 0
    v_mov_b32 v11, 0
    v_mov_b32 v12, 0
    v_mov_b32 v13, 0
    v_mov_b32 v14, 0
    v_mov_b32 v15, 0
    v_mov_b32 v16, 0
    v_mov_b32 v17, 0
    v_mov_b32 v18, 0
    v_mov_b32 v19, 0
    v_mov_b32 v20, 0
    v_mov_b32 v21, 0
    v_mov_b32 v22, 0
    v_mov_b32 v23, 0
    v_mov_b32 v24, 0
    v_mov_b32 v25, 0
    v_mov_b32 v26, 0
    v_mov_b32 v27, 0
    v_mov_b32 v28, 0
    v_mov_b32 v29, 0
    v_mov_b32 v30, 0
    v_mov_b32 v31, 0
    v_mov_b32 v32, 0
    v_mov_b32 v33, 0
    v_mov_b32 v34, 0
    v_mov_b32 v35, 0
    v_mov_b32 v36, 0
    v_mov_b32 v37, 0
    v_mov_b32 v38, 0
    v_mov_b32 v39, 0
    v_mov_b32 v40, 0
    v_mov_b32 v41, 0
    v_mov_b32 v42, 0
    v_mov_b32 v43, 0
    v_mov_b32 v44, 0
    v_mov_b32 v45, 0
    v_mov_b32 v46, 0
    v_mov_b32 v47, 0
    v_mov_b32 v48, 0
    v_mov_b32 v49, 0
    v_mov_b32 v50, 0
    v_mov_b32 v51, 0
    v_mov_b32 v52, 0
    v_mov_b32 v53, 0
    v_mov_b32 v54, 0
    v_mov_b32 v55, 0
    v_mov_b32 v56, 0
    v_mov_b32 v57, 0
    v_mov_b32 v58, 0
    v_mov_b32 v59, 0
    v_mov_b32 v60, 0
    v_mov_b32 v61, 0
    v_mov_b32 v62, 0
    v_mov_b32 v63, 0
    v_mov_b32 v64, 0
    v_mov_b32 v65, 0
    v_mov_b32 v66, 0
    v_mov_b32 v67, 0
    v_mov_b32 v68, 0
    v_mov_b32 v69, 0
    v_mov_b32 v70, 0
    v_mov_b32 v71, 0
    v_mov_b32 v72, 0
    v_mov_b32 v73, 0
    v_mov_b32 v74, 0
    v_mov_b32 v75, 0
    v_mov_b32 v76, 0
    v_mov_b32 v77, 0
    v_mov_b32 v78, 0
    v_mov_b32 v79, 0
    v_mov_b32 v80, 0
    v_mov_b32 v81, 0
    v_mov_b32 v82, 0
    v_mov_b32 v83, 0
    v_mov_b32 v84, 0
    v_mov_b32 v85, 0
    v_mov_b32 v86, 0
    v_mov_b32 v87, 0
    v_mov_b32 v88, 0
    v_mov_b32 v89, 0
    v_mov_b32 v90, 0
    v_mov_b32 v91, 0
    v_mov_b32 v92, 0
    v_mov_b32 v93, 0
    v_mov_b32 v94, 0
    v_mov_b32 v95, 0
    s_waitcnt vmcnt(8)
    s_barrier
    ds_read_b128 v[96:99], v197 offset:0
    ds_read_b64_tr_b16 v[112:113], v199 offset:0
    ds_read_b64_tr_b16 v[114:115], v199 offset:512
    ds_read_b128 v[100:103], v197 offset:2048
    ds_read_b128 v[104:107], v197 offset:4096
    ds_read_b128 v[108:111], v197 offset:6144
    ds_read_b64_tr_b16 v[116:117], v201 offset:0
    ds_read_b64_tr_b16 v[118:119], v201 offset:512
    ds_read_b64_tr_b16 v[120:121], v203 offset:0
    ds_read_b64_tr_b16 v[122:123], v203 offset:512
    ds_read_b64_tr_b16 v[124:125], v199 offset:12288
    ds_read_b64_tr_b16 v[126:127], v199 offset:12800
    ds_read_b64_tr_b16 v[128:129], v201 offset:12288
    ds_read_b64_tr_b16 v[130:131], v201 offset:12800
    ds_read_b64_tr_b16 v[132:133], v203 offset:12288
    ds_read_b64_tr_b16 v[134:135], v203 offset:12800
    s_waitcnt vmcnt(3)
    s_barrier
    s_waitcnt vmcnt(0)
    s_cmp_ge_u32 s2, 206
    s_cbranch_scc1 LGU_p1_done
    s_cmp_ge_u32 s2, 78
    s_cbranch_scc1 LGU_p1_stats
    v_lshlrev_b32 v144, 16, v214
    v_and_b32 v145, 0xffff0000, v214
    v_lshlrev_b32 v146, 16, v215
    v_and_b32 v147, 0xffff0000, v215
    v_lshlrev_b32 v148, 16, v216
    v_and_b32 v149, 0xffff0000, v216
    v_lshlrev_b32 v150, 16, v217
    v_and_b32 v151, 0xffff0000, v217
    v_lshlrev_b32 v152, 16, v218
    v_and_b32 v153, 0xffff0000, v218
    v_lshlrev_b32 v154, 16, v219
    v_and_b32 v155, 0xffff0000, v219
    v_lshlrev_b32 v156, 16, v220
    v_and_b32 v157, 0xffff0000, v220
    v_lshlrev_b32 v158, 16, v221
    v_and_b32 v159, 0xffff0000, v221
    v_pk_add_f32 v[144:145], v[144:145], v[152:153]
    v_pk_add_f32 v[146:147], v[146:147], v[154:155]
    v_pk_add_f32 v[148:149], v[148:149], v[156:157]
    v_pk_add_f32 v[150:151], v[150:151], v[158:159]
    v_lshlrev_b32 v152, 16, v222
    v_and_b32 v153, 0xffff0000, v222
    v_lshlrev_b32 v154, 16, v223
    v_and_b32 v155, 0xffff0000, v223
    v_lshlrev_b32 v156, 16, v224
    v_and_b32 v157, 0xffff0000, v224
    v_lshlrev_b32 v158, 16, v225
    v_and_b32 v159, 0xffff0000, v225
    v_pk_add_f32 v[144:145], v[144:145], v[152:153]
    v_pk_add_f32 v[146:147], v[146:147], v[154:155]
    v_pk_add_f32 v[148:149], v[148:149], v[156:157]
    v_pk_add_f32 v[150:151], v[150:151], v[158:159]
    v_lshlrev_b32 v152, 16, v226
    v_and_b32 v153, 0xffff0000, v226
    v_lshlrev_b32 v154, 16, v227
    v_and_b32 v155, 0xffff0000, v227
    v_lshlrev_b32 v156, 16, v228
    v_and_b32 v157, 0xffff0000, v228
    v_lshlrev_b32 v158, 16, v229
    v_and_b32 v159, 0xffff0000, v229
    v_pk_add_f32 v[144:145], v[144:145], v[152:153]
    v_pk_add_f32 v[146:147], v[146:147], v[154:155]
    v_pk_add_f32 v[148:149], v[148:149], v[156:157]
    v_pk_add_f32 v[150:151], v[150:151], v[158:159]
    v_lshlrev_b32 v152, 16, v230
    v_and_b32 v153, 0xffff0000, v230
    v_lshlrev_b32 v154, 16, v231
    v_and_b32 v155, 0xffff0000, v231
    v_lshlrev_b32 v156, 16, v232
    v_and_b32 v157, 0xffff0000, v232
    v_lshlrev_b32 v158, 16, v233
    v_and_b32 v159, 0xffff0000, v233
    v_pk_add_f32 v[144:145], v[144:145], v[152:153]
    v_pk_add_f32 v[146:147], v[146:147], v[154:155]
    v_pk_add_f32 v[148:149], v[148:149], v[156:157]
    v_pk_add_f32 v[150:151], v[150:151], v[158:159]
    v_lshlrev_b32 v152, 16, v234
    v_and_b32 v153, 0xffff0000, v234
    v_lshlrev_b32 v154, 16, v235
    v_and_b32 v155, 0xffff0000, v235
    v_lshlrev_b32 v156, 16, v236
    v_and_b32 v157, 0xffff0000, v236
    v_lshlrev_b32 v158, 16, v237
    v_and_b32 v159, 0xffff0000, v237
    v_pk_add_f32 v[144:145], v[144:145], v[152:153]
    v_pk_add_f32 v[146:147], v[146:147], v[154:155]
    v_pk_add_f32 v[148:149], v[148:149], v[156:157]
    v_pk_add_f32 v[150:151], v[150:151], v[158:159]
    v_lshlrev_b32 v152, 16, v238
    v_and_b32 v153, 0xffff0000, v238
    v_lshlrev_b32 v154, 16, v239
    v_and_b32 v155, 0xffff0000, v239
    v_lshlrev_b32 v156, 16, v240
    v_and_b32 v157, 0xffff0000, v240
    v_lshlrev_b32 v158, 16, v241
    v_and_b32 v159, 0xffff0000, v241
    v_pk_add_f32 v[144:145], v[144:145], v[152:153]
    v_pk_add_f32 v[146:147], v[146:147], v[154:155]
    v_pk_add_f32 v[148:149], v[148:149], v[156:157]
    v_pk_add_f32 v[150:151], v[150:151], v[158:159]
    v_lshlrev_b32 v152, 16, v242
    v_and_b32 v153, 0xffff0000, v242
    v_lshlrev_b32 v154, 16, v243
    v_and_b32 v155, 0xffff0000, v243
    v_lshlrev_b32 v156, 16, v244
    v_and_b32 v157, 0xffff0000, v244
    v_lshlrev_b32 v158, 16, v245
    v_and_b32 v159, 0xffff0000, v245
    v_pk_add_f32 v[144:145], v[144:145], v[152:153]
    v_pk_add_f32 v[146:147], v[146:147], v[154:155]
    v_pk_add_f32 v[148:149], v[148:149], v[156:157]
    v_pk_add_f32 v[150:151], v[150:151], v[158:159]
    v_lshlrev_b32 v152, 16, v246
    v_and_b32 v153, 0xffff0000, v246
    v_lshlrev_b32 v154, 16, v247
    v_and_b32 v155, 0xffff0000, v247
    v_lshlrev_b32 v156, 16, v248
    v_and_b32 v157, 0xffff0000, v248
    v_lshlrev_b32 v158, 16, v249
    v_and_b32 v159, 0xffff0000, v249
    v_pk_add_f32 v[144:145], v[144:145], v[152:153]
    v_pk_add_f32 v[146:147], v[146:147], v[154:155]
    v_pk_add_f32 v[148:149], v[148:149], v[156:157]
    v_pk_add_f32 v[150:151], v[150:151], v[158:159]
    v_lshlrev_b32 v152, 16, v250
    v_and_b32 v153, 0xffff0000, v250
    v_lshlrev_b32 v154, 16, v251
    v_and_b32 v155, 0xffff0000, v251
    v_lshlrev_b32 v156, 16, v252
    v_and_b32 v157, 0xffff0000, v252
    v_lshlrev_b32 v158, 16, v253
    v_and_b32 v159, 0xffff0000, v253
    v_pk_add_f32 v[144:145], v[144:145], v[152:153]
    v_pk_add_f32 v[146:147], v[146:147], v[154:155]
    v_pk_add_f32 v[148:149], v[148:149], v[156:157]
    v_pk_add_f32 v[150:151], v[150:151], v[158:159]
    v_add_f32_dpp v144, v144, v144 row_ror:8 row_mask:0xf bank_mask:0xf
    v_add_f32_dpp v145, v145, v145 row_ror:8 row_mask:0xf bank_mask:0xf
    v_add_f32_dpp v146, v146, v146 row_ror:8 row_mask:0xf bank_mask:0xf
    v_add_f32_dpp v147, v147, v147 row_ror:8 row_mask:0xf bank_mask:0xf
    v_add_f32_dpp v148, v148, v148 row_ror:8 row_mask:0xf bank_mask:0xf
    v_add_f32_dpp v149, v149, v149 row_ror:8 row_mask:0xf bank_mask:0xf
    v_add_f32_dpp v150, v150, v150 row_ror:8 row_mask:0xf bank_mask:0xf
    v_add_f32_dpp v151, v151, v151 row_ror:8 row_mask:0xf bank_mask:0xf
    v_mov_b32 v152, v144
    v_mov_b32 v153, v144
    s_nop 1
    v_permlane16_swap_b32 v152, v153
    v_add_f32 v144, v152, v153
    v_mov_b32 v154, v145
    v_mov_b32 v155, v145
    s_nop 1
    v_permlane16_swap_b32 v154, v155
    v_add_f32 v145, v154, v155
    v_mov_b32 v156, v146
    v_mov_b32 v157, v146
    s_nop 1
    v_permlane16_swap_b32 v156, v157
    v_add_f32 v146, v156, v157
    v_mov_b32 v158, v147
    v_mov_b32 v159, v147
    s_nop 1
    v_permlane16_swap_b32 v158, v159
    v_add_f32 v147, v158, v159
    v_mov_b32 v152, v148
    v_mov_b32 v153, v148
    s_nop 1
    v_permlane16_swap_b32 v152, v153
    v_add_f32 v148, v152, v153
    v_mov_b32 v154, v149
    v_mov_b32 v155, v149
    s_nop 1
    v_permlane16_swap_b32 v154, v155
    v_add_f32 v149, v154, v155
    v_mov_b32 v156, v150
    v_mov_b32 v157, v150
    s_nop 1
    v_permlane16_swap_b32 v156, v157
    v_add_f32 v150, v156, v157
    v_mov_b32 v158, v151
    v_mov_b32 v159, v151
    s_nop 1
    v_permlane16_swap_b32 v158, v159
    v_add_f32 v151, v158, v159
    v_mov_b32 v152, v144
    v_mov_b32 v153, v144
    s_nop 1
    v_permlane32_swap_b32 v152, v153
    v_add_f32 v144, v152, v153
    v_mov_b32 v154, v145
    v_mov_b32 v155, v145
    s_nop 1
    v_permlane32_swap_b32 v154, v155
    v_add_f32 v145, v154, v155
    v_mov_b32 v156, v146
    v_mov_b32 v157, v146
    s_nop 1
    v_permlane32_swap_b32 v156, v157
    v_add_f32 v146, v156, v157
    v_mov_b32 v158, v147
    v_mov_b32 v159, v147
    s_nop 1
    v_permlane32_swap_b32 v158, v159
    v_add_f32 v147, v158, v159
    v_mov_b32 v152, v148
    v_mov_b32 v153, v148
    s_nop 1
    v_permlane32_swap_b32 v152, v153
    v_add_f32 v148, v152, v153
    v_mov_b32 v154, v149
    v_mov_b32 v155, v149
    s_nop 1
    v_permlane32_swap_b32 v154, v155
    v_add_f32 v149, v154, v155
    v_mov_b32 v156, v150
    v_mov_b32 v157, v150
    s_nop 1
    v_permlane32_swap_b32 v156, v157
    v_add_f32 v150, v156, v157
    v_mov_b32 v158, v151
    v_mov_b32 v159, v151
    s_nop 1
    v_permlane32_swap_b32 v158, v159
    v_add_f32 v151, v158, v159
    v_and_b32 v214, 31, v209
    v_lshlrev_b32 v214, 3, v214
    v_lshlrev_b32 v212, 5, v207
    v_lshl_add_u32 v212, v208, 8, v212
    v_add_u32 v212, 147456, v212
    v_mov_b32 v213, 160320
    v_cmp_gt_u32 vcc, 8, v207
    s_nop 1
    v_cndmask_b32 v212, v213, v212, vcc
    ds_write_b128 v212, v[144:147]
    ds_write_b128 v212, v[148:151] offset:16
    s_waitcnt lgkmcnt(0)
    s_branch LGU_p1_done
LGU_p1_stats:
    v_mov_b32 v226, 0
    v_mov_b32 v227, 0
    v_mov_b32 v228, 0
    v_mov_b32 v229, 0
    v_lshlrev_b32 v210, 16, v214
    v_and_b32 v211, 0xffff0000, v214
    v_pk_add_f32 v[226:227], v[226:227], v[210:211]
    v_pk_fma_f32 v[228:229], v[210:211], v[210:211], v[228:229]
    v_lshlrev_b32 v210, 16, v215
    v_and_b32 v211, 0xffff0000, v215
    v_pk_add_f32 v[226:227], v[226:227], v[210:211]
    v_pk_fma_f32 v[228:229], v[210:211], v[210:211], v[228:229]
    v_lshlrev_b32 v210, 16, v216
    v_and_b32 v211, 0xffff0000, v216
    v_pk_add_f32 v[226:227], v[226:227], v[210:211]
    v_pk_fma_f32 v[228:229], v[210:211], v[210:211], v[228:229]
    v_lshlrev_b32 v210, 16, v217
    v_and_b32 v211, 0xffff0000, v217
    v_pk_add_f32 v[226:227], v[226:227], v[210:211]
    v_pk_fma_f32 v[228:229], v[210:211], v[210:211], v[228:229]
    v_lshlrev_b32 v210, 16, v218
    v_and_b32 v211, 0xffff0000, v218
    v_pk_add_f32 v[226:227], v[226:227], v[210:211]
    v_pk_fma_f32 v[228:229], v[210:211], v[210:211], v[228:229]
    v_lshlrev_b32 v210, 16, v219
    v_and_b32 v211, 0xffff0000, v219
    v_pk_add_f32 v[226:227], v[226:227], v[210:211]
    v_pk_fma_f32 v[228:229], v[210:211], v[210:211], v[228:229]
    v_lshlrev_b32 v210, 16, v220
    v_and_b32 v211, 0xffff0000, v220
    v_pk_add_f32 v[226:227], v[226:227], v[210:211]
    v_pk_fma_f32 v[228:229], v[210:211], v[210:211], v[228:229]
    v_lshlrev_b32 v210, 16, v221
    v_and_b32 v211, 0xffff0000, v221
    v_pk_add_f32 v[226:227], v[226:227], v[210:211]
    v_pk_fma_f32 v[228:229], v[210:211], v[210:211], v[228:229]
    v_lshlrev_b32 v210, 16, v222
    v_and_b32 v211, 0xffff0000, v222
    v_pk_add_f32 v[226:227], v[226:227], v[210:211]
    v_pk_fma_f32 v[228:229], v[210:211], v[210:211], v[228:229]
    v_lshlrev_b32 v210, 16, v223
    v_and_b32 v211, 0xffff0000, v223
    v_pk_add_f32 v[226:227], v[226:227], v[210:211]
    v_pk_fma_f32 v[228:229], v[210:211], v[210:211], v[228:229]
    v_add_f32 v226, v226, v227
    v_add_f32 v228, v228, v229
    s_nop 0
    v_add_f32_dpp v226, v226, v226 row_ror:8 row_mask:0xf bank_mask:0xf
    v_add_f32_dpp v228, v228, v228 row_ror:8 row_mask:0xf bank_mask:0xf
    s_nop 0
    v_add_f32_dpp v226, v226, v226 row_ror:4 row_mask:0xf bank_mask:0xf
    v_add_f32_dpp v228, v228, v228 row_ror:4 row_mask:0xf bank_mask:0xf
    s_nop 0
    v_add_f32_dpp v226, v226, v226 row_ror:2 row_mask:0xf bank_mask:0xf
    v_add_f32_dpp v228, v228, v228 row_ror:2 row_mask:0xf bank_mask:0xf
    s_nop 0
    v_add_f32_dpp v226, v226, v226 row_ror:1 row_mask:0xf bank_mask:0xf
    v_add_f32_dpp v228, v228, v228 row_ror:1 row_mask:0xf bank_mask:0xf
    v_mov_b32 v210, v226
    v_mov_b32 v211, v226
    s_nop 1
    v_permlane16_swap_b32 v210, v211
    v_add_f32 v226, v210, v211
    v_mov_b32 v210, v228
    v_mov_b32 v211, v228
    s_nop 1
    v_permlane16_swap_b32 v210, v211
    v_add_f32 v228, v210, v211
    s_mov_b32 s55, 0x3acccccd
    v_mul_f32 v226, s55, v226
    v_mul_f32 v228, s55, v228
    v_fma_f32 v228, -v226, v226, v228
    v_max_f32 v228, 0, v228
    v_cvt_pk_bf16_f32 v210, v226, v228
    v_lshlrev_b32 v215, 16, v210
    v_and_b32 v211, 0xffff0000, v210
    v_add_f32 v211, 0x3727c5ac, v211
    v_cvt_pk_bf16_f32 v211, v211, v211
    v_lshlrev_b32 v211, 16, v211
    v_sqrt_f32 v211, v211
    s_nop 0
    v_cvt_pk_bf16_f32 v211, v211, v211
    v_lshlrev_b32 v211, 16, v211
    v_rcp_f32 v214, v211
    s_add_u32 s56, s24, 0x1120000
    s_addc_u32 s57, s25, 0
    s_and_b32 s57, s57, 0xffff
    s_mov_b32 s58, 0x4000
    s_mov_b32 s59, 0x00020000
    s_sub_u32 s54, s2, 78
    s_lshl_b32 s54, s54, 4
    v_lshrrev_b32 v212, 5, v209
    v_add_u32 v212, s54, v212
    v_lshlrev_b32 v212, 3, v212
    v_and_b32 v210, 31, v209
    v_mov_b32 v213, 0x7fffff00
    v_cmp_eq_u32 vcc, 0, v210
    s_nop 1
    v_cndmask_b32 v212, v213, v212, vcc
    buffer_store_dwordx2 v[214:215], v212, s[56:59], 0 offen sc1
LGU_p1_done:
    s_add_u32 m0, s46, 0x20000
    s_nop 0
    buffer_load_dwordx4 v195, s[28:31], s44 offen lds
    s_add_u32 m0, s46, 0x22000
    s_nop 0
    buffer_load_dwordx4 v196, s[28:31], s44 offen lds
    s_add_u32 s44, s44, 128
    s_add_u32 m0, s46, 0x12000
    s_nop 0
    buffer_load_dwordx4 v192, s[32:35], s45 offen lds
    s_add_u32 m0, s46, 0x14000
    s_nop 0
    buffer_load_dwordx4 v193, s[40:43], s45 offen lds
    s_add_u32 m0, s46, 0x16000
    s_nop 0
    buffer_load_dwordx4 v194, s[36:39], s45 offen lds
    s_add_u32 s45, s45, 98304
    ds_read_b128 v[144:147], v198 offset:0
    ds_read_b64_tr_b16 v[160:161], v199 offset:24576
    ds_read_b64_tr_b16 v[162:163], v199 offset:25088
    ds_read_b128 v[148:151], v198 offset:2048
    ds_read_b128 v[152:155], v198 offset:4096
    ds_read_b128 v[156:159], v198 offset:6144
    ds_read_b64_tr_b16 v[164:165], v201 offset:24576
    ds_read_b64_tr_b16 v[166:167], v201 offset:25088
    ds_read_b64_tr_b16 v[168:169], v203 offset:24576
    ds_read_b64_tr_b16 v[170:171], v203 offset:25088
    ds_read_b64_tr_b16 v[172:173], v199 offset:36864
    ds_read_b64_tr_b16 v[174:175], v199 offset:37376
    ds_read_b64_tr_b16 v[176:177], v201 offset:36864
    ds_read_b64_tr_b16 v[178:179], v201 offset:37376
    ds_read_b64_tr_b16 v[180:181], v203 offset:36864
    ds_read_b64_tr_b16 v[182:183], v203 offset:37376
    s_waitcnt lgkmcnt(15)
    v_mfma_f32_16x16x32_bf16 v[0:3], v[112:115], v[96:99], v[0:3]
    s_waitcnt lgkmcnt(15)
    v_mfma_f32_16x16x32_bf16 v[4:7], v[112:115], v[100:103], v[4:7]
    s_waitcnt lgkmcnt(15)
    v_mfma_f32_16x16x32_bf16 v[8:11], v[112:115], v[104:107], v[8:11]
    s_waitcnt lgkmcnt(15)
    v_mfma_f32_16x16x32_bf16 v[12:15], v[112:115], v[108:111], v[12:15]
    s_waitcnt lgkmcnt(15)
    v_mfma_f32_16x16x32_bf16 v[16:19], v[116:119], v[96:99], v[16:19]
    v_mfma_f32_16x16x32_bf16 v[20:23], v[116:119], v[100:103], v[20:23]
    v_mfma_f32_16x16x32_bf16 v[24:27], v[116:119], v[104:107], v[24:27]
    v_mfma_f32_16x16x32_bf16 v[28:31], v[116:119], v[108:111], v[28:31]
    s_waitcnt lgkmcnt(15)
    v_mfma_f32_16x16x32_bf16 v[32:35], v[120:123], v[96:99], v[32:35]
    v_mfma_f32_16x16x32_bf16 v[36:39], v[120:123], v[100:103], v[36:39]
    v_mfma_f32_16x16x32_bf16 v[40:43], v[120:123], v[104:107], v[40:43]
    v_mfma_f32_16x16x32_bf16 v[44:47], v[120:123], v[108:111], v[44:47]
    s_waitcnt lgkmcnt(15)
    v_mfma_f32_16x16x32_bf16 v[48:51], v[124:127], v[96:99], v[48:51]
    v_mfma_f32_16x16x32_bf16 v[52:55], v[124:127], v[100:103], v[52:55]
    v_mfma_f32_16x16x32_bf16 v[56:59], v[124:127], v[104:107], v[56:59]
    v_mfma_f32_16x16x32_bf16 v[60:63], v[124:127], v[108:111], v[60:63]
    s_waitcnt lgkmcnt(15)
    v_mfma_f32_16x16x32_bf16 v[64:67], v[128:131], v[96:99], v[64:67]
    v_mfma_f32_16x16x32_bf16 v[68:71], v[128:131], v[100:103], v[68:71]
    v_mfma_f32_16x16x32_bf16 v[72:75], v[128:131], v[104:107], v[72:75]
    v_mfma_f32_16x16x32_bf16 v[76:79], v[128:131], v[108:111], v[76:79]
    s_waitcnt lgkmcnt(15)
    v_mfma_f32_16x16x32_bf16 v[80:83], v[132:135], v[96:99], v[80:83]
    v_mfma_f32_16x16x32_bf16 v[84:87], v[132:135], v[100:103], v[84:87]
    v_mfma_f32_16x16x32_bf16 v[88:91], v[132:135], v[104:107], v[88:91]
    v_mfma_f32_16x16x32_bf16 v[92:95], v[132:135], v[108:111], v[92:95]
    s_waitcnt vmcnt(5)
    s_barrier
    s_cmp_ge_u32 s2, 78
    s_cbranch_scc1 LGU_p2_done
    s_waitcnt lgkmcnt(0)
    v_add_u32 v212, 147456, v214
    ds_read_b64 v[216:217], v212 offset:0
    ds_read_b64 v[218:219], v212 offset:256
    ds_read_b64 v[220:221], v212 offset:512
    ds_read_b64 v[222:223], v212 offset:768
    ds_read_b64 v[224:225], v212 offset:1024
    ds_read_b64 v[226:227], v212 offset:1280
    ds_read_b64 v[228:229], v212 offset:1536
    ds_read_b64 v[230:231], v212 offset:1792
    s_waitcnt lgkmcnt(6)
    v_pk_add_f32 v[216:217], v[216:217], v[218:219]
    s_waitcnt lgkmcnt(5)
    v_pk_add_f32 v[216:217], v[216:217], v[220:221]
    s_waitcnt lgkmcnt(4)
    v_pk_add_f32 v[216:217], v[216:217], v[222:223]
    s_waitcnt lgkmcnt(3)
    v_pk_add_f32 v[216:217], v[216:217], v[224:225]
    s_waitcnt lgkmcnt(2)
    v_pk_add_f32 v[216:217], v[216:217], v[226:227]
    s_waitcnt lgkmcnt(1)
    v_pk_add_f32 v[216:217], v[216:217], v[228:229]
    s_waitcnt lgkmcnt(0)
    v_pk_add_f32 v[216:217], v[216:217], v[230:231]
    s_add_u32 s56, s24, 0x1128000
    s_addc_u32 s57, s25, 0
    s_and_b32 s57, s57, 0xffff
    s_mov_b32 s58, 0x4e00
    s_mov_b32 s59, 0x00020000
    s_lshl_b32 s55, s2, 8
    v_add_u32 v210, s55, v214
    v_mov_b32 v213, 0x7fffff00
    v_cmp_gt_u32 vcc, 32, v209
    s_nop 1
    v_cndmask_b32 v210, v213, v210, vcc
    buffer_store_dwordx2 v[216:217], v210, s[56:59], 0 offen sc1
LGU_p2_done:
    s_add_u32 m0, s46, 0x0
    s_nop 0
    buffer_load_dwordx4 v192, s[32:35], s45 offen lds
    s_add_u32 m0, s46, 0x2000
    s_nop 0
    buffer_load_dwordx4 v193, s[40:43], s45 offen lds
    s_add_u32 m0, s46, 0x4000
    s_nop 0
    buffer_load_dwordx4 v194, s[36:39], s45 offen lds
    s_add_u32 s45, s45, 98304
    ds_read_b128 v[96:99], v197 offset:16384
    ds_read_b64_tr_b16 v[112:113], v199 offset:49152
    ds_read_b64_tr_b16 v[114:115], v199 offset:49664
    ds_read_b128 v[100:103], v197 offset:18432
    ds_read_b128 v[104:107], v197 offset:20480
    ds_read_b128 v[108:111], v197 offset:22528
    ds_read_b64_tr_b16 v[116:117], v201 offset:49152
    ds_read_b64_tr_b16 v[118:119], v201 offset:49664
    ds_read_b64_tr_b16 v[120:121], v203 offset:49152
    ds_read_b64_tr_b16 v[122:123], v203 offset:49664
    ds_read_b64_tr_b16 v[124:125], v199 offset:61440
    ds_read_b64_tr_b16 v[126:127], v199 offset:61952
    ds_read_b64_tr_b16 v[128:129], v201 offset:61440
    ds_read_b64_tr_b16 v[130:131], v201 offset:61952
    ds_read_b64_tr_b16 v[132:133], v203 offset:61440
    ds_read_b64_tr_b16 v[134:135], v203 offset:61952
    s_waitcnt lgkmcnt(15)
    v_mfma_f32_16x16x32_bf16 v[0:3], v[160:163], v[144:147], v[0:3]
    s_waitcnt lgkmcnt(15)
    v_mfma_f32_16x16x32_bf16 v[4:7], v[160:163], v[148:151], v[4:7]
    s_waitcnt lgkmcnt(15)
    v_mfma_f32_16x16x32_bf16 v[8:11], v[160:163], v[152:155], v[8:11]
    s_waitcnt lgkmcnt(15)
    v_mfma_f32_16x16x32_bf16 v[12:15], v[160:163], v[156:159], v[12:15]
    s_waitcnt lgkmcnt(15)
    v_mfma_f32_16x16x32_bf16 v[16:19], v[164:167], v[144:147], v[16:19]
    v_mfma_f32_16x16x32_bf16 v[20:23], v[164:167], v[148:151], v[20:23]
    v_mfma_f32_16x16x32_bf16 v[24:27], v[164:167], v[152:155], v[24:27]
    v_mfma_f32_16x16x32_bf16 v[28:31], v[164:167], v[156:159], v[28:31]
    s_waitcnt lgkmcnt(15)
    v_mfma_f32_16x16x32_bf16 v[32:35], v[168:171], v[144:147], v[32:35]
    v_mfma_f32_16x16x32_bf16 v[36:39], v[168:171], v[148:151], v[36:39]
    v_mfma_f32_16x16x32_bf16 v[40:43], v[168:171], v[152:155], v[40:43]
    v_mfma_f32_16x16x32_bf16 v[44:47], v[168:171], v[156:159], v[44:47]
    s_waitcnt lgkmcnt(15)
    v_mfma_f32_16x16x32_bf16 v[48:51], v[172:175], v[144:147], v[48:51]
    v_mfma_f32_16x16x32_bf16 v[52:55], v[172:175], v[148:151], v[52:55]
    v_mfma_f32_16x16x32_bf16 v[56:59], v[172:175], v[152:155], v[56:59]
    v_mfma_f32_16x16x32_bf16 v[60:63], v[172:175], v[156:159], v[60:63]
    s_waitcnt lgkmcnt(15)
    v_mfma_f32_16x16x32_bf16 v[64:67], v[176:179], v[144:147], v[64:67]
    v_mfma_f32_16x16x32_bf16 v[68:71], v[176:179], v[148:151], v[68:71]
    v_mfma_f32_16x16x32_bf16 v[72:75], v[176:179], v[152:155], v[72:75]
    v_mfma_f32_16x16x32_bf16 v[76:79], v[176:179], v[156:159], v[76:79]
    s_waitcnt lgkmcnt(15)
    v_mfma_f32_16x16x32_bf16 v[80:83], v[180:183], v[144:147], v[80:83]
    v_mfma_f32_16x16x32_bf16 v[84:87], v[180:183], v[148:151], v[84:87]
    v_mfma_f32_16x16x32_bf16 v[88:91], v[180:183], v[152:155], v[88:91]
    v_mfma_f32_16x16x32_bf16 v[92:95], v[180:183], v[156:159], v[92:95]
    s_waitcnt vmcnt(3)
    s_barrier
    s_add_u32 m0, s46, 0x18000
    s_nop 0
    buffer_load_dwordx4 v195, s[28:31], s44 offen lds
    s_add_u32 m0, s46, 0x1a000
    s_nop 0
    buffer_load_dwordx4 v196, s[28:31], s44 offen lds
    s_add_u32 s44, s44, 128
    s_add_u32 m0, s46, 0x6000
    s_nop 0
    buffer_load_dwordx4 v192, s[32:35], s45 offen lds
    s_add_u32 m0, s46, 0x8000
    s_nop 0
    buffer_load_dwordx4 v193, s[40:43], s45 offen lds
    s_add_u32 m0, s46, 0xa000
    s_nop 0
    buffer_load_dwordx4 v194, s[36:39], s45 offen lds
    s_add_u32 s45, s45, 98304
    ds_read_b128 v[144:147], v198 offset:16384
    ds_read_b64_tr_b16 v[160:161], v200 offset:8192
    ds_read_b64_tr_b16 v[162:163], v200 offset:8704
    ds_read_b128 v[148:151], v198 offset:18432
    ds_read_b128 v[152:155], v198 offset:20480
    ds_read_b128 v[156:159], v198 offset:22528
    ds_read_b64_tr_b16 v[164:165], v202 offset:8192
    ds_read_b64_tr_b16 v[166:167], v202 offset:8704
    ds_read_b64_tr_b16 v[168:169], v204 offset:8192
    ds_read_b64_tr_b16 v[170:171], v204 offset:8704
    ds_read_b64_tr_b16 v[172:173], v200 offset:20480
    ds_read_b64_tr_b16 v[174:175], v200 offset:20992
    ds_read_b64_tr_b16 v[176:177], v202 offset:20480
    ds_read_b64_tr_b16 v[178:179], v202 offset:20992
    ds_read_b64_tr_b16 v[180:181], v204 offset:20480
    ds_read_b64_tr_b16 v[182:183], v204 offset:20992
    s_waitcnt lgkmcnt(15)
    v_mfma_f32_16x16x32_bf16 v[0:3], v[112:115], v[96:99], v[0:3]
    s_waitcnt lgkmcnt(15)
    v_mfma_f32_16x16x32_bf16 v[4:7], v[112:115], v[100:103], v[4:7]
    s_waitcnt lgkmcnt(15)
    v_mfma_f32_16x16x32_bf16 v[8:11], v[112:115], v[104:107], v[8:11]
    s_waitcnt lgkmcnt(15)
    v_mfma_f32_16x16x32_bf16 v[12:15], v[112:115], v[108:111], v[12:15]
    s_waitcnt lgkmcnt(15)
    v_mfma_f32_16x16x32_bf16 v[16:19], v[116:119], v[96:99], v[16:19]
    v_mfma_f32_16x16x32_bf16 v[20:23], v[116:119], v[100:103], v[20:23]
    v_mfma_f32_16x16x32_bf16 v[24:27], v[116:119], v[104:107], v[24:27]
    v_mfma_f32_16x16x32_bf16 v[28:31], v[116:119], v[108:111], v[28:31]
    s_waitcnt lgkmcnt(15)
    v_mfma_f32_16x16x32_bf16 v[32:35], v[120:123], v[96:99], v[32:35]
    v_mfma_f32_16x16x32_bf16 v[36:39], v[120:123], v[100:103], v[36:39]
    v_mfma_f32_16x16x32_bf16 v[40:43], v[120:123], v[104:107], v[40:43]
    v_mfma_f32_16x16x32_bf16 v[44:47], v[120:123], v[108:111], v[44:47]
    s_waitcnt lgkmcnt(15)
    v_mfma_f32_16x16x32_bf16 v[48:51], v[124:127], v[96:99], v[48:51]
    v_mfma_f32_16x16x32_bf16 v[52:55], v[124:127], v[100:103], v[52:55]
    v_mfma_f32_16x16x32_bf16 v[56:59], v[124:127], v[104:107], v[56:59]
    v_mfma_f32_16x16x32_bf16 v[60:63], v[124:127], v[108:111], v[60:63]
    s_waitcnt lgkmcnt(15)
    v_mfma_f32_16x16x32_bf16 v[64:67], v[128:131], v[96:99], v[64:67]
    v_mfma_f32_16x16x32_bf16 v[68:71], v[128:131], v[100:103], v[68:71]
    v_mfma_f32_16x16x32_bf16 v[72:75], v[128:131], v[104:107], v[72:75]
    v_mfma_f32_16x16x32_bf16 v[76:79], v[128:131], v[108:111], v[76:79]
    s_waitcnt lgkmcnt(15)
    v_mfma_f32_16x16x32_bf16 v[80:83], v[132:135], v[96:99], v[80:83]
    v_mfma_f32_16x16x32_bf16 v[84:87], v[132:135], v[100:103], v[84:87]
    v_mfma_f32_16x16x32_bf16 v[88:91], v[132:135], v[104:107], v[88:91]
    v_mfma_f32_16x16x32_bf16 v[92:95], v[132:135], v[108:111], v[92:95]
    s_waitcnt vmcnt(5)
    s_barrier
    s_add_u32 m0, s46, 0xc000
    s_nop 0
    buffer_load_dwordx4 v192, s[32:35], s45 offen lds
    s_add_u32 m0, s46, 0xe000
    s_nop 0
    buffer_load_dwordx4 v193, s[40:43], s45 offen lds
    s_add_u32 m0, s46, 0x10000
    s_nop 0
    buffer_load_dwordx4 v194, s[36:39], s45 offen lds
    s_add_u32 s45, s45, 98304
    ds_read_b128 v[96:99], v197 offset:32768
    ds_read_b64_tr_b16 v[112:113], v199 offset:0
    ds_read_b64_tr_b16 v[114:115], v199 offset:512
    ds_read_b128 v[100:103], v197 offset:34816
    ds_read_b128 v[104:107], v197 offset:36864
    ds_read_b128 v[108:111], v197 offset:38912
    ds_read_b64_tr_b16 v[116:117], v201 offset:0
    ds_read_b64_tr_b16 v[118:119], v201 offset:512
    ds_read_b64_tr_b16 v[120:121], v203 offset:0
    ds_read_b64_tr_b16 v[122:123], v203 offset:512
    ds_read_b64_tr_b16 v[124:125], v199 offset:12288
    ds_read_b64_tr_b16 v[126:127], v199 offset:12800
    ds_read_b64_tr_b16 v[128:129], v201 offset:12288
    ds_read_b64_tr_b16 v[130:131], v201 offset:12800
    ds_read_b64_tr_b16 v[132:133], v203 offset:12288
    ds_read_b64_tr_b16 v[134:135], v203 offset:12800
    s_waitcnt lgkmcnt(15)
    v_mfma_f32_16x16x32_bf16 v[0:3], v[160:163], v[144:147], v[0:3]
    s_waitcnt lgkmcnt(15)
    v_mfma_f32_16x16x32_bf16 v[4:7], v[160:163], v[148:151], v[4:7]
    s_waitcnt lgkmcnt(15)
    v_mfma_f32_16x16x32_bf16 v[8:11], v[160:163], v[152:155], v[8:11]
    s_waitcnt lgkmcnt(15)
    v_mfma_f32_16x16x32_bf16 v[12:15], v[160:163], v[156:159], v[12:15]
    s_waitcnt lgkmcnt(15)
    v_mfma_f32_16x16x32_bf16 v[16:19], v[164:167], v[144:147], v[16:19]
    v_mfma_f32_16x16x32_bf16 v[20:23], v[164:167], v[148:151], v[20:23]
    v_mfma_f32_16x16x32_bf16 v[24:27], v[164:167], v[152:155], v[24:27]
    v_mfma_f32_16x16x32_bf16 v[28:31], v[164:167], v[156:159], v[28:31]
    s_waitcnt lgkmcnt(15)
    v_mfma_f32_16x16x32_bf16 v[32:35], v[168:171], v[144:147], v[32:35]
    v_mfma_f32_16x16x32_bf16 v[36:39], v[168:171], v[148:151], v[36:39]
    v_mfma_f32_16x16x32_bf16 v[40:43], v[168:171], v[152:155], v[40:43]
    v_mfma_f32_16x16x32_bf16 v[44:47], v[168:171], v[156:159], v[44:47]
    s_waitcnt lgkmcnt(15)
    v_mfma_f32_16x16x32_bf16 v[48:51], v[172:175], v[144:147], v[48:51]
    v_mfma_f32_16x16x32_bf16 v[52:55], v[172:175], v[148:151], v[52:55]
    v_mfma_f32_16x16x32_bf16 v[56:59], v[172:175], v[152:155], v[56:59]
    v_mfma_f32_16x16x32_bf16 v[60:63], v[172:175], v[156:159], v[60:63]
    s_waitcnt lgkmcnt(15)
    v_mfma_f32_16x16x32_bf16 v[64:67], v[176:179], v[144:147], v[64:67]
    v_mfma_f32_16x16x32_bf16 v[68:71], v[176:179], v[148:151], v[68:71]
    v_mfma_f32_16x16x32_bf16 v[72:75], v[176:179], v[152:155], v[72:75]
    v_mfma_f32_16x16x32_bf16 v[76:79], v[176:179], v[156:159], v[76:79]
    s_waitcnt lgkmcnt(15)
    v_mfma_f32_16x16x32_bf16 v[80:83], v[180:183], v[144:147], v[80:83]
    v_mfma_f32_16x16x32_bf16 v[84:87], v[180:183], v[148:151], v[84:87]
    v_mfma_f32_16x16x32_bf16 v[88:91], v[180:183], v[152:155], v[88:91]
    v_mfma_f32_16x16x32_bf16 v[92:95], v[180:183], v[156:159], v[92:95]
    s_waitcnt vmcnt(3)
    s_barrier
    s_cmp_ge_u32 s2, 220
    s_cbranch_scc1 LGU_sig
    s_cmp_lg_u32 s47, 0
    s_cbranch_scc1 LGU_sig
    v_mov_b32 v210, 1
    v_mov_b32 v211, 0
    s_mov_b64 exec, 1
    buffer_atomic_add v210, v211, s[60:63], 0 offen sc1
    s_mov_b64 exec, -1
LGU_sig:
    s_add_u32 m0, s46, 0x1c000
    s_nop 0
    buffer_load_dwordx4 v195, s[28:31], s44 offen lds
    s_add_u32 m0, s46, 0x1e000
    s_nop 0
    buffer_load_dwordx4 v196, s[28:31], s44 offen lds
    s_add_u32 s44, s44, 128
    s_add_u32 m0, s46, 0x12000
    s_nop 0
    buffer_load_dwordx4 v192, s[32:35], s45 offen lds
    s_add_u32 m0, s46, 0x14000
    s_nop 0
    buffer_load_dwordx4 v193, s[40:43], s45 offen lds
    s_add_u32 m0, s46, 0x16000
    s_nop 0
    buffer_load_dwordx4 v194, s[36:39], s45 offen lds
    s_add_u32 s45, s45, 98304
    ds_read_b128 v[144:147], v198 offset:32768
    ds_read_b64_tr_b16 v[160:161], v199 offset:24576
    ds_read_b64_tr_b16 v[162:163], v199 offset:25088
    ds_read_b128 v[148:151], v198 offset:34816
    ds_read_b128 v[152:155], v198 offset:36864
    ds_read_b128 v[156:159], v198 offset:38912
    ds_read_b64_tr_b16 v[164:165], v201 offset:24576
    ds_read_b64_tr_b16 v[166:167], v201 offset:25088
    ds_read_b64_tr_b16 v[168:169], v203 offset:24576
    ds_read_b64_tr_b16 v[170:171], v203 offset:25088
    ds_read_b64_tr_b16 v[172:173], v199 offset:36864
    ds_read_b64_tr_b16 v[174:175], v199 offset:37376
    ds_read_b64_tr_b16 v[176:177], v201 offset:36864
    ds_read_b64_tr_b16 v[178:179], v201 offset:37376
    ds_read_b64_tr_b16 v[180:181], v203 offset:36864
    ds_read_b64_tr_b16 v[182:183], v203 offset:37376
    s_waitcnt lgkmcnt(15)
    v_mfma_f32_16x16x32_bf16 v[0:3], v[112:115], v[96:99], v[0:3]
    s_waitcnt lgkmcnt(15)
    v_mfma_f32_16x16x32_bf16 v[4:7], v[112:115], v[100:103], v[4:7]
    s_waitcnt lgkmcnt(15)
    v_mfma_f32_16x16x32_bf16 v[8:11], v[112:115], v[104:107], v[8:11]
    s_waitcnt lgkmcnt(15)
    v_mfma_f32_16x16x32_bf16 v[12:15], v[112:115], v[108:111], v[12:15]
    s_waitcnt lgkmcnt(15)
    v_mfma_f32_16x16x32_bf16 v[16:19], v[116:119], v[96:99], v[16:19]
    v_mfma_f32_16x16x32_bf16 v[20:23], v[116:119], v[100:103], v[20:23]
    v_mfma_f32_16x16x32_bf16 v[24:27], v[116:119], v[104:107], v[24:27]
    v_mfma_f32_16x16x32_bf16 v[28:31], v[116:119], v[108:111], v[28:31]
    s_waitcnt lgkmcnt(15)
    v_mfma_f32_16x16x32_bf16 v[32:35], v[120:123], v[96:99], v[32:35]
    v_mfma_f32_16x16x32_bf16 v[36:39], v[120:123], v[100:103], v[36:39]
    v_mfma_f32_16x16x32_bf16 v[40:43], v[120:123], v[104:107], v[40:43]
    v_mfma_f32_16x16x32_bf16 v[44:47], v[120:123], v[108:111], v[44:47]
    s_waitcnt lgkmcnt(15)
    v_mfma_f32_16x16x32_bf16 v[48:51], v[124:127], v[96:99], v[48:51]
    v_mfma_f32_16x16x32_bf16 v[52:55], v[124:127], v[100:103], v[52:55]
    v_mfma_f32_16x16x32_bf16 v[56:59], v[124:127], v[104:107], v[56:59]
    v_mfma_f32_16x16x32_bf16 v[60:63], v[124:127], v[108:111], v[60:63]
    s_waitcnt lgkmcnt(15)
    v_mfma_f32_16x16x32_bf16 v[64:67], v[128:131], v[96:99], v[64:67]
    v_mfma_f32_16x16x32_bf16 v[68:71], v[128:131], v[100:103], v[68:71]
    v_mfma_f32_16x16x32_bf16 v[72:75], v[128:131], v[104:107], v[72:75]
    v_mfma_f32_16x16x32_bf16 v[76:79], v[128:131], v[108:111], v[76:79]
    s_waitcnt lgkmcnt(15)
    v_mfma_f32_16x16x32_bf16 v[80:83], v[132:135], v[96:99], v[80:83]
    v_mfma_f32_16x16x32_bf16 v[84:87], v[132:135], v[100:103], v[84:87]
    v_mfma_f32_16x16x32_bf16 v[88:91], v[132:135], v[104:107], v[88:91]
    v_mfma_f32_16x16x32_bf16 v[92:95], v[132:135], v[108:111], v[92:95]
    s_waitcnt vmcnt(5)
    s_barrier
    s_add_u32 m0, s46, 0x0
    s_nop 0
    buffer_load_dwordx4 v192, s[32:35], s45 offen lds
    s_add_u32 m0, s46, 0x2000
    s_nop 0
    buffer_load_dwordx4 v193, s[40:43], s45 offen lds
    s_add_u32 m0, s46, 0x4000
    s_nop 0
    buffer_load_dwordx4 v194, s[36:39], s45 offen lds
    s_add_u32 s45, s45, 98304
    ds_read_b128 v[96:99], v197 offset:0
    ds_read_b64_tr_b16 v[112:113], v199 offset:49152
    ds_read_b64_tr_b16 v[114:115], v199 offset:49664
    ds_read_b128 v[100:103], v197 offset:2048
    ds_read_b128 v[104:107], v197 offset:4096
    ds_read_b128 v[108:111], v197 offset:6144
    ds_read_b64_tr_b16 v[116:117], v201 offset:49152
    ds_read_b64_tr_b16 v[118:119], v201 offset:49664
    ds_read_b64_tr_b16 v[120:121], v203 offset:49152
    ds_read_b64_tr_b16 v[122:123], v203 offset:49664
    ds_read_b64_tr_b16 v[124:125], v199 offset:61440
    ds_read_b64_tr_b16 v[126:127], v199 offset:61952
    ds_read_b64_tr_b16 v[128:129], v201 offset:61440
    ds_read_b64_tr_b16 v[130:131], v201 offset:61952
    ds_read_b64_tr_b16 v[132:133], v203 offset:61440
    ds_read_b64_tr_b16 v[134:135], v203 offset:61952
    s_waitcnt lgkmcnt(15)
    v_mfma_f32_16x16x32_bf16 v[0:3], v[160:163], v[144:147], v[0:3]
    s_waitcnt lgkmcnt(15)
    v_mfma_f32_16x16x32_bf16 v[4:7], v[160:163], v[148:151], v[4:7]
    s_waitcnt lgkmcnt(15)
    v_mfma_f32_16x16x32_bf16 v[8:11], v[160:163], v[152:155], v[8:11]
    s_waitcnt lgkmcnt(15)
    v_mfma_f32_16x16x32_bf16 v[12:15], v[160:163], v[156:159], v[12:15]
    s_waitcnt lgkmcnt(15)
    v_mfma_f32_16x16x32_bf16 v[16:19], v[164:167], v[144:147], v[16:19]
    v_mfma_f32_16x16x32_bf16 v[20:23], v[164:167], v[148:151], v[20:23]
    v_mfma_f32_16x16x32_bf16 v[24:27], v[164:167], v[152:155], v[24:27]
    v_mfma_f32_16x16x32_bf16 v[28:31], v[164:167], v[156:159], v[28:31]
    s_waitcnt lgkmcnt(15)
    v_mfma_f32_16x16x32_bf16 v[32:35], v[168:171], v[144:147], v[32:35]
    v_mfma_f32_16x16x32_bf16 v[36:39], v[168:171], v[148:151], v[36:39]
    v_mfma_f32_16x16x32_bf16 v[40:43], v[168:171], v[152:155], v[40:43]
    v_mfma_f32_16x16x32_bf16 v[44:47], v[168:171], v[156:159], v[44:47]
    s_waitcnt lgkmcnt(15)
    v_mfma_f32_16x16x32_bf16 v[48:51], v[172:175], v[144:147], v[48:51]
    v_mfma_f32_16x16x32_bf16 v[52:55], v[172:175], v[148:151], v[52:55]
    v_mfma_f32_16x16x32_bf16 v[56:59], v[172:175], v[152:155], v[56:59]
    v_mfma_f32_16x16x32_bf16 v[60:63], v[172:175], v[156:159], v[60:63]
    s_waitcnt lgkmcnt(15)
    v_mfma_f32_16x16x32_bf16 v[64:67], v[176:179], v[144:147], v[64:67]
    v_mfma_f32_16x16x32_bf16 v[68:71], v[176:179], v[148:151], v[68:71]
    v_mfma_f32_16x16x32_bf16 v[72:75], v[176:179], v[152:155], v[72:75]
    v_mfma_f32_16x16x32_bf16 v[76:79], v[176:179], v[156:159], v[76:79]
    s_waitcnt lgkmcnt(15)
    v_mfma_f32_16x16x32_bf16 v[80:83], v[180:183], v[144:147], v[80:83]
    v_mfma_f32_16x16x32_bf16 v[84:87], v[180:183], v[148:151], v[84:87]
    v_mfma_f32_16x16x32_bf16 v[88:91], v[180:183], v[152:155], v[88:91]
    v_mfma_f32_16x16x32_bf16 v[92:95], v[180:183], v[156:159], v[92:95]
    s_waitcnt vmcnt(3)
    s_barrier
    s_add_u32 m0, s46, 0x20000
    s_nop 0
    buffer_load_dwordx4 v195, s[28:31], s44 offen lds
    s_add_u32 m0, s46, 0x22000
    s_nop 0
    buffer_load_dwordx4 v196, s[28:31], s44 offen lds
    s_add_u32 s44, s44, 128
    s_add_u32 m0, s46, 0x6000
    s_nop 0
    buffer_load_dwordx4 v192, s[32:35], s45 offen lds
    s_add_u32 m0, s46, 0x8000
    s_nop 0
    buffer_load_dwordx4 v193, s[40:43], s45 offen lds
    s_add_u32 m0, s46, 0xa000
    s_nop 0
    buffer_load_dwordx4 v194, s[36:39], s45 offen lds
    s_add_u32 s45, s45, 98304
    ds_read_b128 v[144:147], v198 offset:0
    ds_read_b64_tr_b16 v[160:161], v200 offset:8192
    ds_read_b64_tr_b16 v[162:163], v200 offset:8704
    ds_read_b128 v[148:151], v198 offset:2048
    ds_read_b128 v[152:155], v198 offset:4096
    ds_read_b128 v[156:159], v198 offset:6144
    ds_read_b64_tr_b16 v[164:165], v202 offset:8192
    ds_read_b64_tr_b16 v[166:167], v202 offset:8704
    ds_read_b64_tr_b16 v[168:169], v204 offset:8192
    ds_read_b64_tr_b16 v[170:171], v204 offset:8704
    ds_read_b64_tr_b16 v[172:173], v200 offset:20480
    ds_read_b64_tr_b16 v[174:175], v200 offset:20992
    ds_read_b64_tr_b16 v[176:177], v202 offset:20480
    ds_read_b64_tr_b16 v[178:179], v202 offset:20992
    ds_read_b64_tr_b16 v[180:181], v204 offset:20480
    ds_read_b64_tr_b16 v[182:183], v204 offset:20992
    s_waitcnt lgkmcnt(15)
    v_mfma_f32_16x16x32_bf16 v[0:3], v[112:115], v[96:99], v[0:3]
    s_waitcnt lgkmcnt(15)
    v_mfma_f32_16x16x32_bf16 v[4:7], v[112:115], v[100:103], v[4:7]
    s_waitcnt lgkmcnt(15)
    v_mfma_f32_16x16x32_bf16 v[8:11], v[112:115], v[104:107], v[8:11]
    s_waitcnt lgkmcnt(15)
    v_mfma_f32_16x16x32_bf16 v[12:15], v[112:115], v[108:111], v[12:15]
    s_waitcnt lgkmcnt(15)
    v_mfma_f32_16x16x32_bf16 v[16:19], v[116:119], v[96:99], v[16:19]
    v_mfma_f32_16x16x32_bf16 v[20:23], v[116:119], v[100:103], v[20:23]
    v_mfma_f32_16x16x32_bf16 v[24:27], v[116:119], v[104:107], v[24:27]
    v_mfma_f32_16x16x32_bf16 v[28:31], v[116:119], v[108:111], v[28:31]
    s_waitcnt lgkmcnt(15)
    v_mfma_f32_16x16x32_bf16 v[32:35], v[120:123], v[96:99], v[32:35]
    v_mfma_f32_16x16x32_bf16 v[36:39], v[120:123], v[100:103], v[36:39]
    v_mfma_f32_16x16x32_bf16 v[40:43], v[120:123], v[104:107], v[40:43]
    v_mfma_f32_16x16x32_bf16 v[44:47], v[120:123], v[108:111], v[44:47]
    s_waitcnt lgkmcnt(15)
    v_mfma_f32_16x16x32_bf16 v[48:51], v[124:127], v[96:99], v[48:51]
    v_mfma_f32_16x16x32_bf16 v[52:55], v[124:127], v[100:103], v[52:55]
    v_mfma_f32_16x16x32_bf16 v[56:59], v[124:127], v[104:107], v[56:59]
    v_mfma_f32_16x16x32_bf16 v[60:63], v[124:127], v[108:111], v[60:63]
    s_waitcnt lgkmcnt(15)
    v_mfma_f32_16x16x32_bf16 v[64:67], v[128:131], v[96:99], v[64:67]
    v_mfma_f32_16x16x32_bf16 v[68:71], v[128:131], v[100:103], v[68:71]
    v_mfma_f32_16x16x32_bf16 v[72:75], v[128:131], v[104:107], v[72:75]
    v_mfma_f32_16x16x32_bf16 v[76:79], v[128:131], v[108:111], v[76:79]
    s_waitcnt lgkmcnt(15)
    v_mfma_f32_16x16x32_bf16 v[80:83], v[132:135], v[96:99], v[80:83]
    v_mfma_f32_16x16x32_bf16 v[84:87], v[132:135], v[100:103], v[84:87]
    v_mfma_f32_16x16x32_bf16 v[88:91], v[132:135], v[104:107], v[88:91]
    v_mfma_f32_16x16x32_bf16 v[92:95], v[132:135], v[108:111], v[92:95]
    s_waitcnt vmcnt(5)
    s_barrier
    s_add_u32 m0, s46, 0xc000
    s_nop 0
    buffer_load_dwordx4 v192, s[32:35], s45 offen lds
    s_add_u32 m0, s46, 0xe000
    s_nop 0
    buffer_load_dwordx4 v193, s[40:43], s45 offen lds
    s_add_u32 m0, s46, 0x10000
    s_nop 0
    buffer_load_dwordx4 v194, s[36:39], s45 offen lds
    s_add_u32 s45, s45, 98304
    ds_read_b128 v[96:99], v197 offset:16384
    ds_read_b64_tr_b16 v[112:113], v199 offset:0
    ds_read_b64_tr_b16 v[114:115], v199 offset:512
    ds_read_b128 v[100:103], v197 offset:18432
    ds_read_b128 v[104:107], v197 offset:20480
    ds_read_b128 v[108:111], v197 offset:22528
    ds_read_b64_tr_b16 v[116:117], v201 offset:0
    ds_read_b64_tr_b16 v[118:119], v201 offset:512
    ds_read_b64_tr_b16 v[120:121], v203 offset:0
    ds_read_b64_tr_b16 v[122:123], v203 offset:512
    ds_read_b64_tr_b16 v[124:125], v199 offset:12288
    ds_read_b64_tr_b16 v[126:127], v199 offset:12800
    ds_read_b64_tr_b16 v[128:129], v201 offset:12288
    ds_read_b64_tr_b16 v[130:131], v201 offset:12800
    ds_read_b64_tr_b16 v[132:133], v203 offset:12288
    ds_read_b64_tr_b16 v[134:135], v203 offset:12800
    s_waitcnt lgkmcnt(15)
    v_mfma_f32_16x16x32_bf16 v[0:3], v[160:163], v[144:147], v[0:3]
    s_waitcnt lgkmcnt(15)
    v_mfma_f32_16x16x32_bf16 v[4:7], v[160:163], v[148:151], v[4:7]
    s_waitcnt lgkmcnt(15)
    v_mfma_f32_16x16x32_bf16 v[8:11], v[160:163], v[152:155], v[8:11]
    s_waitcnt lgkmcnt(15)
    v_mfma_f32_16x16x32_bf16 v[12:15], v[160:163], v[156:159], v[12:15]
    s_waitcnt lgkmcnt(15)
    v_mfma_f32_16x16x32_bf16 v[16:19], v[164:167], v[144:147], v[16:19]
    v_mfma_f32_16x16x32_bf16 v[20:23], v[164:167], v[148:151], v[20:23]
    v_mfma_f32_16x16x32_bf16 v[24:27], v[164:167], v[152:155], v[24:27]
    v_mfma_f32_16x16x32_bf16 v[28:31], v[164:167], v[156:159], v[28:31]
    s_waitcnt lgkmcnt(15)
    v_mfma_f32_16x16x32_bf16 v[32:35], v[168:171], v[144:147], v[32:35]
    v_mfma_f32_16x16x32_bf16 v[36:39], v[168:171], v[148:151], v[36:39]
    v_mfma_f32_16x16x32_bf16 v[40:43], v[168:171], v[152:155], v[40:43]
    v_mfma_f32_16x16x32_bf16 v[44:47], v[168:171], v[156:159], v[44:47]
    s_waitcnt lgkmcnt(15)
    v_mfma_f32_16x16x32_bf16 v[48:51], v[172:175], v[144:147], v[48:51]
    v_mfma_f32_16x16x32_bf16 v[52:55], v[172:175], v[148:151], v[52:55]
    v_mfma_f32_16x16x32_bf16 v[56:59], v[172:175], v[152:155], v[56:59]
    v_mfma_f32_16x16x32_bf16 v[60:63], v[172:175], v[156:159], v[60:63]
    s_waitcnt lgkmcnt(15)
    v_mfma_f32_16x16x32_bf16 v[64:67], v[176:179], v[144:147], v[64:67]
    v_mfma_f32_16x16x32_bf16 v[68:71], v[176:179], v[148:151], v[68:71]
    v_mfma_f32_16x16x32_bf16 v[72:75], v[176:179], v[152:155], v[72:75]
    v_mfma_f32_16x16x32_bf16 v[76:79], v[176:179], v[156:159], v[76:79]
    s_waitcnt lgkmcnt(15)
    v_mfma_f32_16x16x32_bf16 v[80:83], v[180:183], v[144:147], v[80:83]
    v_mfma_f32_16x16x32_bf16 v[84:87], v[180:183], v[148:151], v[84:87]
    v_mfma_f32_16x16x32_bf16 v[88:91], v[180:183], v[152:155], v[88:91]
    v_mfma_f32_16x16x32_bf16 v[92:95], v[180:183], v[156:159], v[92:95]
    s_waitcnt vmcnt(3)
    s_barrier
    s_add_u32 m0, s46, 0x18000
    s_nop 0
    buffer_load_dwordx4 v195, s[28:31], s44 offen lds
    s_add_u32 m0, s46, 0x1a000
    s_nop 0
    buffer_load_dwordx4 v196, s[28:31], s44 offen lds
    s_add_u32 s44, s44, 128
    s_add_u32 m0, s46, 0x12000
    s_nop 0
    buffer_load_dwordx4 v192, s[32:35], s45 offen lds
    s_add_u32 m0, s46, 0x14000
    s_nop 0
    buffer_load_dwordx4 v193, s[40:43], s45 offen lds
    s_add_u32 m0, s46, 0x16000
    s_nop 0
    buffer_load_dwordx4 v194, s[36:39], s45 offen lds
    s_add_u32 s45, s45, 98304
    ds_read_b128 v[144:147], v198 offset:16384
    ds_read_b64_tr_b16 v[160:161], v199 offset:24576
    ds_read_b64_tr_b16 v[162:163], v199 offset:25088
    ds_read_b128 v[148:151], v198 offset:18432
    ds_read_b128 v[152:155], v198 offset:20480
    ds_read_b128 v[156:159], v198 offset:22528
    ds_read_b64_tr_b16 v[164:165], v201 offset:24576
    ds_read_b64_tr_b16 v[166:167], v201 offset:25088
    ds_read_b64_tr_b16 v[168:169], v203 offset:24576
    ds_read_b64_tr_b16 v[170:171], v203 offset:25088
    ds_read_b64_tr_b16 v[172:173], v199 offset:36864
    ds_read_b64_tr_b16 v[174:175], v199 offset:37376
    ds_read_b64_tr_b16 v[176:177], v201 offset:36864
    ds_read_b64_tr_b16 v[178:179], v201 offset:37376
    ds_read_b64_tr_b16 v[180:181], v203 offset:36864
    ds_read_b64_tr_b16 v[182:183], v203 offset:37376
    s_waitcnt lgkmcnt(15)
    v_mfma_f32_16x16x32_bf16 v[0:3], v[112:115], v[96:99], v[0:3]
    s_waitcnt lgkmcnt(15)
    v_mfma_f32_16x16x32_bf16 v[4:7], v[112:115], v[100:103], v[4:7]
    s_waitcnt lgkmcnt(15)
    v_mfma_f32_16x16x32_bf16 v[8:11], v[112:115], v[104:107], v[8:11]
    s_waitcnt lgkmcnt(15)
    v_mfma_f32_16x16x32_bf16 v[12:15], v[112:115], v[108:111], v[12:15]
    s_waitcnt lgkmcnt(15)
    v_mfma_f32_16x16x32_bf16 v[16:19], v[116:119], v[96:99], v[16:19]
    v_mfma_f32_16x16x32_bf16 v[20:23], v[116:119], v[100:103], v[20:23]
    v_mfma_f32_16x16x32_bf16 v[24:27], v[116:119], v[104:107], v[24:27]
    v_mfma_f32_16x16x32_bf16 v[28:31], v[116:119], v[108:111], v[28:31]
    s_waitcnt lgkmcnt(15)
    v_mfma_f32_16x16x32_bf16 v[32:35], v[120:123], v[96:99], v[32:35]
    v_mfma_f32_16x16x32_bf16 v[36:39], v[120:123], v[100:103], v[36:39]
    v_mfma_f32_16x16x32_bf16 v[40:43], v[120:123], v[104:107], v[40:43]
    v_mfma_f32_16x16x32_bf16 v[44:47], v[120:123], v[108:111], v[44:47]
    s_waitcnt lgkmcnt(15)
    v_mfma_f32_16x16x32_bf16 v[48:51], v[124:127], v[96:99], v[48:51]
    v_mfma_f32_16x16x32_bf16 v[52:55], v[124:127], v[100:103], v[52:55]
    v_mfma_f32_16x16x32_bf16 v[56:59], v[124:127], v[104:107], v[56:59]
    v_mfma_f32_16x16x32_bf16 v[60:63], v[124:127], v[108:111], v[60:63]
    s_waitcnt lgkmcnt(15)
    v_mfma_f32_16x16x32_bf16 v[64:67], v[128:131], v[96:99], v[64:67]
    v_mfma_f32_16x16x32_bf16 v[68:71], v[128:131], v[100:103], v[68:71]
    v_mfma_f32_16x16x32_bf16 v[72:75], v[128:131], v[104:107], v[72:75]
    v_mfma_f32_16x16x32_bf16 v[76:79], v[128:131], v[108:111], v[76:79]
    s_waitcnt lgkmcnt(15)
    v_mfma_f32_16x16x32_bf16 v[80:83], v[132:135], v[96:99], v[80:83]
    v_mfma_f32_16x16x32_bf16 v[84:87], v[132:135], v[100:103], v[84:87]
    v_mfma_f32_16x16x32_bf16 v[88:91], v[132:135], v[104:107], v[88:91]
    v_mfma_f32_16x16x32_bf16 v[92:95], v[132:135], v[108:111], v[92:95]
    s_waitcnt vmcnt(5)
    s_barrier
    s_add_u32 m0, s46, 0x0
    s_nop 0
    buffer_load_dwordx4 v192, s[32:35], s45 offen lds
    s_add_u32 m0, s46, 0x2000
    s_nop 0
    buffer_load_dwordx4 v193, s[40:43], s45 offen lds
    s_add_u32 m0, s46, 0x4000
    s_nop 0
    buffer_load_dwordx4 v194, s[36:39], s45 offen lds
    s_add_u32 s45, s45, 98304
    ds_read_b128 v[96:99], v197 offset:32768
    ds_read_b64_tr_b16 v[112:113], v199 offset:49152
    ds_read_b64_tr_b16 v[114:115], v199 offset:49664
    ds_read_b128 v[100:103], v197 offset:34816
    ds_read_b128 v[104:107], v197 offset:36864
    ds_read_b128 v[108:111], v197 offset:38912
    ds_read_b64_tr_b16 v[116:117], v201 offset:49152
    ds_read_b64_tr_b16 v[118:119], v201 offset:49664
    ds_read_b64_tr_b16 v[120:121], v203 offset:49152
    ds_read_b64_tr_b16 v[122:123], v203 offset:49664
    ds_read_b64_tr_b16 v[124:125], v199 offset:61440
    ds_read_b64_tr_b16 v[126:127], v199 offset:61952
    ds_read_b64_tr_b16 v[128:129], v201 offset:61440
    ds_read_b64_tr_b16 v[130:131], v201 offset:61952
    ds_read_b64_tr_b16 v[132:133], v203 offset:61440
    ds_read_b64_tr_b16 v[134:135], v203 offset:61952
    s_waitcnt lgkmcnt(15)
    v_mfma_f32_16x16x32_bf16 v[0:3], v[160:163], v[144:147], v[0:3]
    s_waitcnt lgkmcnt(15)
    v_mfma_f32_16x16x32_bf16 v[4:7], v[160:163], v[148:151], v[4:7]
    s_waitcnt lgkmcnt(15)
    v_mfma_f32_16x16x32_bf16 v[8:11], v[160:163], v[152:155], v[8:11]
    s_waitcnt lgkmcnt(15)
    v_mfma_f32_16x16x32_bf16 v[12:15], v[160:163], v[156:159], v[12:15]
    s_waitcnt lgkmcnt(15)
    v_mfma_f32_16x16x32_bf16 v[16:19], v[164:167], v[144:147], v[16:19]
    v_mfma_f32_16x16x32_bf16 v[20:23], v[164:167], v[148:151], v[20:23]
    v_mfma_f32_16x16x32_bf16 v[24:27], v[164:167], v[152:155], v[24:27]
    v_mfma_f32_16x16x32_bf16 v[28:31], v[164:167], v[156:159], v[28:31]
    s_waitcnt lgkmcnt(15)
    v_mfma_f32_16x16x32_bf16 v[32:35], v[168:171], v[144:147], v[32:35]
    v_mfma_f32_16x16x32_bf16 v[36:39], v[168:171], v[148:151], v[36:39]
    v_mfma_f32_16x16x32_bf16 v[40:43], v[168:171], v[152:155], v[40:43]
    v_mfma_f32_16x16x32_bf16 v[44:47], v[168:171], v[156:159], v[44:47]
    s_waitcnt lgkmcnt(15)
    v_mfma_f32_16x16x32_bf16 v[48:51], v[172:175], v[144:147], v[48:51]
    v_mfma_f32_16x16x32_bf16 v[52:55], v[172:175], v[148:151], v[52:55]
    v_mfma_f32_16x16x32_bf16 v[56:59], v[172:175], v[152:155], v[56:59]
    v_mfma_f32_16x16x32_bf16 v[60:63], v[172:175], v[156:159], v[60:63]
    s_waitcnt lgkmcnt(15)
    v_mfma_f32_16x16x32_bf16 v[64:67], v[176:179], v[144:147], v[64:67]
    v_mfma_f32_16x16x32_bf16 v[68:71], v[176:179], v[148:151], v[68:71]
    v_mfma_f32_16x16x32_bf16 v[72:75], v[176:179], v[152:155], v[72:75]
    v_mfma_f32_16x16x32_bf16 v[76:79], v[176:179], v[156:159], v[76:79]
    s_waitcnt lgkmcnt(15)
    v_mfma_f32_16x16x32_bf16 v[80:83], v[180:183], v[144:147], v[80:83]
    v_mfma_f32_16x16x32_bf16 v[84:87], v[180:183], v[148:151], v[84:87]
    v_mfma_f32_16x16x32_bf16 v[88:91], v[180:183], v[152:155], v[88:91]
    v_mfma_f32_16x16x32_bf16 v[92:95], v[180:183], v[156:159], v[92:95]
    s_waitcnt vmcnt(3)
    s_barrier
    s_add_u32 m0, s46, 0x1c000
    s_nop 0
    buffer_load_dwordx4 v195, s[28:31], s44 offen lds
    s_add_u32 m0, s46, 0x1e000
    s_nop 0
    buffer_load_dwordx4 v196, s[28:31], s44 offen lds
    s_add_u32 s44, s44, 128
    s_add_u32 m0, s46, 0x6000
    s_nop 0
    buffer_load_dwordx4 v192, s[32:35], s45 offen lds
    s_add_u32 m0, s46, 0x8000
    s_nop 0
    buffer_load_dwordx4 v193, s[40:43], s45 offen lds
    s_add_u32 m0, s46, 0xa000
    s_nop 0
    buffer_load_dwordx4 v194, s[36:39], s45 offen lds
    s_add_u32 s45, s45, 98304
    ds_read_b128 v[144:147], v198 offset:32768
    ds_read_b64_tr_b16 v[160:161], v200 offset:8192
    ds_read_b64_tr_b16 v[162:163], v200 offset:8704
    ds_read_b128 v[148:151], v198 offset:34816
    ds_read_b128 v[152:155], v198 offset:36864
    ds_read_b128 v[156:159], v198 offset:38912
    ds_read_b64_tr_b16 v[164:165], v202 offset:8192
    ds_read_b64_tr_b16 v[166:167], v202 offset:8704
    ds_read_b64_tr_b16 v[168:169], v204 offset:8192
    ds_read_b64_tr_b16 v[170:171], v204 offset:8704
    ds_read_b64_tr_b16 v[172:173], v200 offset:20480
    ds_read_b64_tr_b16 v[174:175], v200 offset:20992
    ds_read_b64_tr_b16 v[176:177], v202 offset:20480
    ds_read_b64_tr_b16 v[178:179], v202 offset:20992
    ds_read_b64_tr_b16 v[180:181], v204 offset:20480
    ds_read_b64_tr_b16 v[182:183], v204 offset:20992
    s_waitcnt lgkmcnt(15)
    v_mfma_f32_16x16x32_bf16 v[0:3], v[112:115], v[96:99], v[0:3]
    s_waitcnt lgkmcnt(15)
    v_mfma_f32_16x16x32_bf16 v[4:7], v[112:115], v[100:103], v[4:7]
    s_waitcnt lgkmcnt(15)
    v_mfma_f32_16x16x32_bf16 v[8:11], v[112:115], v[104:107], v[8:11]
    s_waitcnt lgkmcnt(15)
    v_mfma_f32_16x16x32_bf16 v[12:15], v[112:115], v[108:111], v[12:15]
    s_waitcnt lgkmcnt(15)
    v_mfma_f32_16x16x32_bf16 v[16:19], v[116:119], v[96:99], v[16:19]
    v_mfma_f32_16x16x32_bf16 v[20:23], v[116:119], v[100:103], v[20:23]
    v_mfma_f32_16x16x32_bf16 v[24:27], v[116:119], v[104:107], v[24:27]
    v_mfma_f32_16x16x32_bf16 v[28:31], v[116:119], v[108:111], v[28:31]
    s_waitcnt lgkmcnt(15)
    v_mfma_f32_16x16x32_bf16 v[32:35], v[120:123], v[96:99], v[32:35]
    v_mfma_f32_16x16x32_bf16 v[36:39], v[120:123], v[100:103], v[36:39]
    v_mfma_f32_16x16x32_bf16 v[40:43], v[120:123], v[104:107], v[40:43]
    v_mfma_f32_16x16x32_bf16 v[44:47], v[120:123], v[108:111], v[44:47]
    s_waitcnt lgkmcnt(15)
    v_mfma_f32_16x16x32_bf16 v[48:51], v[124:127], v[96:99], v[48:51]
    v_mfma_f32_16x16x32_bf16 v[52:55], v[124:127], v[100:103], v[52:55]
    v_mfma_f32_16x16x32_bf16 v[56:59], v[124:127], v[104:107], v[56:59]
    v_mfma_f32_16x16x32_bf16 v[60:63], v[124:127], v[108:111], v[60:63]
    s_waitcnt lgkmcnt(15)
    v_mfma_f32_16x16x32_bf16 v[64:67], v[128:131], v[96:99], v[64:67]
    v_mfma_f32_16x16x32_bf16 v[68:71], v[128:131], v[100:103], v[68:71]
    v_mfma_f32_16x16x32_bf16 v[72:75], v[128:131], v[104:107], v[72:75]
    v_mfma_f32_16x16x32_bf16 v[76:79], v[128:131], v[108:111], v[76:79]
    s_waitcnt lgkmcnt(15)
    v_mfma_f32_16x16x32_bf16 v[80:83], v[132:135], v[96:99], v[80:83]
    v_mfma_f32_16x16x32_bf16 v[84:87], v[132:135], v[100:103], v[84:87]
    v_mfma_f32_16x16x32_bf16 v[88:91], v[132:135], v[104:107], v[88:91]
    v_mfma_f32_16x16x32_bf16 v[92:95], v[132:135], v[108:111], v[92:95]
    s_waitcnt vmcnt(5)
    s_barrier
    s_add_u32 m0, s46, 0xc000
    s_nop 0
    buffer_load_dwordx4 v192, s[32:35], s45 offen lds
    s_add_u32 m0, s46, 0xe000
    s_nop 0
    buffer_load_dwordx4 v193, s[40:43], s45 offen lds
    s_add_u32 m0, s46, 0x10000
    s_nop 0
    buffer_load_dwordx4 v194, s[36:39], s45 offen lds
    s_add_u32 s45, s45, 98304
    ds_read_b128 v[96:99], v197 offset:0
    ds_read_b64_tr_b16 v[112:113], v199 offset:0
    ds_read_b64_tr_b16 v[114:115], v199 offset:512
    ds_read_b128 v[100:103], v197 offset:2048
    ds_read_b128 v[104:107], v197 offset:4096
    ds_read_b128 v[108:111], v197 offset:6144
    ds_read_b64_tr_b16 v[116:117], v201 offset:0
    ds_read_b64_tr_b16 v[118:119], v201 offset:512
    ds_read_b64_tr_b16 v[120:121], v203 offset:0
    ds_read_b64_tr_b16 v[122:123], v203 offset:512
    ds_read_b64_tr_b16 v[124:125], v199 offset:12288
    ds_read_b64_tr_b16 v[126:127], v199 offset:12800
    ds_read_b64_tr_b16 v[128:129], v201 offset:12288
    ds_read_b64_tr_b16 v[130:131], v201 offset:12800
    ds_read_b64_tr_b16 v[132:133], v203 offset:12288
    ds_read_b64_tr_b16 v[134:135], v203 offset:12800
    s_waitcnt lgkmcnt(15)
    v_mfma_f32_16x16x32_bf16 v[0:3], v[160:163], v[144:147], v[0:3]
    s_waitcnt lgkmcnt(15)
    v_mfma_f32_16x16x32_bf16 v[4:7], v[160:163], v[148:151], v[4:7]
    s_waitcnt lgkmcnt(15)
    v_mfma_f32_16x16x32_bf16 v[8:11], v[160:163], v[152:155], v[8:11]
    s_waitcnt lgkmcnt(15)
    v_mfma_f32_16x16x32_bf16 v[12:15], v[160:163], v[156:159], v[12:15]
    s_waitcnt lgkmcnt(15)
    v_mfma_f32_16x16x32_bf16 v[16:19], v[164:167], v[144:147], v[16:19]
    v_mfma_f32_16x16x32_bf16 v[20:23], v[164:167], v[148:151], v[20:23]
    v_mfma_f32_16x16x32_bf16 v[24:27], v[164:167], v[152:155], v[24:27]
    v_mfma_f32_16x16x32_bf16 v[28:31], v[164:167], v[156:159], v[28:31]
    s_waitcnt lgkmcnt(15)
    v_mfma_f32_16x16x32_bf16 v[32:35], v[168:171], v[144:147], v[32:35]
    v_mfma_f32_16x16x32_bf16 v[36:39], v[168:171], v[148:151], v[36:39]
    v_mfma_f32_16x16x32_bf16 v[40:43], v[168:171], v[152:155], v[40:43]
    v_mfma_f32_16x16x32_bf16 v[44:47], v[168:171], v[156:159], v[44:47]
    s_waitcnt lgkmcnt(15)
    v_mfma_f32_16x16x32_bf16 v[48:51], v[172:175], v[144:147], v[48:51]
    v_mfma_f32_16x16x32_bf16 v[52:55], v[172:175], v[148:151], v[52:55]
    v_mfma_f32_16x16x32_bf16 v[56:59], v[172:175], v[152:155], v[56:59]
    v_mfma_f32_16x16x32_bf16 v[60:63], v[172:175], v[156:159], v[60:63]
    s_waitcnt lgkmcnt(15)
    v_mfma_f32_16x16x32_bf16 v[64:67], v[176:179], v[144:147], v[64:67]
    v_mfma_f32_16x16x32_bf16 v[68:71], v[176:179], v[148:151], v[68:71]
    v_mfma_f32_16x16x32_bf16 v[72:75], v[176:179], v[152:155], v[72:75]
    v_mfma_f32_16x16x32_bf16 v[76:79], v[176:179], v[156:159], v[76:79]
    s_waitcnt lgkmcnt(15)
    v_mfma_f32_16x16x32_bf16 v[80:83], v[180:183], v[144:147], v[80:83]
    v_mfma_f32_16x16x32_bf16 v[84:87], v[180:183], v[148:151], v[84:87]
    v_mfma_f32_16x16x32_bf16 v[88:91], v[180:183], v[152:155], v[88:91]
    v_mfma_f32_16x16x32_bf16 v[92:95], v[180:183], v[156:159], v[92:95]
    s_waitcnt vmcnt(3)
    s_barrier
    s_add_u32 m0, s46, 0x20000
    s_nop 0
    buffer_load_dwordx4 v195, s[28:31], s44 offen lds
    s_add_u32 m0, s46, 0x22000
    s_nop 0
    buffer_load_dwordx4 v196, s[28:31], s44 offen lds
    s_add_u32 s44, s44, 128
    s_add_u32 m0, s46, 0x12000
    s_nop 0
    buffer_load_dwordx4 v192, s[32:35], s45 offen lds
    s_add_u32 m0, s46, 0x14000
    s_nop 0
    buffer_load_dwordx4 v193, s[40:43], s45 offen lds
    s_add_u32 m0, s46, 0x16000
    s_nop 0
    buffer_load_dwordx4 v194, s[36:39], s45 offen lds
    s_add_u32 s45, s45, 98304
    ds_read_b128 v[144:147], v198 offset:0
    ds_read_b64_tr_b16 v[160:161], v199 offset:24576
    ds_read_b64_tr_b16 v[162:163], v199 offset:25088
    ds_read_b128 v[148:151], v198 offset:2048
    ds_read_b128 v[152:155], v198 offset:4096
    ds_read_b128 v[156:159], v198 offset:6144
    ds_read_b64_tr_b16 v[164:165], v201 offset:24576
    ds_read_b64_tr_b16 v[166:167], v201 offset:25088
    ds_read_b64_tr_b16 v[168:169], v203 offset:24576
    ds_read_b64_tr_b16 v[170:171], v203 offset:25088
    ds_read_b64_tr_b16 v[172:173], v199 offset:36864
    ds_read_b64_tr_b16 v[174:175], v199 offset:37376
    ds_read_b64_tr_b16 v[176:177], v201 offset:36864
    ds_read_b64_tr_b16 v[178:179], v201 offset:37376
    ds_read_b64_tr_b16 v[180:181], v203 offset:36864
    ds_read_b64_tr_b16 v[182:183], v203 offset:37376
    s_waitcnt lgkmcnt(15)
    v_mfma_f32_16x16x32_bf16 v[0:3], v[112:115], v[96:99], v[0:3]
    s_waitcnt lgkmcnt(15)
    v_mfma_f32_16x16x32_bf16 v[4:7], v[112:115], v[100:103], v[4:7]
    s_waitcnt lgkmcnt(15)
    v_mfma_f32_16x16x32_bf16 v[8:11], v[112:115], v[104:107], v[8:11]
    s_waitcnt lgkmcnt(15)
    v_mfma_f32_16x16x32_bf16 v[12:15], v[112:115], v[108:111], v[12:15]
    s_waitcnt lgkmcnt(15)
    v_mfma_f32_16x16x32_bf16 v[16:19], v[116:119], v[96:99], v[16:19]
    v_mfma_f32_16x16x32_bf16 v[20:23], v[116:119], v[100:103], v[20:23]
    v_mfma_f32_16x16x32_bf16 v[24:27], v[116:119], v[104:107], v[24:27]
    v_mfma_f32_16x16x32_bf16 v[28:31], v[116:119], v[108:111], v[28:31]
    s_waitcnt lgkmcnt(15)
    v_mfma_f32_16x16x32_bf16 v[32:35], v[120:123], v[96:99], v[32:35]
    v_mfma_f32_16x16x32_bf16 v[36:39], v[120:123], v[100:103], v[36:39]
    v_mfma_f32_16x16x32_bf16 v[40:43], v[120:123], v[104:107], v[40:43]
    v_mfma_f32_16x16x32_bf16 v[44:47], v[120:123], v[108:111], v[44:47]
    s_waitcnt lgkmcnt(15)
    v_mfma_f32_16x16x32_bf16 v[48:51], v[124:127], v[96:99], v[48:51]
    v_mfma_f32_16x16x32_bf16 v[52:55], v[124:127], v[100:103], v[52:55]
    v_mfma_f32_16x16x32_bf16 v[56:59], v[124:127], v[104:107], v[56:59]
    v_mfma_f32_16x16x32_bf16 v[60:63], v[124:127], v[108:111], v[60:63]
    s_waitcnt lgkmcnt(15)
    v_mfma_f32_16x16x32_bf16 v[64:67], v[128:131], v[96:99], v[64:67]
    v_mfma_f32_16x16x32_bf16 v[68:71], v[128:131], v[100:103], v[68:71]
    v_mfma_f32_16x16x32_bf16 v[72:75], v[128:131], v[104:107], v[72:75]
    v_mfma_f32_16x16x32_bf16 v[76:79], v[128:131], v[108:111], v[76:79]
    s_waitcnt lgkmcnt(15)
    v_mfma_f32_16x16x32_bf16 v[80:83], v[132:135], v[96:99], v[80:83]
    v_mfma_f32_16x16x32_bf16 v[84:87], v[132:135], v[100:103], v[84:87]
    v_mfma_f32_16x16x32_bf16 v[88:91], v[132:135], v[104:107], v[88:91]
    v_mfma_f32_16x16x32_bf16 v[92:95], v[132:135], v[108:111], v[92:95]
    s_waitcnt vmcnt(5)
    s_barrier
    s_add_u32 m0, s46, 0x0
    s_nop 0
    buffer_load_dwordx4 v192, s[32:35], s45 offen lds
    s_add_u32 m0, s46, 0x2000
    s_nop 0
    buffer_load_dwordx4 v193, s[40:43], s45 offen lds
    s_add_u32 m0, s46, 0x4000
    s_nop 0
    buffer_load_dwordx4 v194, s[36:39], s45 offen lds
    s_add_u32 s45, s45, 98304
    ds_read_b128 v[96:99], v197 offset:16384
    ds_read_b64_tr_b16 v[112:113], v199 offset:49152
    ds_read_b64_tr_b16 v[114:115], v199 offset:49664
    ds_read_b128 v[100:103], v197 offset:18432
    ds_read_b128 v[104:107], v197 offset:20480
    ds_read_b128 v[108:111], v197 offset:22528
    ds_read_b64_tr_b16 v[116:117], v201 offset:49152
    ds_read_b64_tr_b16 v[118:119], v201 offset:49664
    ds_read_b64_tr_b16 v[120:121], v203 offset:49152
    ds_read_b64_tr_b16 v[122:123], v203 offset:49664
    ds_read_b64_tr_b16 v[124:125], v199 offset:61440
    ds_read_b64_tr_b16 v[126:127], v199 offset:61952
    ds_read_b64_tr_b16 v[128:129], v201 offset:61440
    ds_read_b64_tr_b16 v[130:131], v201 offset:61952
    ds_read_b64_tr_b16 v[132:133], v203 offset:61440
    ds_read_b64_tr_b16 v[134:135], v203 offset:61952
    s_waitcnt lgkmcnt(15)
    v_mfma_f32_16x16x32_bf16 v[0:3], v[160:163], v[144:147], v[0:3]
    s_waitcnt lgkmcnt(15)
    v_mfma_f32_16x16x32_bf16 v[4:7], v[160:163], v[148:151], v[4:7]
    s_waitcnt lgkmcnt(15)
    v_mfma_f32_16x16x32_bf16 v[8:11], v[160:163], v[152:155], v[8:11]
    s_waitcnt lgkmcnt(15)
    v_mfma_f32_16x16x32_bf16 v[12:15], v[160:163], v[156:159], v[12:15]
    s_waitcnt lgkmcnt(15)
    v_mfma_f32_16x16x32_bf16 v[16:19], v[164:167], v[144:147], v[16:19]
    v_mfma_f32_16x16x32_bf16 v[20:23], v[164:167], v[148:151], v[20:23]
    v_mfma_f32_16x16x32_bf16 v[24:27], v[164:167], v[152:155], v[24:27]
    v_mfma_f32_16x16x32_bf16 v[28:31], v[164:167], v[156:159], v[28:31]
    s_waitcnt lgkmcnt(15)
    v_mfma_f32_16x16x32_bf16 v[32:35], v[168:171], v[144:147], v[32:35]
    v_mfma_f32_16x16x32_bf16 v[36:39], v[168:171], v[148:151], v[36:39]
    v_mfma_f32_16x16x32_bf16 v[40:43], v[168:171], v[152:155], v[40:43]
    v_mfma_f32_16x16x32_bf16 v[44:47], v[168:171], v[156:159], v[44:47]
    s_waitcnt lgkmcnt(15)
    v_mfma_f32_16x16x32_bf16 v[48:51], v[172:175], v[144:147], v[48:51]
    v_mfma_f32_16x16x32_bf16 v[52:55], v[172:175], v[148:151], v[52:55]
    v_mfma_f32_16x16x32_bf16 v[56:59], v[172:175], v[152:155], v[56:59]
    v_mfma_f32_16x16x32_bf16 v[60:63], v[172:175], v[156:159], v[60:63]
    s_waitcnt lgkmcnt(15)
    v_mfma_f32_16x16x32_bf16 v[64:67], v[176:179], v[144:147], v[64:67]
    v_mfma_f32_16x16x32_bf16 v[68:71], v[176:179], v[148:151], v[68:71]
    v_mfma_f32_16x16x32_bf16 v[72:75], v[176:179], v[152:155], v[72:75]
    v_mfma_f32_16x16x32_bf16 v[76:79], v[176:179], v[156:159], v[76:79]
    s_waitcnt lgkmcnt(15)
    v_mfma_f32_16x16x32_bf16 v[80:83], v[180:183], v[144:147], v[80:83]
    v_mfma_f32_16x16x32_bf16 v[84:87], v[180:183], v[148:151], v[84:87]
    v_mfma_f32_16x16x32_bf16 v[88:91], v[180:183], v[152:155], v[88:91]
    v_mfma_f32_16x16x32_bf16 v[92:95], v[180:183], v[156:159], v[92:95]
    s_waitcnt vmcnt(3)
    s_barrier
    s_add_u32 m0, s46, 0x18000
    s_nop 0
    buffer_load_dwordx4 v195, s[28:31], s44 offen lds
    s_add_u32 m0, s46, 0x1a000
    s_nop 0
    buffer_load_dwordx4 v196, s[28:31], s44 offen lds
    s_add_u32 s44, s44, 128
    s_add_u32 m0, s46, 0x6000
    s_nop 0
    buffer_load_dwordx4 v192, s[32:35], s45 offen lds
    s_add_u32 m0, s46, 0x8000
    s_nop 0
    buffer_load_dwordx4 v193, s[40:43], s45 offen lds
    s_add_u32 m0, s46, 0xa000
    s_nop 0
    buffer_load_dwordx4 v194, s[36:39], s45 offen lds
    s_add_u32 s45, s45, 98304
    ds_read_b128 v[144:147], v198 offset:16384
    ds_read_b64_tr_b16 v[160:161], v200 offset:8192
    ds_read_b64_tr_b16 v[162:163], v200 offset:8704
    ds_read_b128 v[148:151], v198 offset:18432
    ds_read_b128 v[152:155], v198 offset:20480
    ds_read_b128 v[156:159], v198 offset:22528
    ds_read_b64_tr_b16 v[164:165], v202 offset:8192
    ds_read_b64_tr_b16 v[166:167], v202 offset:8704
    ds_read_b64_tr_b16 v[168:169], v204 offset:8192
    ds_read_b64_tr_b16 v[170:171], v204 offset:8704
    ds_read_b64_tr_b16 v[172:173], v200 offset:20480
    ds_read_b64_tr_b16 v[174:175], v200 offset:20992
    ds_read_b64_tr_b16 v[176:177], v202 offset:20480
    ds_read_b64_tr_b16 v[178:179], v202 offset:20992
    ds_read_b64_tr_b16 v[180:181], v204 offset:20480
    ds_read_b64_tr_b16 v[182:183], v204 offset:20992
    s_waitcnt lgkmcnt(15)
    v_mfma_f32_16x16x32_bf16 v[0:3], v[112:115], v[96:99], v[0:3]
    s_waitcnt lgkmcnt(15)
    v_mfma_f32_16x16x32_bf16 v[4:7], v[112:115], v[100:103], v[4:7]
    s_waitcnt lgkmcnt(15)
    v_mfma_f32_16x16x32_bf16 v[8:11], v[112:115], v[104:107], v[8:11]
    s_waitcnt lgkmcnt(15)
    v_mfma_f32_16x16x32_bf16 v[12:15], v[112:115], v[108:111], v[12:15]
    s_waitcnt lgkmcnt(15)
    v_mfma_f32_16x16x32_bf16 v[16:19], v[116:119], v[96:99], v[16:19]
    v_mfma_f32_16x16x32_bf16 v[20:23], v[116:119], v[100:103], v[20:23]
    v_mfma_f32_16x16x32_bf16 v[24:27], v[116:119], v[104:107], v[24:27]
    v_mfma_f32_16x16x32_bf16 v[28:31], v[116:119], v[108:111], v[28:31]
    s_waitcnt lgkmcnt(15)
    v_mfma_f32_16x16x32_bf16 v[32:35], v[120:123], v[96:99], v[32:35]
    v_mfma_f32_16x16x32_bf16 v[36:39], v[120:123], v[100:103], v[36:39]
    v_mfma_f32_16x16x32_bf16 v[40:43], v[120:123], v[104:107], v[40:43]
    v_mfma_f32_16x16x32_bf16 v[44:47], v[120:123], v[108:111], v[44:47]
    s_waitcnt lgkmcnt(15)
    v_mfma_f32_16x16x32_bf16 v[48:51], v[124:127], v[96:99], v[48:51]
    v_mfma_f32_16x16x32_bf16 v[52:55], v[124:127], v[100:103], v[52:55]
    v_mfma_f32_16x16x32_bf16 v[56:59], v[124:127], v[104:107], v[56:59]
    v_mfma_f32_16x16x32_bf16 v[60:63], v[124:127], v[108:111], v[60:63]
    s_waitcnt lgkmcnt(15)
    v_mfma_f32_16x16x32_bf16 v[64:67], v[128:131], v[96:99], v[64:67]
    v_mfma_f32_16x16x32_bf16 v[68:71], v[128:131], v[100:103], v[68:71]
    v_mfma_f32_16x16x32_bf16 v[72:75], v[128:131], v[104:107], v[72:75]
    v_mfma_f32_16x16x32_bf16 v[76:79], v[128:131], v[108:111], v[76:79]
    s_waitcnt lgkmcnt(15)
    v_mfma_f32_16x16x32_bf16 v[80:83], v[132:135], v[96:99], v[80:83]
    v_mfma_f32_16x16x32_bf16 v[84:87], v[132:135], v[100:103], v[84:87]
    v_mfma_f32_16x16x32_bf16 v[88:91], v[132:135], v[104:107], v[88:91]
    v_mfma_f32_16x16x32_bf16 v[92:95], v[132:135], v[108:111], v[92:95]
    s_waitcnt vmcnt(5)
    s_barrier
    s_add_u32 m0, s46, 0xc000
    s_nop 0
    buffer_load_dwordx4 v192, s[32:35], s45 offen lds
    s_add_u32 m0, s46, 0xe000
    s_nop 0
    buffer_load_dwordx4 v193, s[40:43], s45 offen lds
    s_add_u32 m0, s46, 0x10000
    s_nop 0
    buffer_load_dwordx4 v194, s[36:39], s45 offen lds
    s_add_u32 s45, s45, 98304
    v_mov_b32 v210, 0
    buffer_load_dword v211, v210, s[60:63], 0 offen sc1
    ds_read_b128 v[96:99], v197 offset:32768
    ds_read_b64_tr_b16 v[112:113], v199 offset:0
    ds_read_b64_tr_b16 v[114:115], v199 offset:512
    ds_read_b128 v[100:103], v197 offset:34816
    ds_read_b128 v[104:107], v197 offset:36864
    ds_read_b128 v[108:111], v197 offset:38912
    ds_read_b64_tr_b16 v[116:117], v201 offset:0
    ds_read_b64_tr_b16 v[118:119], v201 offset:512
    ds_read_b64_tr_b16 v[120:121], v203 offset:0
    ds_read_b64_tr_b16 v[122:123], v203 offset:512
    ds_read_b64_tr_b16 v[124:125], v199 offset:12288
    ds_read_b64_tr_b16 v[126:127], v199 offset:12800
    ds_read_b64_tr_b16 v[128:129], v201 offset:12288
    ds_read_b64_tr_b16 v[130:131], v201 offset:12800
    ds_read_b64_tr_b16 v[132:133], v203 offset:12288
    ds_read_b64_tr_b16 v[134:135], v203 offset:12800
    s_waitcnt lgkmcnt(15)
    v_mfma_f32_16x16x32_bf16 v[0:3], v[160:163], v[144:147], v[0:3]
    s_waitcnt lgkmcnt(15)
    v_mfma_f32_16x16x32_bf16 v[4:7], v[160:163], v[148:151], v[4:7]
    s_waitcnt lgkmcnt(15)
    v_mfma_f32_16x16x32_bf16 v[8:11], v[160:163], v[152:155], v[8:11]
    s_waitcnt lgkmcnt(15)
    v_mfma_f32_16x16x32_bf16 v[12:15], v[160:163], v[156:159], v[12:15]
    s_waitcnt lgkmcnt(15)
    v_mfma_f32_16x16x32_bf16 v[16:19], v[164:167], v[144:147], v[16:19]
    v_mfma_f32_16x16x32_bf16 v[20:23], v[164:167], v[148:151], v[20:23]
    v_mfma_f32_16x16x32_bf16 v[24:27], v[164:167], v[152:155], v[24:27]
    v_mfma_f32_16x16x32_bf16 v[28:31], v[164:167], v[156:159], v[28:31]
    s_waitcnt lgkmcnt(15)
    v_mfma_f32_16x16x32_bf16 v[32:35], v[168:171], v[144:147], v[32:35]
    v_mfma_f32_16x16x32_bf16 v[36:39], v[168:171], v[148:151], v[36:39]
    v_mfma_f32_16x16x32_bf16 v[40:43], v[168:171], v[152:155], v[40:43]
    v_mfma_f32_16x16x32_bf16 v[44:47], v[168:171], v[156:159], v[44:47]
    s_waitcnt lgkmcnt(15)
    v_mfma_f32_16x16x32_bf16 v[48:51], v[172:175], v[144:147], v[48:51]
    v_mfma_f32_16x16x32_bf16 v[52:55], v[172:175], v[148:151], v[52:55]
    v_mfma_f32_16x16x32_bf16 v[56:59], v[172:175], v[152:155], v[56:59]
    v_mfma_f32_16x16x32_bf16 v[60:63], v[172:175], v[156:159], v[60:63]
    s_waitcnt lgkmcnt(15)
    v_mfma_f32_16x16x32_bf16 v[64:67], v[176:179], v[144:147], v[64:67]
    v_mfma_f32_16x16x32_bf16 v[68:71], v[176:179], v[148:151], v[68:71]
    v_mfma_f32_16x16x32_bf16 v[72:75], v[176:179], v[152:155], v[72:75]
    v_mfma_f32_16x16x32_bf16 v[76:79], v[176:179], v[156:159], v[76:79]
    s_waitcnt lgkmcnt(15)
    v_mfma_f32_16x16x32_bf16 v[80:83], v[180:183], v[144:147], v[80:83]
    v_mfma_f32_16x16x32_bf16 v[84:87], v[180:183], v[148:151], v[84:87]
    v_mfma_f32_16x16x32_bf16 v[88:91], v[180:183], v[152:155], v[88:91]
    v_mfma_f32_16x16x32_bf16 v[92:95], v[180:183], v[156:159], v[92:95]
    s_waitcnt vmcnt(4)
    s_barrier
    s_add_u32 m0, s46, 0x12000
    s_nop 0
    buffer_load_dwordx4 v192, s[32:35], s45 offen lds
    s_add_u32 m0, s46, 0x14000
    s_nop 0
    buffer_load_dwordx4 v193, s[40:43], s45 offen lds
    s_add_u32 m0, s46, 0x16000
    s_nop 0
    buffer_load_dwordx4 v194, s[36:39], s45 offen lds
    s_add_u32 s45, s45, 98304
    ds_read_b128 v[144:147], v198 offset:32768
    ds_read_b64_tr_b16 v[160:161], v199 offset:24576
    ds_read_b64_tr_b16 v[162:163], v199 offset:25088
    ds_read_b128 v[148:151], v198 offset:34816
    ds_read_b128 v[152:155], v198 offset:36864
    ds_read_b128 v[156:159], v198 offset:38912
    ds_read_b64_tr_b16 v[164:165], v201 offset:24576
    ds_read_b64_tr_b16 v[166:167], v201 offset:25088
    ds_read_b64_tr_b16 v[168:169], v203 offset:24576
    ds_read_b64_tr_b16 v[170:171], v203 offset:25088
    ds_read_b64_tr_b16 v[172:173], v199 offset:36864
    ds_read_b64_tr_b16 v[174:175], v199 offset:37376
    ds_read_b64_tr_b16 v[176:177], v201 offset:36864
    ds_read_b64_tr_b16 v[178:179], v201 offset:37376
    ds_read_b64_tr_b16 v[180:181], v203 offset:36864
    ds_read_b64_tr_b16 v[182:183], v203 offset:37376
    s_waitcnt lgkmcnt(15)
    v_mfma_f32_16x16x32_bf16 v[0:3], v[112:115], v[96:99], v[0:3]
    s_waitcnt lgkmcnt(15)
    v_mfma_f32_16x16x32_bf16 v[4:7], v[112:115], v[100:103], v[4:7]
    s_waitcnt lgkmcnt(15)
    v_mfma_f32_16x16x32_bf16 v[8:11], v[112:115], v[104:107], v[8:11]
    s_waitcnt lgkmcnt(15)
    v_mfma_f32_16x16x32_bf16 v[12:15], v[112:115], v[108:111], v[12:15]
    s_waitcnt lgkmcnt(15)
    v_mfma_f32_16x16x32_bf16 v[16:19], v[116:119], v[96:99], v[16:19]
    v_mfma_f32_16x16x32_bf16 v[20:23], v[116:119], v[100:103], v[20:23]
    v_mfma_f32_16x16x32_bf16 v[24:27], v[116:119], v[104:107], v[24:27]
    v_mfma_f32_16x16x32_bf16 v[28:31], v[116:119], v[108:111], v[28:31]
    s_waitcnt lgkmcnt(15)
    v_mfma_f32_16x16x32_bf16 v[32:35], v[120:123], v[96:99], v[32:35]
    v_mfma_f32_16x16x32_bf16 v[36:39], v[120:123], v[100:103], v[36:39]
    v_mfma_f32_16x16x32_bf16 v[40:43], v[120:123], v[104:107], v[40:43]
    v_mfma_f32_16x16x32_bf16 v[44:47], v[120:123], v[108:111], v[44:47]
    s_waitcnt lgkmcnt(15)
    v_mfma_f32_16x16x32_bf16 v[48:51], v[124:127], v[96:99], v[48:51]
    v_mfma_f32_16x16x32_bf16 v[52:55], v[124:127], v[100:103], v[52:55]
    v_mfma_f32_16x16x32_bf16 v[56:59], v[124:127], v[104:107], v[56:59]
    v_mfma_f32_16x16x32_bf16 v[60:63], v[124:127], v[108:111], v[60:63]
    s_waitcnt lgkmcnt(15)
    v_mfma_f32_16x16x32_bf16 v[64:67], v[128:131], v[96:99], v[64:67]
    v_mfma_f32_16x16x32_bf16 v[68:71], v[128:131], v[100:103], v[68:71]
    v_mfma_f32_16x16x32_bf16 v[72:75], v[128:131], v[104:107], v[72:75]
    v_mfma_f32_16x16x32_bf16 v[76:79], v[128:131], v[108:111], v[76:79]
    s_waitcnt lgkmcnt(15)
    v_mfma_f32_16x16x32_bf16 v[80:83], v[132:135], v[96:99], v[80:83]
    v_mfma_f32_16x16x32_bf16 v[84:87], v[132:135], v[100:103], v[84:87]
    v_mfma_f32_16x16x32_bf16 v[88:91], v[132:135], v[104:107], v[88:91]
    v_mfma_f32_16x16x32_bf16 v[92:95], v[132:135], v[108:111], v[92:95]
    s_waitcnt vmcnt(4)
    s_barrier
    ds_read_b128 v[96:99], v197 offset:0
    ds_read_b64_tr_b16 v[112:113], v199 offset:49152
    ds_read_b64_tr_b16 v[114:115], v199 offset:49664
    ds_read_b128 v[100:103], v197 offset:2048
    ds_read_b128 v[104:107], v197 offset:4096
    ds_read_b128 v[108:111], v197 offset:6144
    ds_read_b64_tr_b16 v[116:117], v201 offset:49152
    ds_read_b64_tr_b16 v[118:119], v201 offset:49664
    ds_read_b64_tr_b16 v[120:121], v203 offset:49152
    ds_read_b64_tr_b16 v[122:123], v203 offset:49664
    ds_read_b64_tr_b16 v[124:125], v199 offset:61440
    ds_read_b64_tr_b16 v[126:127], v199 offset:61952
    ds_read_b64_tr_b16 v[128:129], v201 offset:61440
    ds_read_b64_tr_b16 v[130:131], v201 offset:61952
    ds_read_b64_tr_b16 v[132:133], v203 offset:61440
    ds_read_b64_tr_b16 v[134:135], v203 offset:61952
    s_waitcnt lgkmcnt(15)
    v_mfma_f32_16x16x32_bf16 v[0:3], v[160:163], v[144:147], v[0:3]
    s_waitcnt lgkmcnt(15)
    v_mfma_f32_16x16x32_bf16 v[4:7], v[160:163], v[148:151], v[4:7]
    s_waitcnt lgkmcnt(15)
    v_mfma_f32_16x16x32_bf16 v[8:11], v[160:163], v[152:155], v[8:11]
    s_waitcnt lgkmcnt(15)
    v_mfma_f32_16x16x32_bf16 v[12:15], v[160:163], v[156:159], v[12:15]
    s_waitcnt lgkmcnt(15)
    v_mfma_f32_16x16x32_bf16 v[16:19], v[164:167], v[144:147], v[16:19]
    v_mfma_f32_16x16x32_bf16 v[20:23], v[164:167], v[148:151], v[20:23]
    v_mfma_f32_16x16x32_bf16 v[24:27], v[164:167], v[152:155], v[24:27]
    v_mfma_f32_16x16x32_bf16 v[28:31], v[164:167], v[156:159], v[28:31]
    s_waitcnt lgkmcnt(15)
    v_mfma_f32_16x16x32_bf16 v[32:35], v[168:171], v[144:147], v[32:35]
    v_mfma_f32_16x16x32_bf16 v[36:39], v[168:171], v[148:151], v[36:39]
    v_mfma_f32_16x16x32_bf16 v[40:43], v[168:171], v[152:155], v[40:43]
    v_mfma_f32_16x16x32_bf16 v[44:47], v[168:171], v[156:159], v[44:47]
    s_waitcnt lgkmcnt(15)
    v_mfma_f32_16x16x32_bf16 v[48:51], v[172:175], v[144:147], v[48:51]
    v_mfma_f32_16x16x32_bf16 v[52:55], v[172:175], v[148:151], v[52:55]
    v_mfma_f32_16x16x32_bf16 v[56:59], v[172:175], v[152:155], v[56:59]
    v_mfma_f32_16x16x32_bf16 v[60:63], v[172:175], v[156:159], v[60:63]
    s_waitcnt lgkmcnt(15)
    v_mfma_f32_16x16x32_bf16 v[64:67], v[176:179], v[144:147], v[64:67]
    v_mfma_f32_16x16x32_bf16 v[68:71], v[176:179], v[148:151], v[68:71]
    v_mfma_f32_16x16x32_bf16 v[72:75], v[176:179], v[152:155], v[72:75]
    v_mfma_f32_16x16x32_bf16 v[76:79], v[176:179], v[156:159], v[76:79]
    s_waitcnt lgkmcnt(15)
    v_mfma_f32_16x16x32_bf16 v[80:83], v[180:183], v[144:147], v[80:83]
    v_mfma_f32_16x16x32_bf16 v[84:87], v[180:183], v[148:151], v[84:87]
    v_mfma_f32_16x16x32_bf16 v[88:91], v[180:183], v[152:155], v[88:91]
    v_mfma_f32_16x16x32_bf16 v[92:95], v[180:183], v[156:159], v[92:95]
    s_waitcnt vmcnt(0)
    s_cmp_lg_u32 s47, 0
    s_cbranch_scc1 LGU_wf_ok
    v_readfirstlane_b32 s48, v211
    s_cmp_ge_u32 s48, 220
    s_cbranch_scc1 LGU_wf_ok
    v_mov_b32 v210, 0
    s_mov_b32 s49, 0
LGU_wf:
    buffer_load_dword v211, v210, s[60:63], 0 offen sc1
    s_waitcnt vmcnt(0)
    v_readfirstlane_b32 s48, v211
    s_cmp_ge_u32 s48, 220
    s_cbranch_scc1 LGU_wf_ok
    s_sleep 8
    s_add_u32 s49, s49, 1
    s_cmp_lt_u32 s49, 0x10000
    s_cbranch_scc1 LGU_wf
LGU_wf_ok:
    s_barrier
    s_add_u32 s56, s24, 0x1120000
    s_addc_u32 s57, s25, 0
    s_and_b32 s57, s57, 0xffff
    s_mov_b32 s58, 0x4000
    s_mov_b32 s59, 0x00020000
    s_add_u32 s64, s24, 0x1128000
    s_addc_u32 s65, s25, 0
    s_and_b32 s65, s65, 0xffff
    s_mov_b32 s66, 0x4e00
    s_mov_b32 s67, 0x00020000
    v_and_b32 v210, 15, v207
    v_lshrrev_b32 v213, 2, v208
    v_and_b32 v214, 3, v208
    v_mul_u32_u24 v215, 64, v213
    v_add_u32 v215, v215, v210
    s_lshl_b32 s48, s51, 7
    v_add_u32 v215, s48, v215
    v_lshlrev_b32 v215, 3, v215
    buffer_load_dwordx2 v[230:231], v215, s[56:59], 0 offen offset:0 sc1
    buffer_load_dwordx2 v[232:233], v215, s[56:59], 0 offen offset:128 sc1
    buffer_load_dwordx2 v[234:235], v215, s[56:59], 0 offen offset:256 sc1
    buffer_load_dwordx2 v[236:237], v215, s[56:59], 0 offen offset:384 sc1
    s_mul_i32 s48, s52, 192
    s_add_u32 s48, s48, 1920
    v_mul_u32_u24 v216, 48, v214
    v_add3_u32 v216, v216, v210, s48
    v_lshlrev_b32 v216, 2, v216
    v_add_u32 v217, 6144, v216
    buffer_load_dword v238, v216, s[64:67], 0 offen offset:0 sc1
    buffer_load_dword v239, v216, s[64:67], 0 offen offset:64 sc1
    buffer_load_dword v240, v216, s[64:67], 0 offen offset:128 sc1
    buffer_load_dword v241, v217, s[64:67], 0 offen offset:0 sc1
    buffer_load_dword v242, v217, s[64:67], 0 offen offset:64 sc1
    buffer_load_dword v243, v217, s[64:67], 0 offen offset:128 sc1
    ds_read_b128 v[144:147], v198 offset:0
    ds_read_b64_tr_b16 v[160:161], v200 offset:8192
    ds_read_b64_tr_b16 v[162:163], v200 offset:8704
    ds_read_b128 v[148:151], v198 offset:2048
    ds_read_b128 v[152:155], v198 offset:4096
    ds_read_b128 v[156:159], v198 offset:6144
    ds_read_b64_tr_b16 v[164:165], v202 offset:8192
    ds_read_b64_tr_b16 v[166:167], v202 offset:8704
    ds_read_b64_tr_b16 v[168:169], v204 offset:8192
    ds_read_b64_tr_b16 v[170:171], v204 offset:8704
    ds_read_b64_tr_b16 v[172:173], v200 offset:20480
    ds_read_b64_tr_b16 v[174:175], v200 offset:20992
    ds_read_b64_tr_b16 v[176:177], v202 offset:20480
    ds_read_b64_tr_b16 v[178:179], v202 offset:20992
    ds_read_b64_tr_b16 v[180:181], v204 offset:20480
    ds_read_b64_tr_b16 v[182:183], v204 offset:20992
    s_waitcnt lgkmcnt(15)
    v_mfma_f32_16x16x32_bf16 v[0:3], v[112:115], v[96:99], v[0:3]
    s_waitcnt lgkmcnt(15)
    v_mfma_f32_16x16x32_bf16 v[4:7], v[112:115], v[100:103], v[4:7]
    s_waitcnt lgkmcnt(15)
    v_mfma_f32_16x16x32_bf16 v[8:11], v[112:115], v[104:107], v[8:11]
    s_waitcnt lgkmcnt(15)
    v_mfma_f32_16x16x32_bf16 v[12:15], v[112:115], v[108:111], v[12:15]
    s_waitcnt lgkmcnt(15)
    v_mfma_f32_16x16x32_bf16 v[16:19], v[116:119], v[96:99], v[16:19]
    v_mfma_f32_16x16x32_bf16 v[20:23], v[116:119], v[100:103], v[20:23]
    v_mfma_f32_16x16x32_bf16 v[24:27], v[116:119], v[104:107], v[24:27]
    v_mfma_f32_16x16x32_bf16 v[28:31], v[116:119], v[108:111], v[28:31]
    s_waitcnt lgkmcnt(15)
    v_mfma_f32_16x16x32_bf16 v[32:35], v[120:123], v[96:99], v[32:35]
    v_mfma_f32_16x16x32_bf16 v[36:39], v[120:123], v[100:103], v[36:39]
    v_mfma_f32_16x16x32_bf16 v[40:43], v[120:123], v[104:107], v[40:43]
    v_mfma_f32_16x16x32_bf16 v[44:47], v[120:123], v[108:111], v[44:47]
    s_waitcnt lgkmcnt(15)
    v_mfma_f32_16x16x32_bf16 v[48:51], v[124:127], v[96:99], v[48:51]
    v_mfma_f32_16x16x32_bf16 v[52:55], v[124:127], v[100:103], v[52:55]
    v_mfma_f32_16x16x32_bf16 v[56:59], v[124:127], v[104:107], v[56:59]
    v_mfma_f32_16x16x32_bf16 v[60:63], v[124:127], v[108:111], v[60:63]
    s_waitcnt lgkmcnt(15)
    v_mfma_f32_16x16x32_bf16 v[64:67], v[128:131], v[96:99], v[64:67]
    v_mfma_f32_16x16x32_bf16 v[68:71], v[128:131], v[100:103], v[68:71]
    v_mfma_f32_16x16x32_bf16 v[72:75], v[128:131], v[104:107], v[72:75]
    v_mfma_f32_16x16x32_bf16 v[76:79], v[128:131], v[108:111], v[76:79]
    s_waitcnt lgkmcnt(15)
    v_mfma_f32_16x16x32_bf16 v[80:83], v[132:135], v[96:99], v[80:83]
    v_mfma_f32_16x16x32_bf16 v[84:87], v[132:135], v[100:103], v[84:87]
    v_mfma_f32_16x16x32_bf16 v[88:91], v[132:135], v[104:107], v[88:91]
    v_mfma_f32_16x16x32_bf16 v[92:95], v[132:135], v[108:111], v[92:95]
    s_waitcnt lgkmcnt(13)
    v_mfma_f32_16x16x32_bf16 v[0:3], v[160:163], v[144:147], v[0:3]
    s_waitcnt lgkmcnt(12)
    v_mfma_f32_16x16x32_bf16 v[4:7], v[160:163], v[148:151], v[4:7]
    s_waitcnt lgkmcnt(11)
    v_mfma_f32_16x16x32_bf16 v[8:11], v[160:163], v[152:155], v[8:11]
    s_waitcnt lgkmcnt(10)
    v_mfma_f32_16x16x32_bf16 v[12:15], v[160:163], v[156:159], v[12:15]
    s_waitcnt lgkmcnt(8)
    v_mfma_f32_16x16x32_bf16 v[16:19], v[164:167], v[144:147], v[16:19]
    v_mfma_f32_16x16x32_bf16 v[20:23], v[164:167], v[148:151], v[20:23]
    v_mfma_f32_16x16x32_bf16 v[24:27], v[164:167], v[152:155], v[24:27]
    v_mfma_f32_16x16x32_bf16 v[28:31], v[164:167], v[156:159], v[28:31]
    s_waitcnt lgkmcnt(6)
    v_mfma_f32_16x16x32_bf16 v[32:35], v[168:171], v[144:147], v[32:35]
    v_mfma_f32_16x16x32_bf16 v[36:39], v[168:171], v[148:151], v[36:39]
    v_mfma_f32_16x16x32_bf16 v[40:43], v[168:171], v[152:155], v[40:43]
    v_mfma_f32_16x16x32_bf16 v[44:47], v[168:171], v[156:159], v[44:47]
    s_waitcnt lgkmcnt(4)
    v_mfma_f32_16x16x32_bf16 v[48:51], v[172:175], v[144:147], v[48:51]
    v_mfma_f32_16x16x32_bf16 v[52:55], v[172:175], v[148:151], v[52:55]
    v_mfma_f32_16x16x32_bf16 v[56:59], v[172:175], v[152:155], v[56:59]
    v_mfma_f32_16x16x32_bf16 v[60:63], v[172:175], v[156:159], v[60:63]
    s_waitcnt lgkmcnt(2)
    v_mfma_f32_16x16x32_bf16 v[64:67], v[176:179], v[144:147], v[64:67]
    v_mfma_f32_16x16x32_bf16 v[68:71], v[176:179], v[148:151], v[68:71]
    v_mfma_f32_16x16x32_bf16 v[72:75], v[176:179], v[152:155], v[72:75]
    v_mfma_f32_16x16x32_bf16 v[76:79], v[176:179], v[156:159], v[76:79]
    s_waitcnt lgkmcnt(0)
    v_mfma_f32_16x16x32_bf16 v[80:83], v[180:183], v[144:147], v[80:83]
    v_mfma_f32_16x16x32_bf16 v[84:87], v[180:183], v[148:151], v[84:87]
    v_mfma_f32_16x16x32_bf16 v[88:91], v[180:183], v[152:155], v[88:91]
    v_mfma_f32_16x16x32_bf16 v[92:95], v[180:183], v[156:159], v[92:95]
    s_barrier
    s_waitcnt vmcnt(0)
    v_cmp_gt_u32 vcc, 16, v207
    v_lshrrev_b32 v212, 16, v231
    v_xor_b32 v212, 0x8000, v212
    v_lshl_or_b32 v213, v212, 16, v212
    v_cndmask_b32 v136, 0, v213, vcc
    v_cndmask_b32 v137, 0, v212, vcc
    v_mov_b32 v138, 0
    v_mov_b32 v139, 0
    v_lshrrev_b32 v212, 16, v233
    v_xor_b32 v212, 0x8000, v212
    v_lshl_or_b32 v213, v212, 16, v212
    v_cndmask_b32 v140, 0, v213, vcc
    v_cndmask_b32 v141, 0, v212, vcc
    v_mov_b32 v142, 0
    v_mov_b32 v143, 0
    v_lshrrev_b32 v212, 16, v235
    v_xor_b32 v212, 0x8000, v212
    v_lshl_or_b32 v213, v212, 16, v212
    v_cndmask_b32 v144, 0, v213, vcc
    v_cndmask_b32 v145, 0, v212, vcc
    v_mov_b32 v146, 0
    v_mov_b32 v147, 0
    v_lshrrev_b32 v212, 16, v237
    v_xor_b32 v212, 0x8000, v212
    v_lshl_or_b32 v213, v212, 16, v212
    v_cndmask_b32 v148, 0, v213, vcc
    v_cndmask_b32 v149, 0, v212, vcc
    v_mov_b32 v150, 0
    v_mov_b32 v151, 0
    v_cvt_pk_bf16_f32 v210, v238, v238
    v_lshlrev_b32 v212, 16, v210
    v_sub_f32 v238, v238, v212
    v_cvt_pk_bf16_f32 v211, v238, v238
    v_lshlrev_b32 v212, 16, v211
    v_sub_f32 v238, v238, v212
    v_cvt_pk_bf16_f32 v212, v238, v238
    v_and_b32 v210, 0xffff, v210
    v_lshl_or_b32 v210, v211, 16, v210
    v_and_b32 v212, 0xffff, v212
    v_cndmask_b32 v96, 0, v210, vcc
    v_cndmask_b32 v97, 0, v212, vcc
    v_mov_b32 v98, 0
    v_mov_b32 v99, 0
    v_cvt_pk_bf16_f32 v213, v239, v239
    v_lshlrev_b32 v215, 16, v213
    v_sub_f32 v239, v239, v215
    v_cvt_pk_bf16_f32 v214, v239, v239
    v_lshlrev_b32 v215, 16, v214
    v_sub_f32 v239, v239, v215
    v_cvt_pk_bf16_f32 v215, v239, v239
    v_and_b32 v213, 0xffff, v213
    v_lshl_or_b32 v213, v214, 16, v213
    v_and_b32 v215, 0xffff, v215
    v_cndmask_b32 v100, 0, v213, vcc
    v_cndmask_b32 v101, 0, v215, vcc
    v_mov_b32 v102, 0
    v_mov_b32 v103, 0
    v_cvt_pk_bf16_f32 v216, v240, v240
    v_lshlrev_b32 v218, 16, v216
    v_sub_f32 v240, v240, v218
    v_cvt_pk_bf16_f32 v217, v240, v240
    v_lshlrev_b32 v218, 16, v217
    v_sub_f32 v240, v240, v218
    v_cvt_pk_bf16_f32 v218, v240, v240
    v_and_b32 v216, 0xffff, v216
    v_lshl_or_b32 v216, v217, 16, v216
    v_and_b32 v218, 0xffff, v218
    v_cndmask_b32 v104, 0, v216, vcc
    v_cndmask_b32 v105, 0, v218, vcc
    v_mov_b32 v106, 0
    v_mov_b32 v107, 0
    v_cvt_pk_bf16_f32 v210, v241, v241
    v_lshlrev_b32 v212, 16, v210
    v_sub_f32 v241, v241, v212
    v_cvt_pk_bf16_f32 v211, v241, v241
    v_lshlrev_b32 v212, 16, v211
    v_sub_f32 v241, v241, v212
    v_cvt_pk_bf16_f32 v212, v241, v241
    v_and_b32 v210, 0xffff, v210
    v_lshl_or_b32 v210, v211, 16, v210
    v_and_b32 v212, 0xffff, v212
    v_cndmask_b32 v108, 0, v210, vcc
    v_cndmask_b32 v109, 0, v212, vcc
    v_mov_b32 v110, 0
    v_mov_b32 v111, 0
    v_cvt_pk_bf16_f32 v213, v242, v242
    v_lshlrev_b32 v215, 16, v213
    v_sub_f32 v242, v242, v215
    v_cvt_pk_bf16_f32 v214, v242, v242
    v_lshlrev_b32 v215, 16, v214
    v_sub_f32 v242, v242, v215
    v_cvt_pk_bf16_f32 v215, v242, v242
    v_and_b32 v213, 0xffff, v213
    v_lshl_or_b32 v213, v214, 16, v213
    v_and_b32 v215, 0xffff, v215
    v_cndmask_b32 v112, 0, v213, vcc
    v_cndmask_b32 v113, 0, v215, vcc
    v_mov_b32 v114, 0
    v_mov_b32 v115, 0
    v_cvt_pk_bf16_f32 v216, v243, v243
    v_lshlrev_b32 v218, 16, v216
    v_sub_f32 v243, v243, v218
    v_cvt_pk_bf16_f32 v217, v243, v243
    v_lshlrev_b32 v218, 16, v217
    v_sub_f32 v243, v243, v218
    v_cvt_pk_bf16_f32 v218, v243, v243
    v_and_b32 v216, 0xffff, v216
    v_lshl_or_b32 v216, v217, 16, v216
    v_and_b32 v218, 0xffff, v218
    v_cndmask_b32 v116, 0, v216, vcc
    v_cndmask_b32 v117, 0, v218, vcc
    v_mov_b32 v118, 0
    v_mov_b32 v119, 0
    v_mfma_f32_16x16x32_bf16 v[0:3], v[96:99], v[136:139], v[0:3]
    v_mfma_f32_16x16x32_bf16 v[4:7], v[96:99], v[140:143], v[4:7]
    v_mfma_f32_16x16x32_bf16 v[8:11], v[96:99], v[144:147], v[8:11]
    v_mfma_f32_16x16x32_bf16 v[12:15], v[96:99], v[148:151], v[12:15]
    v_mfma_f32_16x16x32_bf16 v[16:19], v[100:103], v[136:139], v[16:19]
    v_mfma_f32_16x16x32_bf16 v[20:23], v[100:103], v[140:143], v[20:23]
    v_mfma_f32_16x16x32_bf16 v[24:27], v[100:103], v[144:147], v[24:27]
    v_mfma_f32_16x16x32_bf16 v[28:31], v[100:103], v[148:151], v[28:31]
    v_mfma_f32_16x16x32_bf16 v[32:35], v[104:107], v[136:139], v[32:35]
    v_mfma_f32_16x16x32_bf16 v[36:39], v[104:107], v[140:143], v[36:39]
    v_mfma_f32_16x16x32_bf16 v[40:43], v[104:107], v[144:147], v[40:43]
    v_mfma_f32_16x16x32_bf16 v[44:47], v[104:107], v[148:151], v[44:47]
    v_mfma_f32_16x16x32_bf16 v[48:51], v[108:111], v[136:139], v[48:51]
    v_mfma_f32_16x16x32_bf16 v[52:55], v[108:111], v[140:143], v[52:55]
    v_mfma_f32_16x16x32_bf16 v[56:59], v[108:111], v[144:147], v[56:59]
    v_mfma_f32_16x16x32_bf16 v[60:63], v[108:111], v[148:151], v[60:63]
    v_mfma_f32_16x16x32_bf16 v[64:67], v[112:115], v[136:139], v[64:67]
    v_mfma_f32_16x16x32_bf16 v[68:71], v[112:115], v[140:143], v[68:71]
    v_mfma_f32_16x16x32_bf16 v[72:75], v[112:115], v[144:147], v[72:75]
    v_mfma_f32_16x16x32_bf16 v[76:79], v[112:115], v[148:151], v[76:79]
    v_mfma_f32_16x16x32_bf16 v[80:83], v[116:119], v[136:139], v[80:83]
    v_mfma_f32_16x16x32_bf16 v[84:87], v[116:119], v[140:143], v[84:87]
    v_mfma_f32_16x16x32_bf16 v[88:91], v[116:119], v[144:147], v[88:91]
    v_mfma_f32_16x16x32_bf16 v[92:95], v[116:119], v[148:151], v[92:95]
    s_mov_b32 s40, s24
    s_and_b32 s41, s25, 0xffff
    s_mov_b32 s42, 0x600000
    s_mov_b32 s43, 0x00020000
    v_lshrrev_b32 v210, 2, v208
    v_mul_u32_u24 v210, 192, v210
    v_bfe_u32 v211, v208, 1, 1
    v_mul_u32_u24 v211, 3, v211
    s_mul_i32 s48, s51, 384
    s_mul_i32 s49, s52, 6
    s_add_u32 s48, s48, s49
    v_add3_u32 v210, v210, v211, s48
    v_lshlrev_b32 v210, 10, v210
    v_lshl_add_u32 v210, v207, 4, v210
    v_and_b32 v211, 1, v208
    v_lshl_add_u32 v160, v211, 10, v210
    v_lshl_add_u32 v161, v211, 3, v210
    v_mov_b32 v162, 0xbdd2d3e8
    v_mov_b32 v164, 0xc0135761
    s_mov_b32 s49, 0
    v_pk_mul_f32 v[0:1], v[0:1], v[230:231] op_sel_hi:[1,0]
    v_pk_mul_f32 v[48:49], v[48:49], v[230:231] op_sel_hi:[1,0]
    v_pk_mul_f32 v[2:3], v[2:3], v[230:231] op_sel_hi:[1,0]
    v_pk_mul_f32 v[50:51], v[50:51], v[230:231] op_sel_hi:[1,0]
    v_pk_mul_f32 v[16:17], v[16:17], v[230:231] op_sel_hi:[1,0]
    v_pk_mul_f32 v[64:65], v[64:65], v[230:231] op_sel_hi:[1,0]
    v_pk_mul_f32 v[18:19], v[18:19], v[230:231] op_sel_hi:[1,0]
    v_pk_mul_f32 v[66:67], v[66:67], v[230:231] op_sel_hi:[1,0]
    v_pk_mul_f32 v[32:33], v[32:33], v[230:231] op_sel_hi:[1,0]
    v_pk_mul_f32 v[80:81], v[80:81], v[230:231] op_sel_hi:[1,0]
    v_pk_mul_f32 v[34:35], v[34:35], v[230:231] op_sel_hi:[1,0]
    v_pk_mul_f32 v[82:83], v[82:83], v[230:231] op_sel_hi:[1,0]
    v_pk_mul_f32 v[210:211], v[0:1], v[0:1]
    v_pk_mul_f32 v[212:213], v[2:3], v[2:3]
    v_pk_mul_f32 v[214:215], v[16:17], v[16:17]
    v_pk_mul_f32 v[216:217], v[18:19], v[18:19]
    v_pk_mul_f32 v[218:219], v[32:33], v[32:33]
    v_pk_mul_f32 v[220:221], v[34:35], v[34:35]
    v_pk_fma_f32 v[210:211], v[210:211], v[162:163], v[164:165] op_sel_hi:[1,0,0]
    v_pk_fma_f32 v[212:213], v[212:213], v[162:163], v[164:165] op_sel_hi:[1,0,0]
    v_pk_fma_f32 v[214:215], v[214:215], v[162:163], v[164:165] op_sel_hi:[1,0,0]
    v_pk_fma_f32 v[216:217], v[216:217], v[162:163], v[164:165] op_sel_hi:[1,0,0]
    v_pk_fma_f32 v[218:219], v[218:219], v[162:163], v[164:165] op_sel_hi:[1,0,0]
    v_pk_fma_f32 v[220:221], v[220:221], v[162:163], v[164:165] op_sel_hi:[1,0,0]
    v_pk_mul_f32 v[210:211], v[210:211], v[0:1]
    v_pk_mul_f32 v[212:213], v[212:213], v[2:3]
    v_pk_mul_f32 v[214:215], v[214:215], v[16:17]
    v_pk_mul_f32 v[216:217], v[216:217], v[18:19]
    v_pk_mul_f32 v[218:219], v[218:219], v[32:33]
    v_pk_mul_f32 v[220:221], v[220:221], v[34:35]
    v_exp_f32 v210, v210
    v_exp_f32 v211, v211
    v_exp_f32 v212, v212
    v_exp_f32 v213, v213
    v_exp_f32 v214, v214
    v_exp_f32 v215, v215
    v_exp_f32 v216, v216
    v_exp_f32 v217, v217
    v_exp_f32 v218, v218
    v_exp_f32 v219, v219
    v_exp_f32 v220, v220
    v_exp_f32 v221, v221
    v_pk_mul_f32 v[0:1], v[0:1], v[48:49]
    v_pk_mul_f32 v[2:3], v[2:3], v[50:51]
    v_pk_mul_f32 v[16:17], v[16:17], v[64:65]
    v_pk_mul_f32 v[18:19], v[18:19], v[66:67]
    v_pk_mul_f32 v[32:33], v[32:33], v[80:81]
    v_pk_mul_f32 v[34:35], v[34:35], v[82:83]
    v_pk_add_f32 v[210:211], v[210:211], 1.0 op_sel_hi:[1,0]
    v_pk_add_f32 v[212:213], v[212:213], 1.0 op_sel_hi:[1,0]
    v_pk_add_f32 v[214:215], v[214:215], 1.0 op_sel_hi:[1,0]
    v_pk_add_f32 v[216:217], v[216:217], 1.0 op_sel_hi:[1,0]
    v_pk_add_f32 v[218:219], v[218:219], 1.0 op_sel_hi:[1,0]
    v_pk_add_f32 v[220:221], v[220:221], 1.0 op_sel_hi:[1,0]
    v_rcp_f32 v210, v210
    v_rcp_f32 v211, v211
    v_rcp_f32 v212, v212
    v_rcp_f32 v213, v213
    v_rcp_f32 v214, v214
    v_rcp_f32 v215, v215
    v_rcp_f32 v216, v216
    v_rcp_f32 v217, v217
    v_rcp_f32 v218, v218
    v_rcp_f32 v219, v219
    v_rcp_f32 v220, v220
    v_rcp_f32 v221, v221
    v_pk_mul_f32 v[0:1], v[0:1], v[210:211]
    v_pk_mul_f32 v[2:3], v[2:3], v[212:213]
    v_pk_mul_f32 v[16:17], v[16:17], v[214:215]
    v_pk_mul_f32 v[18:19], v[18:19], v[216:217]
    v_pk_mul_f32 v[32:33], v[32:33], v[218:219]
    v_pk_mul_f32 v[34:35], v[34:35], v[220:221]
    v_cvt_pk_bf16_f32 v168, v0, v1
    v_cvt_pk_bf16_f32 v169, v2, v3
    v_cvt_pk_bf16_f32 v170, v16, v17
    v_cvt_pk_bf16_f32 v171, v18, v19
    v_cvt_pk_bf16_f32 v172, v32, v33
    v_cvt_pk_bf16_f32 v173, v34, v35
    buffer_store_dwordx4 v[168:171], v160, s[40:43], s49 offen
    buffer_store_dwordx2 v[172:173], v161, s[40:43], s49 offen offset:2048
    s_add_u32 s49, s49, 49152
    v_pk_mul_f32 v[4:5], v[4:5], v[232:233] op_sel_hi:[1,0]
    v_pk_mul_f32 v[52:53], v[52:53], v[232:233] op_sel_hi:[1,0]
    v_pk_mul_f32 v[6:7], v[6:7], v[232:233] op_sel_hi:[1,0]
    v_pk_mul_f32 v[54:55], v[54:55], v[232:233] op_sel_hi:[1,0]
    v_pk_mul_f32 v[20:21], v[20:21], v[232:233] op_sel_hi:[1,0]
    v_pk_mul_f32 v[68:69], v[68:69], v[232:233] op_sel_hi:[1,0]
    v_pk_mul_f32 v[22:23], v[22:23], v[232:233] op_sel_hi:[1,0]
    v_pk_mul_f32 v[70:71], v[70:71], v[232:233] op_sel_hi:[1,0]
    v_pk_mul_f32 v[36:37], v[36:37], v[232:233] op_sel_hi:[1,0]
    v_pk_mul_f32 v[84:85], v[84:85], v[232:233] op_sel_hi:[1,0]
    v_pk_mul_f32 v[38:39], v[38:39], v[232:233] op_sel_hi:[1,0]
    v_pk_mul_f32 v[86:87], v[86:87], v[232:233] op_sel_hi:[1,0]
    v_pk_mul_f32 v[210:211], v[4:5], v[4:5]
    v_pk_mul_f32 v[212:213], v[6:7], v[6:7]
    v_pk_mul_f32 v[214:215], v[20:21], v[20:21]
    v_pk_mul_f32 v[216:217], v[22:23], v[22:23]
    v_pk_mul_f32 v[218:219], v[36:37], v[36:37]
    v_pk_mul_f32 v[220:221], v[38:39], v[38:39]
    v_pk_fma_f32 v[210:211], v[210:211], v[162:163], v[164:165] op_sel_hi:[1,0,0]
    v_pk_fma_f32 v[212:213], v[212:213], v[162:163], v[164:165] op_sel_hi:[1,0,0]
    v_pk_fma_f32 v[214:215], v[214:215], v[162:163], v[164:165] op_sel_hi:[1,0,0]
    v_pk_fma_f32 v[216:217], v[216:217], v[162:163], v[164:165] op_sel_hi:[1,0,0]
    v_pk_fma_f32 v[218:219], v[218:219], v[162:163], v[164:165] op_sel_hi:[1,0,0]
    v_pk_fma_f32 v[220:221], v[220:221], v[162:163], v[164:165] op_sel_hi:[1,0,0]
    v_pk_mul_f32 v[210:211], v[210:211], v[4:5]
    v_pk_mul_f32 v[212:213], v[212:213], v[6:7]
    v_pk_mul_f32 v[214:215], v[214:215], v[20:21]
    v_pk_mul_f32 v[216:217], v[216:217], v[22:23]
    v_pk_mul_f32 v[218:219], v[218:219], v[36:37]
    v_pk_mul_f32 v[220:221], v[220:221], v[38:39]
    v_exp_f32 v210, v210
    v_exp_f32 v211, v211
    v_exp_f32 v212, v212
    v_exp_f32 v213, v213
    v_exp_f32 v214, v214
    v_exp_f32 v215, v215
    v_exp_f32 v216, v216
    v_exp_f32 v217, v217
    v_exp_f32 v218, v218
    v_exp_f32 v219, v219
    v_exp_f32 v220, v220
    v_exp_f32 v221, v221
    v_pk_mul_f32 v[4:5], v[4:5], v[52:53]
    v_pk_mul_f32 v[6:7], v[6:7], v[54:55]
    v_pk_mul_f32 v[20:21], v[20:21], v[68:69]
    v_pk_mul_f32 v[22:23], v[22:23], v[70:71]
    v_pk_mul_f32 v[36:37], v[36:37], v[84:85]
    v_pk_mul_f32 v[38:39], v[38:39], v[86:87]
    v_pk_add_f32 v[210:211], v[210:211], 1.0 op_sel_hi:[1,0]
    v_pk_add_f32 v[212:213], v[212:213], 1.0 op_sel_hi:[1,0]
    v_pk_add_f32 v[214:215], v[214:215], 1.0 op_sel_hi:[1,0]
    v_pk_add_f32 v[216:217], v[216:217], 1.0 op_sel_hi:[1,0]
    v_pk_add_f32 v[218:219], v[218:219], 1.0 op_sel_hi:[1,0]
    v_pk_add_f32 v[220:221], v[220:221], 1.0 op_sel_hi:[1,0]
    v_rcp_f32 v210, v210
    v_rcp_f32 v211, v211
    v_rcp_f32 v212, v212
    v_rcp_f32 v213, v213
    v_rcp_f32 v214, v214
    v_rcp_f32 v215, v215
    v_rcp_f32 v216, v216
    v_rcp_f32 v217, v217
    v_rcp_f32 v218, v218
    v_rcp_f32 v219, v219
    v_rcp_f32 v220, v220
    v_rcp_f32 v221, v221
    v_pk_mul_f32 v[4:5], v[4:5], v[210:211]
    v_pk_mul_f32 v[6:7], v[6:7], v[212:213]
    v_pk_mul_f32 v[20:21], v[20:21], v[214:215]
    v_pk_mul_f32 v[22:23], v[22:23], v[216:217]
    v_pk_mul_f32 v[36:37], v[36:37], v[218:219]
    v_pk_mul_f32 v[38:39], v[38:39], v[220:221]
    v_cvt_pk_bf16_f32 v176, v4, v5
    v_cvt_pk_bf16_f32 v177, v6, v7
    v_cvt_pk_bf16_f32 v178, v20, v21
    v_cvt_pk_bf16_f32 v179, v22, v23
    v_cvt_pk_bf16_f32 v180, v36, v37
    v_cvt_pk_bf16_f32 v181, v38, v39
    buffer_store_dwordx4 v[176:179], v160, s[40:43], s49 offen
    buffer_store_dwordx2 v[180:181], v161, s[40:43], s49 offen offset:2048
    s_add_u32 s49, s49, 49152
    v_pk_mul_f32 v[8:9], v[8:9], v[234:235] op_sel_hi:[1,0]
    v_pk_mul_f32 v[56:57], v[56:57], v[234:235] op_sel_hi:[1,0]
    v_pk_mul_f32 v[10:11], v[10:11], v[234:235] op_sel_hi:[1,0]
    v_pk_mul_f32 v[58:59], v[58:59], v[234:235] op_sel_hi:[1,0]
    v_pk_mul_f32 v[24:25], v[24:25], v[234:235] op_sel_hi:[1,0]
    v_pk_mul_f32 v[72:73], v[72:73], v[234:235] op_sel_hi:[1,0]
    v_pk_mul_f32 v[26:27], v[26:27], v[234:235] op_sel_hi:[1,0]
    v_pk_mul_f32 v[74:75], v[74:75], v[234:235] op_sel_hi:[1,0]
    v_pk_mul_f32 v[40:41], v[40:41], v[234:235] op_sel_hi:[1,0]
    v_pk_mul_f32 v[88:89], v[88:89], v[234:235] op_sel_hi:[1,0]
    v_pk_mul_f32 v[42:43], v[42:43], v[234:235] op_sel_hi:[1,0]
    v_pk_mul_f32 v[90:91], v[90:91], v[234:235] op_sel_hi:[1,0]
    v_pk_mul_f32 v[210:211], v[8:9], v[8:9]
    v_pk_mul_f32 v[212:213], v[10:11], v[10:11]
    v_pk_mul_f32 v[214:215], v[24:25], v[24:25]
    v_pk_mul_f32 v[216:217], v[26:27], v[26:27]
    v_pk_mul_f32 v[218:219], v[40:41], v[40:41]
    v_pk_mul_f32 v[220:221], v[42:43], v[42:43]
    v_pk_fma_f32 v[210:211], v[210:211], v[162:163], v[164:165] op_sel_hi:[1,0,0]
    v_pk_fma_f32 v[212:213], v[212:213], v[162:163], v[164:165] op_sel_hi:[1,0,0]
    v_pk_fma_f32 v[214:215], v[214:215], v[162:163], v[164:165] op_sel_hi:[1,0,0]
    v_pk_fma_f32 v[216:217], v[216:217], v[162:163], v[164:165] op_sel_hi:[1,0,0]
    v_pk_fma_f32 v[218:219], v[218:219], v[162:163], v[164:165] op_sel_hi:[1,0,0]
    v_pk_fma_f32 v[220:221], v[220:221], v[162:163], v[164:165] op_sel_hi:[1,0,0]
    v_pk_mul_f32 v[210:211], v[210:211], v[8:9]
    v_pk_mul_f32 v[212:213], v[212:213], v[10:11]
    v_pk_mul_f32 v[214:215], v[214:215], v[24:25]
    v_pk_mul_f32 v[216:217], v[216:217], v[26:27]
    v_pk_mul_f32 v[218:219], v[218:219], v[40:41]
    v_pk_mul_f32 v[220:221], v[220:221], v[42:43]
    v_exp_f32 v210, v210
    v_exp_f32 v211, v211
    v_exp_f32 v212, v212
    v_exp_f32 v213, v213
    v_exp_f32 v214, v214
    v_exp_f32 v215, v215
    v_exp_f32 v216, v216
    v_exp_f32 v217, v217
    v_exp_f32 v218, v218
    v_exp_f32 v219, v219
    v_exp_f32 v220, v220
    v_exp_f32 v221, v221
    v_pk_mul_f32 v[8:9], v[8:9], v[56:57]
    v_pk_mul_f32 v[10:11], v[10:11], v[58:59]
    v_pk_mul_f32 v[24:25], v[24:25], v[72:73]
    v_pk_mul_f32 v[26:27], v[26:27], v[74:75]
    v_pk_mul_f32 v[40:41], v[40:41], v[88:89]
    v_pk_mul_f32 v[42:43], v[42:43], v[90:91]
    v_pk_add_f32 v[210:211], v[210:211], 1.0 op_sel_hi:[1,0]
    v_pk_add_f32 v[212:213], v[212:213], 1.0 op_sel_hi:[1,0]
    v_pk_add_f32 v[214:215], v[214:215], 1.0 op_sel_hi:[1,0]
    v_pk_add_f32 v[216:217], v[216:217], 1.0 op_sel_hi:[1,0]
    v_pk_add_f32 v[218:219], v[218:219], 1.0 op_sel_hi:[1,0]
    v_pk_add_f32 v[220:221], v[220:221], 1.0 op_sel_hi:[1,0]
    v_rcp_f32 v210, v210
    v_rcp_f32 v211, v211
    v_rcp_f32 v212, v212
    v_rcp_f32 v213, v213
    v_rcp_f32 v214, v214
    v_rcp_f32 v215, v215
    v_rcp_f32 v216, v216
    v_rcp_f32 v217, v217
    v_rcp_f32 v218, v218
    v_rcp_f32 v219, v219
    v_rcp_f32 v220, v220
    v_rcp_f32 v221, v221
    v_pk_mul_f32 v[8:9], v[8:9], v[210:211]
    v_pk_mul_f32 v[10:11], v[10:11], v[212:213]
    v_pk_mul_f32 v[24:25], v[24:25], v[214:215]
    v_pk_mul_f32 v[26:27], v[26:27], v[216:217]
    v_pk_mul_f32 v[40:41], v[40:41], v[218:219]
    v_pk_mul_f32 v[42:43], v[42:43], v[220:221]
    v_cvt_pk_bf16_f32 v168, v8, v9
    v_cvt_pk_bf16_f32 v169, v10, v11
    v_cvt_pk_bf16_f32 v170, v24, v25
    v_cvt_pk_bf16_f32 v171, v26, v27
    v_cvt_pk_bf16_f32 v172, v40, v41
    v_cvt_pk_bf16_f32 v173, v42, v43
    buffer_store_dwordx4 v[168:171], v160, s[40:43], s49 offen
    buffer_store_dwordx2 v[172:173], v161, s[40:43], s49 offen offset:2048
    s_add_u32 s49, s49, 49152
    v_pk_mul_f32 v[12:13], v[12:13], v[236:237] op_sel_hi:[1,0]
    v_pk_mul_f32 v[60:61], v[60:61], v[236:237] op_sel_hi:[1,0]
    v_pk_mul_f32 v[14:15], v[14:15], v[236:237] op_sel_hi:[1,0]
    v_pk_mul_f32 v[62:63], v[62:63], v[236:237] op_sel_hi:[1,0]
    v_pk_mul_f32 v[28:29], v[28:29], v[236:237] op_sel_hi:[1,0]
    v_pk_mul_f32 v[76:77], v[76:77], v[236:237] op_sel_hi:[1,0]
    v_pk_mul_f32 v[30:31], v[30:31], v[236:237] op_sel_hi:[1,0]
    v_pk_mul_f32 v[78:79], v[78:79], v[236:237] op_sel_hi:[1,0]
    v_pk_mul_f32 v[44:45], v[44:45], v[236:237] op_sel_hi:[1,0]
    v_pk_mul_f32 v[92:93], v[92:93], v[236:237] op_sel_hi:[1,0]
    v_pk_mul_f32 v[46:47], v[46:47], v[236:237] op_sel_hi:[1,0]
    v_pk_mul_f32 v[94:95], v[94:95], v[236:237] op_sel_hi:[1,0]
    v_pk_mul_f32 v[210:211], v[12:13], v[12:13]
    v_pk_mul_f32 v[212:213], v[14:15], v[14:15]
    v_pk_mul_f32 v[214:215], v[28:29], v[28:29]
    v_pk_mul_f32 v[216:217], v[30:31], v[30:31]
    v_pk_mul_f32 v[218:219], v[44:45], v[44:45]
    v_pk_mul_f32 v[220:221], v[46:47], v[46:47]
    v_pk_fma_f32 v[210:211], v[210:211], v[162:163], v[164:165] op_sel_hi:[1,0,0]
    v_pk_fma_f32 v[212:213], v[212:213], v[162:163], v[164:165] op_sel_hi:[1,0,0]
    v_pk_fma_f32 v[214:215], v[214:215], v[162:163], v[164:165] op_sel_hi:[1,0,0]
    v_pk_fma_f32 v[216:217], v[216:217], v[162:163], v[164:165] op_sel_hi:[1,0,0]
    v_pk_fma_f32 v[218:219], v[218:219], v[162:163], v[164:165] op_sel_hi:[1,0,0]
    v_pk_fma_f32 v[220:221], v[220:221], v[162:163], v[164:165] op_sel_hi:[1,0,0]
    v_pk_mul_f32 v[210:211], v[210:211], v[12:13]
    v_pk_mul_f32 v[212:213], v[212:213], v[14:15]
    v_pk_mul_f32 v[214:215], v[214:215], v[28:29]
    v_pk_mul_f32 v[216:217], v[216:217], v[30:31]
    v_pk_mul_f32 v[218:219], v[218:219], v[44:45]
    v_pk_mul_f32 v[220:221], v[220:221], v[46:47]
    v_exp_f32 v210, v210
    v_exp_f32 v211, v211
    v_exp_f32 v212, v212
    v_exp_f32 v213, v213
    v_exp_f32 v214, v214
    v_exp_f32 v215, v215
    v_exp_f32 v216, v216
    v_exp_f32 v217, v217
    v_exp_f32 v218, v218
    v_exp_f32 v219, v219
    v_exp_f32 v220, v220
    v_exp_f32 v221, v221
    v_pk_mul_f32 v[12:13], v[12:13], v[60:61]
    v_pk_mul_f32 v[14:15], v[14:15], v[62:63]
    v_pk_mul_f32 v[28:29], v[28:29], v[76:77]
    v_pk_mul_f32 v[30:31], v[30:31], v[78:79]
    v_pk_mul_f32 v[44:45], v[44:45], v[92:93]
    v_pk_mul_f32 v[46:47], v[46:47], v[94:95]
    v_pk_add_f32 v[210:211], v[210:211], 1.0 op_sel_hi:[1,0]
    v_pk_add_f32 v[212:213], v[212:213], 1.0 op_sel_hi:[1,0]
    v_pk_add_f32 v[214:215], v[214:215], 1.0 op_sel_hi:[1,0]
    v_pk_add_f32 v[216:217], v[216:217], 1.0 op_sel_hi:[1,0]
    v_pk_add_f32 v[218:219], v[218:219], 1.0 op_sel_hi:[1,0]
    v_pk_add_f32 v[220:221], v[220:221], 1.0 op_sel_hi:[1,0]
    v_rcp_f32 v210, v210
    v_rcp_f32 v211, v211
    v_rcp_f32 v212, v212
    v_rcp_f32 v213, v213
    v_rcp_f32 v214, v214
    v_rcp_f32 v215, v215
    v_rcp_f32 v216, v216
    v_rcp_f32 v217, v217
    v_rcp_f32 v218, v218
    v_rcp_f32 v219, v219
    v_rcp_f32 v220, v220
    v_rcp_f32 v221, v221
    v_pk_mul_f32 v[12:13], v[12:13], v[210:211]
    v_pk_mul_f32 v[14:15], v[14:15], v[212:213]
    v_pk_mul_f32 v[28:29], v[28:29], v[214:215]
    v_pk_mul_f32 v[30:31], v[30:31], v[216:217]
    v_pk_mul_f32 v[44:45], v[44:45], v[218:219]
    v_pk_mul_f32 v[46:47], v[46:47], v[220:221]
    v_cvt_pk_bf16_f32 v176, v12, v13
    v_cvt_pk_bf16_f32 v177, v14, v15
    v_cvt_pk_bf16_f32 v178, v28, v29
    v_cvt_pk_bf16_f32 v179, v30, v31
    v_cvt_pk_bf16_f32 v180, v44, v45
    v_cvt_pk_bf16_f32 v181, v46, v47
    buffer_store_dwordx4 v[176:179], v160, s[40:43], s49 offen
    buffer_store_dwordx2 v[180:181], v161, s[40:43], s49 offen offset:2048
    s_waitcnt vmcnt(0)
    s_endpgm
Lk1_qkv:
    s_sub_u32 s48, s2, 128
    s_lshr_b32 s51, s48, 3
    s_and_b32 s52, s48, 7
    v_readfirstlane_b32 s47, v0
    s_cmp_ge_u32 s47, 256
    s_cbranch_scc1 Lk1_q
    v_mov_b32 v209, v0
    v_and_b32 v207, 63, v0
    v_lshrrev_b32 v208, 6, v0
    s_nop 0
    v_readfirstlane_b32 s47, v208
    s_lshl_b32 s46, s47, 10
    s_mov_b32 s28, s4
    s_and_b32 s29, s5, 0xffff
    s_mov_b32 s30, 0x280000
    s_mov_b32 s31, 0x00020000
    v_lshrrev_b32 v210, 3, v207
    v_and_b32 v211, 7, v207
    v_xor_b32 v212, v211, v210
    s_lshl_b32 s48, s51, 7
    v_lshl_add_u32 v213, v208, 3, v210
    v_add_u32 v213, s48, v213
    s_movk_i32 s49, 1280
    v_mul_lo_u32 v213, v213, s49
    v_lshl_add_u32 v195, v212, 4, v213
    v_add_u32 v196, 81920, v195
    v_and_b32 v213, 3, v208
    v_bfe_u32 v214, v210, 1, 1
    v_and_b32 v215, 1, v213
    v_lshl_add_u32 v214, v215, 1, v214
    v_lshlrev_b32 v214, 1, v214
    v_xor_b32 v214, v211, v214
    v_lshl_add_u32 v215, v213, 3, v210
    s_movk_i32 s49, 3840
    v_mul_lo_u32 v215, v215, s49
    v_lshl_add_u32 v215, v214, 4, v215
    v_lshrrev_b32 v216, 2, v208
    v_lshl_add_u32 v215, v216, 7, v215
    s_mul_i32 s48, s52, 80
    s_and_b32 s48, s48, 0xffc0
    s_lshl_b32 s48, s48, 1
    v_add_u32 v192, s48, v215
    v_add_u32 v193, 1280, v192
    v_add_u32 v194, 2560, v192
    s_mov_b32 s32, s6
    s_and_b32 s33, s7, 0xffff
    s_mov_b32 s34, 0x258000
    s_mov_b32 s35, 0x00020000
    s_mov_b32 s44, 0
    s_mov_b32 s45, 0
    s_add_u32 m0, s46, 0x18000
    s_nop 0
    buffer_load_dwordx4 v195, s[28:31], s44 offen lds
    s_add_u32 m0, s46, 0x1a000
    s_nop 0
    buffer_load_dwordx4 v196, s[28:31], s44 offen lds
    s_add_u32 s44, s44, 128
    s_add_u32 m0, s46, 0x0
    s_nop 0
    buffer_load_dwordx4 v192, s[32:35], s45 offen lds
    s_add_u32 m0, s46, 0x2000
    s_nop 0
    buffer_load_dwordx4 v193, s[32:35], s45 offen lds
    s_add_u32 m0, s46, 0x4000
    s_nop 0
    buffer_load_dwordx4 v194, s[32:35], s45 offen lds
    s_add_u32 s45, s45, 122880
    s_add_u32 m0, s46, 0x1c000
    s_nop 0
    buffer_load_dwordx4 v195, s[28:31], s44 offen lds
    s_add_u32 m0, s46, 0x1e000
    s_nop 0
    buffer_load_dwordx4 v196, s[28:31], s44 offen lds
    s_add_u32 s44, s44, 128
    s_add_u32 m0, s46, 0x6000
    s_nop 0
    buffer_load_dwordx4 v192, s[32:35], s45 offen lds
    s_add_u32 m0, s46, 0x8000
    s_nop 0
    buffer_load_dwordx4 v193, s[32:35], s45 offen lds
    s_add_u32 m0, s46, 0xa000
    s_nop 0
    buffer_load_dwordx4 v194, s[32:35], s45 offen lds
    s_add_u32 s45, s45, 122880
    s_add_u32 m0, s46, 0xc000
    s_nop 0
    buffer_load_dwordx4 v192, s[32:35], s45 offen lds
    s_add_u32 m0, s46, 0xe000
    s_nop 0
    buffer_load_dwordx4 v193, s[32:35], s45 offen lds
    s_add_u32 m0, s46, 0x10000
    s_nop 0
    buffer_load_dwordx4 v194, s[32:35], s45 offen lds
    s_add_u32 s45, s45, 122880
    v_and_b32 v210, 15, v207
    v_lshrrev_b32 v211, 4, v207
    v_lshrrev_b32 v213, 0, v208
    v_and_b32 v213, 3, v213
    v_and_b32 v214, 0, v208
    v_and_b32 v215, 7, v210
    v_mul_u32_u24 v216, 4096, v213
    v_lshl_add_u32 v216, v210, 7, v216
    v_add_u32 v216, 98304, v216
    v_add_u32 v217, 0, v211
    v_xor_b32 v217, v217, v215
    v_lshl_add_u32 v197, v217, 4, v216
    v_add_u32 v217, 4, v211
    v_xor_b32 v217, v217, v215
    v_lshl_add_u32 v198, v217, 4, v216
    v_bfe_u32 v215, v210, 3, 1
    v_and_b32 v216, 1, v211
    v_lshl_add_u32 v215, v216, 1, v215
    v_lshrrev_b32 v216, 2, v210
    v_lshl_add_u32 v216, v211, 3, v216
    v_lshlrev_b32 v216, 7, v216
    v_and_b32 v217, 3, v210
    v_lshl_add_u32 v216, v217, 3, v216
    v_mul_u32_u24 v217, 5, v214
    s_mul_i32 s48, s52, 5
    s_and_b32 s48, s48, 3
    s_add_u32 s48, s48, 8
    v_add_u32 v217, s48, v217
    v_add_u32 v218, 0, v217
    v_and_b32 v219, 3, v218
    v_xor_b32 v219, v219, v215
    v_lshl_add_u32 v219, v219, 5, v216
    v_lshrrev_b32 v218, 2, v218
    v_lshl_add_u32 v199, v218, 12, v219
    v_add_u32 v200, 0x10000, v199
    v_add_u32 v218, 1, v217
    v_and_b32 v219, 3, v218
    v_xor_b32 v219, v219, v215
    v_lshl_add_u32 v219, v219, 5, v216
    v_lshrrev_b32 v218, 2, v218
    v_lshl_add_u32 v201, v218, 12, v219
    v_add_u32 v202, 0x10000, v201
    v_add_u32 v218, 2, v217
    v_and_b32 v219, 3, v218
    v_xor_b32 v219, v219, v215
    v_lshl_add_u32 v219, v219, 5, v216
    v_lshrrev_b32 v218, 2, v218
    v_lshl_add_u32 v203, v218, 12, v219
    v_add_u32 v204, 0x10000, v203
    v_add_u32 v218, 3, v217
    v_and_b32 v219, 3, v218
    v_xor_b32 v219, v219, v215
    v_lshl_add_u32 v219, v219, 5, v216
    v_lshrrev_b32 v218, 2, v218
    v_lshl_add_u32 v205, v218, 12, v219
    v_add_u32 v206, 0x10000, v205
    s_mov_b32 s36, s8
    s_and_b32 s37, s9, 0xffff
    s_mov_b32 s38, 0x6400
    s_mov_b32 s39, 0x00020000
    s_mul_i32 s48, s52, 3200
    v_lshlrev_b32 v210, 4, v209
    v_add_u32 v211, s48, v210
    buffer_load_dwordx4 v[96:99], v211, s[36:39], 0 offen
    s_mov_b32 s60, s22
    s_and_b32 s61, s23, 0xffff
    s_mov_b32 s62, 0x100
    s_mov_b32 s63, 0x00020000
    s_cmp_lg_u32 s2, 220
    s_cbranch_scc1 LKV_pp_nf
    s_add_u32 s56, s24, 0x1130000
    s_addc_u32 s57, s25, 0
    s_and_b32 s57, s57, 0xffff
    s_mov_b32 s58, 0x1000
    s_mov_b32 s59, 0x00020000
    v_lshlrev_b32 v1, 4, v209
    v_mov_b32 v8, 0
    v_mov_b32 v9, 0
    v_mov_b32 v10, 0
    v_mov_b32 v11, 0
    buffer_store_dwordx4 v[8:11], v1, s[56:59], 0 offen
LKV_pp_nf:
    s_cmp_ge_u32 s2, 220
    s_cbranch_scc1 LKV_pp_done
    s_cmp_ge_u32 s2, 206
    s_cbranch_scc1 LKV_pp_zero
    s_cmp_ge_u32 s2, 78
    s_cbranch_scc1 LKV_pp_stats
    s_mov_b32 s56, s6
    s_and_b32 s57, s7, 0xffff
    s_mov_b32 s58, 0x258000
    s_mov_b32 s59, 0x00020000
    s_movk_i32 s54, 3840
    s_lshl_b32 s55, s2, 7
    s_cmp_lt_u32 s2, 30
    s_cbranch_scc1 LKV_pp_cs
    s_mov_b32 s56, s14
    s_and_b32 s57, s15, 0xffff
    s_mov_b32 s58, 0x1e0000
    s_mov_b32 s59, 0x00020000
    s_movk_i32 s54, 3072
    s_sub_u32 s55, s55, 3840
    s_cmp_lt_u32 s2, 54
    s_cbranch_scc1 LKV_pp_cs
    s_mov_b32 s56, s16
    s_and_b32 s57, s17, 0xffff
    s_mov_b32 s58, 0x1e0000
    s_mov_b32 s59, 0x00020000
    s_sub_u32 s55, s55, 3072
LKV_pp_cs:
    v_and_b32 v1, 7, v209
    v_lshrrev_b32 v2, 3, v209
    v_mul_lo_u32 v2, v2, s54
    v_lshl_add_u32 v2, v1, 4, v2
    v_add_u32 v2, s55, v2
    s_lshl_b32 s54, s54, 6
    s_mov_b32 s55, 0
    buffer_load_dwordx4 v[214:217], v2, s[56:59], s55 offen
    s_add_u32 s55, s55, s54
    buffer_load_dwordx4 v[218:221], v2, s[56:59], s55 offen
    s_add_u32 s55, s55, s54
    buffer_load_dwordx4 v[222:225], v2, s[56:59], s55 offen
    s_add_u32 s55, s55, s54
    buffer_load_dwordx4 v[226:229], v2, s[56:59], s55 offen
    s_add_u32 s55, s55, s54
    buffer_load_dwordx4 v[230:233], v2, s[56:59], s55 offen
    s_add_u32 s55, s55, s54
    buffer_load_dwordx4 v[234:237], v2, s[56:59], s55 offen
    s_add_u32 s55, s55, s54
    buffer_load_dwordx4 v[238:241], v2, s[56:59], s55 offen
    s_add_u32 s55, s55, s54
    buffer_load_dwordx4 v[242:245], v2, s[56:59], s55 offen
    s_add_u32 s55, s55, s54
    buffer_load_dwordx4 v[246:249], v2, s[56:59], s55 offen
    s_add_u32 s55, s55, s54
    buffer_load_dwordx4 v[250:253], v2, s[56:59], s55 offen
    s_branch LKV_pp_done
LKV_pp_stats:
    s_sub_u32 s54, s2, 78
    s_lshl_b32 s54, s54, 4
    v_lshrrev_b32 v1, 5, v209
    v_add_u32 v1, s54, v1
    v_and_b32 v2, 31, v209
    v_mul_u32_u24 v3, 40, v2
    s_movk_i32 s55, 1280
    v_mul_lo_u32 v4, v1, s55
    v_add_u32 v3, v3, v4
    s_waitcnt vmcnt(9)
    buffer_load_dwordx4 v[214:217], v3, s[28:31], 0 offen
    s_waitcnt vmcnt(9)
    buffer_load_dwordx4 v[218:221], v3, s[28:31], 0 offen offset:16
    s_waitcnt vmcnt(9)
    buffer_load_dwordx2 v[222:223], v3, s[28:31], 0 offen offset:32
    s_branch LKV_pp_done
LKV_pp_zero:
    s_add_u32 s56, s24, 0x1100000
    s_addc_u32 s57, s25, 0
    s_and_b32 s57, s57, 0xffff
    s_mov_b32 s58, 0x1a400
    s_mov_b32 s59, 0x00020000
    s_sub_u32 s54, s2, 206
    s_mul_i32 s54, s54, 7680
    v_lshlrev_b32 v1, 4, v209
    v_add_u32 v1, s54, v1
    v_mov_b32 v3, 0x7fffff00
    v_cmp_gt_u32 vcc, 480, v209
    s_nop 1
    v_cndmask_b32 v1, v3, v1, vcc
    v_mov_b32 v8, 0
    v_mov_b32 v9, 0
    v_mov_b32 v10, 0
    v_mov_b32 v11, 0
    buffer_store_dwordx4 v[8:11], v1, s[56:59], 0 offen sc1
LKV_pp_done:
    s_waitcnt vmcnt(0)
    v_lshlrev_b32 v210, 4, v209
    v_add_u32 v211, 147456, v210
    v_mov_b32 v213, 160320
    v_cmp_gt_u32 vcc, 3200, v210
    s_nop 1
    v_cndmask_b32 v211, v213, v211, vcc
    ds_write_b128 v211, v[96:99]
    v_mov_b32 v104, 0
    v_mov_b32 v105, 0
    v_mov_b32 v106, 0
    v_mov_b32 v107, 0
    v_and_b32 v210, 3, v209
    v_lshlrev_b32 v210, 4, v210
    v_add_u32 v210, 160256, v210
    ds_write_b128 v210, v[104:107]
    s_waitcnt lgkmcnt(0)
    v_mov_b32 v0, 0
    v_mov_b32 v1, 0
    v_mov_b32 v2, 0
    v_mov_b32 v3, 0
    v_mov_b32 v4, 0
    v_mov_b32 v5, 0
    v_mov_b32 v6, 0
    v_mov_b32 v7, 0
    v_mov_b32 v8, 0
    v_mov_b32 v9, 0
    v_mov_b32 v10, 0
    v_mov_b32 v11, 0
    v_mov_b32 v12, 0
    v_mov_b32 v13, 0
    v_mov_b32 v14, 0
    v_mov_b32 v15, 0
    v_mov_b32 v16, 0
    v_mov_b32 v17, 0
    v_mov_b32 v18, 0
    v_mov_b32 v19, 0
    v_mov_b32 v20, 0
    v_mov_b32 v21, 0
    v_mov_b32 v22, 0
    v_mov_b32 v23, 0
    v_mov_b32 v24, 0
    v_mov_b32 v25, 0
    v_mov_b32 v26, 0
    v_mov_b32 v27, 0
    v_mov_b32 v28, 0
    v_mov_b32 v29, 0
    v_mov_b32 v30, 0
    v_mov_b32 v31, 0
    v_mov_b32 v32, 0
    v_mov_b32 v33, 0
    v_mov_b32 v34, 0
    v_mov_b32 v35, 0
    v_mov_b32 v36, 0
    v_mov_b32 v37, 0
    v_mov_b32 v38, 0
    v_mov_b32 v39, 0
    v_mov_b32 v40, 0
    v_mov_b32 v41, 0
    v_mov_b32 v42, 0
    v_mov_b32 v43, 0
    v_mov_b32 v44, 0
    v_mov_b32 v45, 0
    v_mov_b32 v46, 0
    v_mov_b32 v47, 0
    v_mov_b32 v48, 0
    v_mov_b32 v49, 0
    v_mov_b32 v50, 0
    v_mov_b32 v51, 0
    v_mov_b32 v52, 0
    v_mov_b32 v53, 0
    v_mov_b32 v54, 0
    v_mov_b32 v55, 0
    v_mov_b32 v56, 0
    v_mov_b32 v57, 0
    v_mov_b32 v58, 0
    v_mov_b32 v59, 0
    v_mov_b32 v60, 0
    v_mov_b32 v61, 0
    v_mov_b32 v62, 0
    v_mov_b32 v63, 0
    v_mov_b32 v64, 0
    v_mov_b32 v65, 0
    v_mov_b32 v66, 0
    v_mov_b32 v67, 0
    v_mov_b32 v68, 0
    v_mov_b32 v69, 0
    v_mov_b32 v70, 0
    v_mov_b32 v71, 0
    v_mov_b32 v72, 0
    v_mov_b32 v73, 0
    v_mov_b32 v74, 0
    v_mov_b32 v75, 0
    v_mov_b32 v76, 0
    v_mov_b32 v77, 0
    v_mov_b32 v78, 0
    v_mov_b32 v79, 0
    s_waitcnt vmcnt(8)
    s_barrier
    ds_read_b128 v[96:99], v197 offset:0
    ds_read_b64_tr_b16 v[104:105], v199 offset:0
    ds_read_b64_tr_b16 v[106:107], v199 offset:512
    ds_read_b128 v[100:103], v197 offset:2048
    ds_read_b64_tr_b16 v[108:109], v201 offset:0
    ds_read_b64_tr_b16 v[110:111], v201 offset:512
    ds_read_b64_tr_b16 v[112:113], v203 offset:0
    ds_read_b64_tr_b16 v[114:115], v203 offset:512
    ds_read_b64_tr_b16 v[116:117], v205 offset:0
    ds_read_b64_tr_b16 v[118:119], v205 offset:512
    ds_read_b64_tr_b16 v[120:121], v199 offset:4096
    ds_read_b64_tr_b16 v[122:123], v199 offset:4608
    ds_read_b64_tr_b16 v[124:125], v199 offset:8192
    ds_read_b64_tr_b16 v[126:127], v199 offset:8704
    ds_read_b64_tr_b16 v[128:129], v201 offset:8192
    ds_read_b64_tr_b16 v[130:131], v201 offset:8704
    ds_read_b64_tr_b16 v[132:133], v203 offset:8192
    ds_read_b64_tr_b16 v[134:135], v203 offset:8704
    ds_read_b64_tr_b16 v[136:137], v205 offset:8192
    ds_read_b64_tr_b16 v[138:139], v205 offset:8704
    ds_read_b64_tr_b16 v[140:141], v199 offset:12288
    ds_read_b64_tr_b16 v[142:143], v199 offset:12800
    s_waitcnt vmcnt(3)
    s_barrier
    s_waitcnt vmcnt(0)
    s_cmp_ge_u32 s2, 206
    s_cbranch_scc1 LKV_p1_done
    s_cmp_ge_u32 s2, 78
    s_cbranch_scc1 LKV_p1_stats
    v_lshlrev_b32 v144, 16, v214
    v_and_b32 v145, 0xffff0000, v214
    v_lshlrev_b32 v146, 16, v215
    v_and_b32 v147, 0xffff0000, v215
    v_lshlrev_b32 v148, 16, v216
    v_and_b32 v149, 0xffff0000, v216
    v_lshlrev_b32 v150, 16, v217
    v_and_b32 v151, 0xffff0000, v217
    v_lshlrev_b32 v152, 16, v218
    v_and_b32 v153, 0xffff0000, v218
    v_lshlrev_b32 v154, 16, v219
    v_and_b32 v155, 0xffff0000, v219
    v_lshlrev_b32 v156, 16, v220
    v_and_b32 v157, 0xffff0000, v220
    v_lshlrev_b32 v158, 16, v221
    v_and_b32 v159, 0xffff0000, v221
    v_pk_add_f32 v[144:145], v[144:145], v[152:153]
    v_pk_add_f32 v[146:147], v[146:147], v[154:155]
    v_pk_add_f32 v[148:149], v[148:149], v[156:157]
    v_pk_add_f32 v[150:151], v[150:151], v[158:159]
    v_lshlrev_b32 v152, 16, v222
    v_and_b32 v153, 0xffff0000, v222
    v_lshlrev_b32 v154, 16, v223
    v_and_b32 v155, 0xffff0000, v223
    v_lshlrev_b32 v156, 16, v224
    v_and_b32 v157, 0xffff0000, v224
    v_lshlrev_b32 v158, 16, v225
    v_and_b32 v159, 0xffff0000, v225
    v_pk_add_f32 v[144:145], v[144:145], v[152:153]
    v_pk_add_f32 v[146:147], v[146:147], v[154:155]
    v_pk_add_f32 v[148:149], v[148:149], v[156:157]
    v_pk_add_f32 v[150:151], v[150:151], v[158:159]
    v_lshlrev_b32 v152, 16, v226
    v_and_b32 v153, 0xffff0000, v226
    v_lshlrev_b32 v154, 16, v227
    v_and_b32 v155, 0xffff0000, v227
    v_lshlrev_b32 v156, 16, v228
    v_and_b32 v157, 0xffff0000, v228
    v_lshlrev_b32 v158, 16, v229
    v_and_b32 v159, 0xffff0000, v229
    v_pk_add_f32 v[144:145], v[144:145], v[152:153]
    v_pk_add_f32 v[146:147], v[146:147], v[154:155]
    v_pk_add_f32 v[148:149], v[148:149], v[156:157]
    v_pk_add_f32 v[150:151], v[150:151], v[158:159]
    v_lshlrev_b32 v152, 16, v230
    v_and_b32 v153, 0xffff0000, v230
    v_lshlrev_b32 v154, 16, v231
    v_and_b32 v155, 0xffff0000, v231
    v_lshlrev_b32 v156, 16, v232
    v_and_b32 v157, 0xffff0000, v232
    v_lshlrev_b32 v158, 16, v233
    v_and_b32 v159, 0xffff0000, v233
    v_pk_add_f32 v[144:145], v[144:145], v[152:153]
    v_pk_add_f32 v[146:147], v[146:147], v[154:155]
    v_pk_add_f32 v[148:149], v[148:149], v[156:157]
    v_pk_add_f32 v[150:151], v[150:151], v[158:159]
    v_lshlrev_b32 v152, 16, v234
    v_and_b32 v153, 0xffff0000, v234
    v_lshlrev_b32 v154, 16, v235
    v_and_b32 v155, 0xffff0000, v235
    v_lshlrev_b32 v156, 16, v236
    v_and_b32 v157, 0xffff0000, v236
    v_lshlrev_b32 v158, 16, v237
    v_and_b32 v159, 0xffff0000, v237
    v_pk_add_f32 v[144:145], v[144:145], v[152:153]
    v_pk_add_f32 v[146:147], v[146:147], v[154:155]
    v_pk_add_f32 v[148:149], v[148:149], v[156:157]
    v_pk_add_f32 v[150:151], v[150:151], v[158:159]
    v_lshlrev_b32 v152, 16, v238
    v_and_b32 v153, 0xffff0000, v238
    v_lshlrev_b32 v154, 16, v239
    v_and_b32 v155, 0xffff0000, v239
    v_lshlrev_b32 v156, 16, v240
    v_and_b32 v157, 0xffff0000, v240
    v_lshlrev_b32 v158, 16, v241
    v_and_b32 v159, 0xffff0000, v241
    v_pk_add_f32 v[144:145], v[144:145], v[152:153]
    v_pk_add_f32 v[146:147], v[146:147], v[154:155]
    v_pk_add_f32 v[148:149], v[148:149], v[156:157]
    v_pk_add_f32 v[150:151], v[150:151], v[158:159]
    v_lshlrev_b32 v152, 16, v242
    v_and_b32 v153, 0xffff0000, v242
    v_lshlrev_b32 v154, 16, v243
    v_and_b32 v155, 0xffff0000, v243
    v_lshlrev_b32 v156, 16, v244
    v_and_b32 v157, 0xffff0000, v244
    v_lshlrev_b32 v158, 16, v245
    v_and_b32 v159, 0xffff0000, v245
    v_pk_add_f32 v[144:145], v[144:145], v[152:153]
    v_pk_add_f32 v[146:147], v[146:147], v[154:155]
    v_pk_add_f32 v[148:149], v[148:149], v[156:157]
    v_pk_add_f32 v[150:151], v[150:151], v[158:159]
    v_lshlrev_b32 v152, 16, v246
    v_and_b32 v153, 0xffff0000, v246
    v_lshlrev_b32 v154, 16, v247
    v_and_b32 v155, 0xffff0000, v247
    v_lshlrev_b32 v156, 16, v248
    v_and_b32 v157, 0xffff0000, v248
    v_lshlrev_b32 v158, 16, v249
    v_and_b32 v159, 0xffff0000, v249
    v_pk_add_f32 v[144:145], v[144:145], v[152:153]
    v_pk_add_f32 v[146:147], v[146:147], v[154:155]
    v_pk_add_f32 v[148:149], v[148:149], v[156:157]
    v_pk_add_f32 v[150:151], v[150:151], v[158:159]
    v_lshlrev_b32 v152, 16, v250
    v_and_b32 v153, 0xffff0000, v250
    v_lshlrev_b32 v154, 16, v251
    v_and_b32 v155, 0xffff0000, v251
    v_lshlrev_b32 v156, 16, v252
    v_and_b32 v157, 0xffff0000, v252
    v_lshlrev_b32 v158, 16, v253
    v_and_b32 v159, 0xffff0000, v253
    v_pk_add_f32 v[144:145], v[144:145], v[152:153]
    v_pk_add_f32 v[146:147], v[146:147], v[154:155]
    v_pk_add_f32 v[148:149], v[148:149], v[156:157]
    v_pk_add_f32 v[150:151], v[150:151], v[158:159]
    v_add_f32_dpp v144, v144, v144 row_ror:8 row_mask:0xf bank_mask:0xf
    v_add_f32_dpp v145, v145, v145 row_ror:8 row_mask:0xf bank_mask:0xf
    v_add_f32_dpp v146, v146, v146 row_ror:8 row_mask:0xf bank_mask:0xf
    v_add_f32_dpp v147, v147, v147 row_ror:8 row_mask:0xf bank_mask:0xf
    v_add_f32_dpp v148, v148, v148 row_ror:8 row_mask:0xf bank_mask:0xf
    v_add_f32_dpp v149, v149, v149 row_ror:8 row_mask:0xf bank_mask:0xf
    v_add_f32_dpp v150, v150, v150 row_ror:8 row_mask:0xf bank_mask:0xf
    v_add_f32_dpp v151, v151, v151 row_ror:8 row_mask:0xf bank_mask:0xf
    v_mov_b32 v152, v144
    v_mov_b32 v153, v144
    s_nop 1
    v_permlane16_swap_b32 v152, v153
    v_add_f32 v144, v152, v153
    v_mov_b32 v154, v145
    v_mov_b32 v155, v145
    s_nop 1
    v_permlane16_swap_b32 v154, v155
    v_add_f32 v145, v154, v155
    v_mov_b32 v156, v146
    v_mov_b32 v157, v146
    s_nop 1
    v_permlane16_swap_b32 v156, v157
    v_add_f32 v146, v156, v157
    v_mov_b32 v158, v147
    v_mov_b32 v159, v147
    s_nop 1
    v_permlane16_swap_b32 v158, v159
    v_add_f32 v147, v158, v159
    v_mov_b32 v152, v148
    v_mov_b32 v153, v148
    s_nop 1
    v_permlane16_swap_b32 v152, v153
    v_add_f32 v148, v152, v153
    v_mov_b32 v154, v149
    v_mov_b32 v155, v149
    s_nop 1
    v_permlane16_swap_b32 v154, v155
    v_add_f32 v149, v154, v155
    v_mov_b32 v156, v150
    v_mov_b32 v157, v150
    s_nop 1
    v_permlane16_swap_b32 v156, v157
    v_add_f32 v150, v156, v157
    v_mov_b32 v158, v151
    v_mov_b32 v159, v151
    s_nop 1
    v_permlane16_swap_b32 v158, v159
    v_add_f32 v151, v158, v159
    v_mov_b32 v152, v144
    v_mov_b32 v153, v144
    s_nop 1
    v_permlane32_swap_b32 v152, v153
    v_add_f32 v144, v152, v153
    v_mov_b32 v154, v145
    v_mov_b32 v155, v145
    s_nop 1
    v_permlane32_swap_b32 v154, v155
    v_add_f32 v145, v154, v155
    v_mov_b32 v156, v146
    v_mov_b32 v157, v146
    s_nop 1
    v_permlane32_swap_b32 v156, v157
    v_add_f32 v146, v156, v157
    v_mov_b32 v158, v147
    v_mov_b32 v159, v147
    s_nop 1
    v_permlane32_swap_b32 v158, v159
    v_add_f32 v147, v158, v159
    v_mov_b32 v152, v148
    v_mov_b32 v153, v148
    s_nop 1
    v_permlane32_swap_b32 v152, v153
    v_add_f32 v148, v152, v153
    v_mov_b32 v154, v149
    v_mov_b32 v155, v149
    s_nop 1
    v_permlane32_swap_b32 v154, v155
    v_add_f32 v149, v154, v155
    v_mov_b32 v156, v150
    v_mov_b32 v157, v150
    s_nop 1
    v_permlane32_swap_b32 v156, v157
    v_add_f32 v150, v156, v157
    v_mov_b32 v158, v151
    v_mov_b32 v159, v151
    s_nop 1
    v_permlane32_swap_b32 v158, v159
    v_add_f32 v151, v158, v159
    v_and_b32 v214, 31, v209
    v_lshlrev_b32 v214, 3, v214
    v_lshlrev_b32 v212, 5, v207
    v_lshl_add_u32 v212, v208, 8, v212
    v_add_u32 v212, 147456, v212
    v_mov_b32 v213, 160320
    v_cmp_gt_u32 vcc, 8, v207
    s_nop 1
    v_cndmask_b32 v212, v213, v212, vcc
    ds_write_b128 v212, v[144:147]
    ds_write_b128 v212, v[148:151] offset:16
    s_waitcnt lgkmcnt(0)
    s_branch LKV_p1_done
LKV_p1_stats:
    v_mov_b32 v226, 0
    v_mov_b32 v227, 0
    v_mov_b32 v228, 0
    v_mov_b32 v229, 0
    v_lshlrev_b32 v210, 16, v214
    v_and_b32 v211, 0xffff0000, v214
    v_pk_add_f32 v[226:227], v[226:227], v[210:211]
    v_pk_fma_f32 v[228:229], v[210:211], v[210:211], v[228:229]
    v_lshlrev_b32 v210, 16, v215
    v_and_b32 v211, 0xffff0000, v215
    v_pk_add_f32 v[226:227], v[226:227], v[210:211]
    v_pk_fma_f32 v[228:229], v[210:211], v[210:211], v[228:229]
    v_lshlrev_b32 v210, 16, v216
    v_and_b32 v211, 0xffff0000, v216
    v_pk_add_f32 v[226:227], v[226:227], v[210:211]
    v_pk_fma_f32 v[228:229], v[210:211], v[210:211], v[228:229]
    v_lshlrev_b32 v210, 16, v217
    v_and_b32 v211, 0xffff0000, v217
    v_pk_add_f32 v[226:227], v[226:227], v[210:211]
    v_pk_fma_f32 v[228:229], v[210:211], v[210:211], v[228:229]
    v_lshlrev_b32 v210, 16, v218
    v_and_b32 v211, 0xffff0000, v218
    v_pk_add_f32 v[226:227], v[226:227], v[210:211]
    v_pk_fma_f32 v[228:229], v[210:211], v[210:211], v[228:229]
    v_lshlrev_b32 v210, 16, v219
    v_and_b32 v211, 0xffff0000, v219
    v_pk_add_f32 v[226:227], v[226:227], v[210:211]
    v_pk_fma_f32 v[228:229], v[210:211], v[210:211], v[228:229]
    v_lshlrev_b32 v210, 16, v220
    v_and_b32 v211, 0xffff0000, v220
    v_pk_add_f32 v[226:227], v[226:227], v[210:211]
    v_pk_fma_f32 v[228:229], v[210:211], v[210:211], v[228:229]
    v_lshlrev_b32 v210, 16, v221
    v_and_b32 v211, 0xffff0000, v221
    v_pk_add_f32 v[226:227], v[226:227], v[210:211]
    v_pk_fma_f32 v[228:229], v[210:211], v[210:211], v[228:229]
    v_lshlrev_b32 v210, 16, v222
    v_and_b32 v211, 0xffff0000, v222
    v_pk_add_f32 v[226:227], v[226:227], v[210:211]
    v_pk_fma_f32 v[228:229], v[210:211], v[210:211], v[228:229]
    v_lshlrev_b32 v210, 16, v223
    v_and_b32 v211, 0xffff0000, v223
    v_pk_add_f32 v[226:227], v[226:227], v[210:211]
    v_pk_fma_f32 v[228:229], v[210:211], v[210:211], v[228:229]
    v_add_f32 v226, v226, v227
    v_add_f32 v228, v228, v229
    s_nop 0
    v_add_f32_dpp v226, v226, v226 row_ror:8 row_mask:0xf bank_mask:0xf
    v_add_f32_dpp v228, v228, v228 row_ror:8 row_mask:0xf bank_mask:0xf
    s_nop 0
    v_add_f32_dpp v226, v226, v226 row_ror:4 row_mask:0xf bank_mask:0xf
    v_add_f32_dpp v228, v228, v228 row_ror:4 row_mask:0xf bank_mask:0xf
    s_nop 0
    v_add_f32_dpp v226, v226, v226 row_ror:2 row_mask:0xf bank_mask:0xf
    v_add_f32_dpp v228, v228, v228 row_ror:2 row_mask:0xf bank_mask:0xf
    s_nop 0
    v_add_f32_dpp v226, v226, v226 row_ror:1 row_mask:0xf bank_mask:0xf
    v_add_f32_dpp v228, v228, v228 row_ror:1 row_mask:0xf bank_mask:0xf
    v_mov_b32 v210, v226
    v_mov_b32 v211, v226
    s_nop 1
    v_permlane16_swap_b32 v210, v211
    v_add_f32 v226, v210, v211
    v_mov_b32 v210, v228
    v_mov_b32 v211, v228
    s_nop 1
    v_permlane16_swap_b32 v210, v211
    v_add_f32 v228, v210, v211
    s_mov_b32 s55, 0x3acccccd
    v_mul_f32 v226, s55, v226
    v_mul_f32 v228, s55, v228
    v_fma_f32 v228, -v226, v226, v228
    v_max_f32 v228, 0, v228
    v_cvt_pk_bf16_f32 v210, v226, v228
    v_lshlrev_b32 v215, 16, v210
    v_and_b32 v211, 0xffff0000, v210
    v_add_f32 v211, 0x3727c5ac, v211
    v_cvt_pk_bf16_f32 v211, v211, v211
    v_lshlrev_b32 v211, 16, v211
    v_sqrt_f32 v211, v211
    s_nop 0
    v_cvt_pk_bf16_f32 v211, v211, v211
    v_lshlrev_b32 v211, 16, v211
    v_rcp_f32 v214, v211
    s_add_u32 s56, s24, 0x1120000
    s_addc_u32 s57, s25, 0
    s_and_b32 s57, s57, 0xffff
    s_mov_b32 s58, 0x4000
    s_mov_b32 s59, 0x00020000
    s_sub_u32 s54, s2, 78
    s_lshl_b32 s54, s54, 4
    v_lshrrev_b32 v212, 5, v209
    v_add_u32 v212, s54, v212
    v_lshlrev_b32 v212, 3, v212
    v_and_b32 v210, 31, v209
    v_mov_b32 v213, 0x7fffff00
    v_cmp_eq_u32 vcc, 0, v210
    s_nop 1
    v_cndmask_b32 v212, v213, v212, vcc
    buffer_store_dwordx2 v[214:215], v212, s[56:59], 0 offen sc1
LKV_p1_done:
    s_add_u32 m0, s46, 0x20000
    s_nop 0
    buffer_load_dwordx4 v195, s[28:31], s44 offen lds
    s_add_u32 m0, s46, 0x22000
    s_nop 0
    buffer_load_dwordx4 v196, s[28:31], s44 offen lds
    s_add_u32 s44, s44, 128
    s_add_u32 m0, s46, 0x12000
    s_nop 0
    buffer_load_dwordx4 v192, s[32:35], s45 offen lds
    s_add_u32 m0, s46, 0x14000
    s_nop 0
    buffer_load_dwordx4 v193, s[32:35], s45 offen lds
    s_add_u32 m0, s46, 0x16000
    s_nop 0
    buffer_load_dwordx4 v194, s[32:35], s45 offen lds
    s_add_u32 s45, s45, 122880
    ds_read_b128 v[144:147], v198 offset:0
    ds_read_b64_tr_b16 v[152:153], v199 offset:24576
    ds_read_b64_tr_b16 v[154:155], v199 offset:25088
    ds_read_b128 v[148:151], v198 offset:2048
    ds_read_b64_tr_b16 v[156:157], v201 offset:24576
    ds_read_b64_tr_b16 v[158:159], v201 offset:25088
    ds_read_b64_tr_b16 v[160:161], v203 offset:24576
    ds_read_b64_tr_b16 v[162:163], v203 offset:25088
    ds_read_b64_tr_b16 v[164:165], v205 offset:24576
    ds_read_b64_tr_b16 v[166:167], v205 offset:25088
    ds_read_b64_tr_b16 v[168:169], v199 offset:28672
    ds_read_b64_tr_b16 v[170:171], v199 offset:29184
    ds_read_b64_tr_b16 v[172:173], v199 offset:32768
    ds_read_b64_tr_b16 v[174:175], v199 offset:33280
    ds_read_b64_tr_b16 v[176:177], v201 offset:32768
    ds_read_b64_tr_b16 v[178:179], v201 offset:33280
    ds_read_b64_tr_b16 v[180:181], v203 offset:32768
    ds_read_b64_tr_b16 v[182:183], v203 offset:33280
    ds_read_b64_tr_b16 v[184:185], v205 offset:32768
    ds_read_b64_tr_b16 v[186:187], v205 offset:33280
    ds_read_b64_tr_b16 v[188:189], v199 offset:36864
    ds_read_b64_tr_b16 v[190:191], v199 offset:37376
    s_waitcnt lgkmcnt(15)
    v_mfma_f32_16x16x32_bf16 v[0:3], v[104:107], v[96:99], v[0:3]
    s_waitcnt lgkmcnt(15)
    v_mfma_f32_16x16x32_bf16 v[4:7], v[104:107], v[100:103], v[4:7]
    s_waitcnt lgkmcnt(15)
    v_mfma_f32_16x16x32_bf16 v[8:11], v[108:111], v[96:99], v[8:11]
    v_mfma_f32_16x16x32_bf16 v[12:15], v[108:111], v[100:103], v[12:15]
    s_waitcnt lgkmcnt(15)
    v_mfma_f32_16x16x32_bf16 v[16:19], v[112:115], v[96:99], v[16:19]
    v_mfma_f32_16x16x32_bf16 v[20:23], v[112:115], v[100:103], v[20:23]
    s_waitcnt lgkmcnt(15)
    v_mfma_f32_16x16x32_bf16 v[24:27], v[116:119], v[96:99], v[24:27]
    v_mfma_f32_16x16x32_bf16 v[28:31], v[116:119], v[100:103], v[28:31]
    s_waitcnt lgkmcnt(15)
    v_mfma_f32_16x16x32_bf16 v[32:35], v[120:123], v[96:99], v[32:35]
    v_mfma_f32_16x16x32_bf16 v[36:39], v[120:123], v[100:103], v[36:39]
    s_waitcnt lgkmcnt(15)
    v_mfma_f32_16x16x32_bf16 v[40:43], v[96:99], v[124:127], v[40:43]
    v_mfma_f32_16x16x32_bf16 v[44:47], v[100:103], v[124:127], v[44:47]
    s_waitcnt lgkmcnt(15)
    v_mfma_f32_16x16x32_bf16 v[48:51], v[96:99], v[128:131], v[48:51]
    v_mfma_f32_16x16x32_bf16 v[52:55], v[100:103], v[128:131], v[52:55]
    s_waitcnt lgkmcnt(15)
    v_mfma_f32_16x16x32_bf16 v[56:59], v[96:99], v[132:135], v[56:59]
    v_mfma_f32_16x16x32_bf16 v[60:63], v[100:103], v[132:135], v[60:63]
    s_waitcnt lgkmcnt(15)
    v_mfma_f32_16x16x32_bf16 v[64:67], v[96:99], v[136:139], v[64:67]
    v_mfma_f32_16x16x32_bf16 v[68:71], v[100:103], v[136:139], v[68:71]
    s_waitcnt lgkmcnt(15)
    v_mfma_f32_16x16x32_bf16 v[72:75], v[96:99], v[140:143], v[72:75]
    v_mfma_f32_16x16x32_bf16 v[76:79], v[100:103], v[140:143], v[76:79]
    s_waitcnt vmcnt(5)
    s_barrier
    s_cmp_ge_u32 s2, 78
    s_cbranch_scc1 LKV_p2_done
    s_waitcnt lgkmcnt(0)
    v_add_u32 v212, 147456, v214
    ds_read_b64 v[216:217], v212 offset:0
    ds_read_b64 v[218:219], v212 offset:256
    ds_read_b64 v[220:221], v212 offset:512
    ds_read_b64 v[222:223], v212 offset:768
    ds_read_b64 v[224:225], v212 offset:1024
    ds_read_b64 v[226:227], v212 offset:1280
    ds_read_b64 v[228:229], v212 offset:1536
    ds_read_b64 v[230:231], v212 offset:1792
    s_waitcnt lgkmcnt(6)
    v_pk_add_f32 v[216:217], v[216:217], v[218:219]
    s_waitcnt lgkmcnt(5)
    v_pk_add_f32 v[216:217], v[216:217], v[220:221]
    s_waitcnt lgkmcnt(4)
    v_pk_add_f32 v[216:217], v[216:217], v[222:223]
    s_waitcnt lgkmcnt(3)
    v_pk_add_f32 v[216:217], v[216:217], v[224:225]
    s_waitcnt lgkmcnt(2)
    v_pk_add_f32 v[216:217], v[216:217], v[226:227]
    s_waitcnt lgkmcnt(1)
    v_pk_add_f32 v[216:217], v[216:217], v[228:229]
    s_waitcnt lgkmcnt(0)
    v_pk_add_f32 v[216:217], v[216:217], v[230:231]
    s_add_u32 s56, s24, 0x1128000
    s_addc_u32 s57, s25, 0
    s_and_b32 s57, s57, 0xffff
    s_mov_b32 s58, 0x4e00
    s_mov_b32 s59, 0x00020000
    s_lshl_b32 s55, s2, 8
    v_add_u32 v210, s55, v214
    v_mov_b32 v213, 0x7fffff00
    v_cmp_gt_u32 vcc, 32, v209
    s_nop 1
    v_cndmask_b32 v210, v213, v210, vcc
    buffer_store_dwordx2 v[216:217], v210, s[56:59], 0 offen sc1
LKV_p2_done:
    s_add_u32 m0, s46, 0x0
    s_nop 0
    buffer_load_dwordx4 v192, s[32:35], s45 offen lds
    s_add_u32 m0, s46, 0x2000
    s_nop 0
    buffer_load_dwordx4 v193, s[32:35], s45 offen lds
    s_add_u32 m0, s46, 0x4000
    s_nop 0
    buffer_load_dwordx4 v194, s[32:35], s45 offen lds
    s_add_u32 s45, s45, 122880
    ds_read_b128 v[96:99], v197 offset:16384
    ds_read_b64_tr_b16 v[104:105], v199 offset:49152
    ds_read_b64_tr_b16 v[106:107], v199 offset:49664
    ds_read_b128 v[100:103], v197 offset:18432
    ds_read_b64_tr_b16 v[108:109], v201 offset:49152
    ds_read_b64_tr_b16 v[110:111], v201 offset:49664
    ds_read_b64_tr_b16 v[112:113], v203 offset:49152
    ds_read_b64_tr_b16 v[114:115], v203 offset:49664
    ds_read_b64_tr_b16 v[116:117], v205 offset:49152
    ds_read_b64_tr_b16 v[118:119], v205 offset:49664
    ds_read_b64_tr_b16 v[120:121], v199 offset:53248
    ds_read_b64_tr_b16 v[122:123], v199 offset:53760
    ds_read_b64_tr_b16 v[124:125], v199 offset:57344
    ds_read_b64_tr_b16 v[126:127], v199 offset:57856
    ds_read_b64_tr_b16 v[128:129], v201 offset:57344
    ds_read_b64_tr_b16 v[130:131], v201 offset:57856
    ds_read_b64_tr_b16 v[132:133], v203 offset:57344
    ds_read_b64_tr_b16 v[134:135], v203 offset:57856
    ds_read_b64_tr_b16 v[136:137], v205 offset:57344
    ds_read_b64_tr_b16 v[138:139], v205 offset:57856
    ds_read_b64_tr_b16 v[140:141], v199 offset:61440
    ds_read_b64_tr_b16 v[142:143], v199 offset:61952
    s_waitcnt lgkmcnt(15)
    v_mfma_f32_16x16x32_bf16 v[0:3], v[152:155], v[144:147], v[0:3]
    s_waitcnt lgkmcnt(15)
    v_mfma_f32_16x16x32_bf16 v[4:7], v[152:155], v[148:151], v[4:7]
    s_waitcnt lgkmcnt(15)
    v_mfma_f32_16x16x32_bf16 v[8:11], v[156:159], v[144:147], v[8:11]
    v_mfma_f32_16x16x32_bf16 v[12:15], v[156:159], v[148:151], v[12:15]
    s_waitcnt lgkmcnt(15)
    v_mfma_f32_16x16x32_bf16 v[16:19], v[160:163], v[144:147], v[16:19]
    v_mfma_f32_16x16x32_bf16 v[20:23], v[160:163], v[148:151], v[20:23]
    s_waitcnt lgkmcnt(15)
    v_mfma_f32_16x16x32_bf16 v[24:27], v[164:167], v[144:147], v[24:27]
    v_mfma_f32_16x16x32_bf16 v[28:31], v[164:167], v[148:151], v[28:31]
    s_waitcnt lgkmcnt(15)
    v_mfma_f32_16x16x32_bf16 v[32:35], v[168:171], v[144:147], v[32:35]
    v_mfma_f32_16x16x32_bf16 v[36:39], v[168:171], v[148:151], v[36:39]
    s_waitcnt lgkmcnt(15)
    v_mfma_f32_16x16x32_bf16 v[40:43], v[144:147], v[172:175], v[40:43]
    v_mfma_f32_16x16x32_bf16 v[44:47], v[148:151], v[172:175], v[44:47]
    s_waitcnt lgkmcnt(15)
    v_mfma_f32_16x16x32_bf16 v[48:51], v[144:147], v[176:179], v[48:51]
    v_mfma_f32_16x16x32_bf16 v[52:55], v[148:151], v[176:179], v[52:55]
    s_waitcnt lgkmcnt(15)
    v_mfma_f32_16x16x32_bf16 v[56:59], v[144:147], v[180:183], v[56:59]
    v_mfma_f32_16x16x32_bf16 v[60:63], v[148:151], v[180:183], v[60:63]
    s_waitcnt lgkmcnt(15)
    v_mfma_f32_16x16x32_bf16 v[64:67], v[144:147], v[184:187], v[64:67]
    v_mfma_f32_16x16x32_bf16 v[68:71], v[148:151], v[184:187], v[68:71]
    s_waitcnt lgkmcnt(15)
    v_mfma_f32_16x16x32_bf16 v[72:75], v[144:147], v[188:191], v[72:75]
    v_mfma_f32_16x16x32_bf16 v[76:79], v[148:151], v[188:191], v[76:79]
    s_waitcnt vmcnt(3)
    s_barrier
    s_add_u32 m0, s46, 0x18000
    s_nop 0
    buffer_load_dwordx4 v195, s[28:31], s44 offen lds
    s_add_u32 m0, s46, 0x1a000
    s_nop 0
    buffer_load_dwordx4 v196, s[28:31], s44 offen lds
    s_add_u32 s44, s44, 128
    s_add_u32 m0, s46, 0x6000
    s_nop 0
    buffer_load_dwordx4 v192, s[32:35], s45 offen lds
    s_add_u32 m0, s46, 0x8000
    s_nop 0
    buffer_load_dwordx4 v193, s[32:35], s45 offen lds
    s_add_u32 m0, s46, 0xa000
    s_nop 0
    buffer_load_dwordx4 v194, s[32:35], s45 offen lds
    s_add_u32 s45, s45, 122880
    ds_read_b128 v[144:147], v198 offset:16384
    ds_read_b64_tr_b16 v[152:153], v200 offset:8192
    ds_read_b64_tr_b16 v[154:155], v200 offset:8704
    ds_read_b128 v[148:151], v198 offset:18432
    ds_read_b64_tr_b16 v[156:157], v202 offset:8192
    ds_read_b64_tr_b16 v[158:159], v202 offset:8704
    ds_read_b64_tr_b16 v[160:161], v204 offset:8192
    ds_read_b64_tr_b16 v[162:163], v204 offset:8704
    ds_read_b64_tr_b16 v[164:165], v206 offset:8192
    ds_read_b64_tr_b16 v[166:167], v206 offset:8704
    ds_read_b64_tr_b16 v[168:169], v200 offset:12288
    ds_read_b64_tr_b16 v[170:171], v200 offset:12800
    ds_read_b64_tr_b16 v[172:173], v200 offset:16384
    ds_read_b64_tr_b16 v[174:175], v200 offset:16896
    ds_read_b64_tr_b16 v[176:177], v202 offset:16384
    ds_read_b64_tr_b16 v[178:179], v202 offset:16896
    ds_read_b64_tr_b16 v[180:181], v204 offset:16384
    ds_read_b64_tr_b16 v[182:183], v204 offset:16896
    ds_read_b64_tr_b16 v[184:185], v206 offset:16384
    ds_read_b64_tr_b16 v[186:187], v206 offset:16896
    ds_read_b64_tr_b16 v[188:189], v200 offset:20480
    ds_read_b64_tr_b16 v[190:191], v200 offset:20992
    s_waitcnt lgkmcnt(15)
    v_mfma_f32_16x16x32_bf16 v[0:3], v[104:107], v[96:99], v[0:3]
    s_waitcnt lgkmcnt(15)
    v_mfma_f32_16x16x32_bf16 v[4:7], v[104:107], v[100:103], v[4:7]
    s_waitcnt lgkmcnt(15)
    v_mfma_f32_16x16x32_bf16 v[8:11], v[108:111], v[96:99], v[8:11]
    v_mfma_f32_16x16x32_bf16 v[12:15], v[108:111], v[100:103], v[12:15]
    s_waitcnt lgkmcnt(15)
    v_mfma_f32_16x16x32_bf16 v[16:19], v[112:115], v[96:99], v[16:19]
    v_mfma_f32_16x16x32_bf16 v[20:23], v[112:115], v[100:103], v[20:23]
    s_waitcnt lgkmcnt(15)
    v_mfma_f32_16x16x32_bf16 v[24:27], v[116:119], v[96:99], v[24:27]
    v_mfma_f32_16x16x32_bf16 v[28:31], v[116:119], v[100:103], v[28:31]
    s_waitcnt lgkmcnt(15)
    v_mfma_f32_16x16x32_bf16 v[32:35], v[120:123], v[96:99], v[32:35]
    v_mfma_f32_16x16x32_bf16 v[36:39], v[120:123], v[100:103], v[36:39]
    s_waitcnt lgkmcnt(15)
    v_mfma_f32_16x16x32_bf16 v[40:43], v[96:99], v[124:127], v[40:43]
    v_mfma_f32_16x16x32_bf16 v[44:47], v[100:103], v[124:127], v[44:47]
    s_waitcnt lgkmcnt(15)
    v_mfma_f32_16x16x32_bf16 v[48:51], v[96:99], v[128:131], v[48:51]
    v_mfma_f32_16x16x32_bf16 v[52:55], v[100:103], v[128:131], v[52:55]
    s_waitcnt lgkmcnt(15)
    v_mfma_f32_16x16x32_bf16 v[56:59], v[96:99], v[132:135], v[56:59]
    v_mfma_f32_16x16x32_bf16 v[60:63], v[100:103], v[132:135], v[60:63]
    s_waitcnt lgkmcnt(15)
    v_mfma_f32_16x16x32_bf16 v[64:67], v[96:99], v[136:139], v[64:67]
    v_mfma_f32_16x16x32_bf16 v[68:71], v[100:103], v[136:139], v[68:71]
    s_waitcnt lgkmcnt(15)
    v_mfma_f32_16x16x32_bf16 v[72:75], v[96:99], v[140:143], v[72:75]
    v_mfma_f32_16x16x32_bf16 v[76:79], v[100:103], v[140:143], v[76:79]
    s_waitcnt vmcnt(5)
    s_barrier
    s_add_u32 m0, s46, 0xc000
    s_nop 0
    buffer_load_dwordx4 v192, s[32:35], s45 offen lds
    s_add_u32 m0, s46, 0xe000
    s_nop 0
    buffer_load_dwordx4 v193, s[32:35], s45 offen lds
    s_add_u32 m0, s46, 0x10000
    s_nop 0
    buffer_load_dwordx4 v194, s[32:35], s45 offen lds
    s_add_u32 s45, s45, 122880
    ds_read_b128 v[96:99], v197 offset:32768
    ds_read_b64_tr_b16 v[104:105], v199 offset:0
    ds_read_b64_tr_b16 v[106:107], v199 offset:512
    ds_read_b128 v[100:103], v197 offset:34816
    ds_read_b64_tr_b16 v[108:109], v201 offset:0
    ds_read_b64_tr_b16 v[110:111], v201 offset:512
    ds_read_b64_tr_b16 v[112:113], v203 offset:0
    ds_read_b64_tr_b16 v[114:115], v203 offset:512
    ds_read_b64_tr_b16 v[116:117], v205 offset:0
    ds_read_b64_tr_b16 v[118:119], v205 offset:512
    ds_read_b64_tr_b16 v[120:121], v199 offset:4096
    ds_read_b64_tr_b16 v[122:123], v199 offset:4608
    ds_read_b64_tr_b16 v[124:125], v199 offset:8192
    ds_read_b64_tr_b16 v[126:127], v199 offset:8704
    ds_read_b64_tr_b16 v[128:129], v201 offset:8192
    ds_read_b64_tr_b16 v[130:131], v201 offset:8704
    ds_read_b64_tr_b16 v[132:133], v203 offset:8192
    ds_read_b64_tr_b16 v[134:135], v203 offset:8704
    ds_read_b64_tr_b16 v[136:137], v205 offset:8192
    ds_read_b64_tr_b16 v[138:139], v205 offset:8704
    ds_read_b64_tr_b16 v[140:141], v199 offset:12288
    ds_read_b64_tr_b16 v[142:143], v199 offset:12800
    s_waitcnt lgkmcnt(15)
    v_mfma_f32_16x16x32_bf16 v[0:3], v[152:155], v[144:147], v[0:3]
    s_waitcnt lgkmcnt(15)
    v_mfma_f32_16x16x32_bf16 v[4:7], v[152:155], v[148:151], v[4:7]
    s_waitcnt lgkmcnt(15)
    v_mfma_f32_16x16x32_bf16 v[8:11], v[156:159], v[144:147], v[8:11]
    v_mfma_f32_16x16x32_bf16 v[12:15], v[156:159], v[148:151], v[12:15]
    s_waitcnt lgkmcnt(15)
    v_mfma_f32_16x16x32_bf16 v[16:19], v[160:163], v[144:147], v[16:19]
    v_mfma_f32_16x16x32_bf16 v[20:23], v[160:163], v[148:151], v[20:23]
    s_waitcnt lgkmcnt(15)
    v_mfma_f32_16x16x32_bf16 v[24:27], v[164:167], v[144:147], v[24:27]
    v_mfma_f32_16x16x32_bf16 v[28:31], v[164:167], v[148:151], v[28:31]
    s_waitcnt lgkmcnt(15)
    v_mfma_f32_16x16x32_bf16 v[32:35], v[168:171], v[144:147], v[32:35]
    v_mfma_f32_16x16x32_bf16 v[36:39], v[168:171], v[148:151], v[36:39]
    s_waitcnt lgkmcnt(15)
    v_mfma_f32_16x16x32_bf16 v[40:43], v[144:147], v[172:175], v[40:43]
    v_mfma_f32_16x16x32_bf16 v[44:47], v[148:151], v[172:175], v[44:47]
    s_waitcnt lgkmcnt(15)
    v_mfma_f32_16x16x32_bf16 v[48:51], v[144:147], v[176:179], v[48:51]
    v_mfma_f32_16x16x32_bf16 v[52:55], v[148:151], v[176:179], v[52:55]
    s_waitcnt lgkmcnt(15)
    v_mfma_f32_16x16x32_bf16 v[56:59], v[144:147], v[180:183], v[56:59]
    v_mfma_f32_16x16x32_bf16 v[60:63], v[148:151], v[180:183], v[60:63]
    s_waitcnt lgkmcnt(15)
    v_mfma_f32_16x16x32_bf16 v[64:67], v[144:147], v[184:187], v[64:67]
    v_mfma_f32_16x16x32_bf16 v[68:71], v[148:151], v[184:187], v[68:71]
    s_waitcnt lgkmcnt(15)
    v_mfma_f32_16x16x32_bf16 v[72:75], v[144:147], v[188:191], v[72:75]
    v_mfma_f32_16x16x32_bf16 v[76:79], v[148:151], v[188:191], v[76:79]
    s_waitcnt vmcnt(3)
    s_barrier
    s_cmp_ge_u32 s2, 220
    s_cbranch_scc1 LKV_sig
    s_cmp_lg_u32 s47, 0
    s_cbranch_scc1 LKV_sig
    v_mov_b32 v210, 1
    v_mov_b32 v211, 0
    s_mov_b64 exec, 1
    buffer_atomic_add v210, v211, s[60:63], 0 offen sc1
    s_mov_b64 exec, -1
LKV_sig:
    s_add_u32 m0, s46, 0x1c000
    s_nop 0
    buffer_load_dwordx4 v195, s[28:31], s44 offen lds
    s_add_u32 m0, s46, 0x1e000
    s_nop 0
    buffer_load_dwordx4 v196, s[28:31], s44 offen lds
    s_add_u32 s44, s44, 128
    s_add_u32 m0, s46, 0x12000
    s_nop 0
    buffer_load_dwordx4 v192, s[32:35], s45 offen lds
    s_add_u32 m0, s46, 0x14000
    s_nop 0
    buffer_load_dwordx4 v193, s[32:35], s45 offen lds
    s_add_u32 m0, s46, 0x16000
    s_nop 0
    buffer_load_dwordx4 v194, s[32:35], s45 offen lds
    s_add_u32 s45, s45, 122880
    ds_read_b128 v[144:147], v198 offset:32768
    ds_read_b64_tr_b16 v[152:153], v199 offset:24576
    ds_read_b64_tr_b16 v[154:155], v199 offset:25088
    ds_read_b128 v[148:151], v198 offset:34816
    ds_read_b64_tr_b16 v[156:157], v201 offset:24576
    ds_read_b64_tr_b16 v[158:159], v201 offset:25088
    ds_read_b64_tr_b16 v[160:161], v203 offset:24576
    ds_read_b64_tr_b16 v[162:163], v203 offset:25088
    ds_read_b64_tr_b16 v[164:165], v205 offset:24576
    ds_read_b64_tr_b16 v[166:167], v205 offset:25088
    ds_read_b64_tr_b16 v[168:169], v199 offset:28672
    ds_read_b64_tr_b16 v[170:171], v199 offset:29184
    ds_read_b64_tr_b16 v[172:173], v199 offset:32768
    ds_read_b64_tr_b16 v[174:175], v199 offset:33280
    ds_read_b64_tr_b16 v[176:177], v201 offset:32768
    ds_read_b64_tr_b16 v[178:179], v201 offset:33280
    ds_read_b64_tr_b16 v[180:181], v203 offset:32768
    ds_read_b64_tr_b16 v[182:183], v203 offset:33280
    ds_read_b64_tr_b16 v[184:185], v205 offset:32768
    ds_read_b64_tr_b16 v[186:187], v205 offset:33280
    ds_read_b64_tr_b16 v[188:189], v199 offset:36864
    ds_read_b64_tr_b16 v[190:191], v199 offset:37376
    s_waitcnt lgkmcnt(15)
    v_mfma_f32_16x16x32_bf16 v[0:3], v[104:107], v[96:99], v[0:3]
    s_waitcnt lgkmcnt(15)
    v_mfma_f32_16x16x32_bf16 v[4:7], v[104:107], v[100:103], v[4:7]
    s_waitcnt lgkmcnt(15)
    v_mfma_f32_16x16x32_bf16 v[8:11], v[108:111], v[96:99], v[8:11]
    v_mfma_f32_16x16x32_bf16 v[12:15], v[108:111], v[100:103], v[12:15]
    s_waitcnt lgkmcnt(15)
    v_mfma_f32_16x16x32_bf16 v[16:19], v[112:115], v[96:99], v[16:19]
    v_mfma_f32_16x16x32_bf16 v[20:23], v[112:115], v[100:103], v[20:23]
    s_waitcnt lgkmcnt(15)
    v_mfma_f32_16x16x32_bf16 v[24:27], v[116:119], v[96:99], v[24:27]
    v_mfma_f32_16x16x32_bf16 v[28:31], v[116:119], v[100:103], v[28:31]
    s_waitcnt lgkmcnt(15)
    v_mfma_f32_16x16x32_bf16 v[32:35], v[120:123], v[96:99], v[32:35]
    v_mfma_f32_16x16x32_bf16 v[36:39], v[120:123], v[100:103], v[36:39]
    s_waitcnt lgkmcnt(15)
    v_mfma_f32_16x16x32_bf16 v[40:43], v[96:99], v[124:127], v[40:43]
    v_mfma_f32_16x16x32_bf16 v[44:47], v[100:103], v[124:127], v[44:47]
    s_waitcnt lgkmcnt(15)
    v_mfma_f32_16x16x32_bf16 v[48:51], v[96:99], v[128:131], v[48:51]
    v_mfma_f32_16x16x32_bf16 v[52:55], v[100:103], v[128:131], v[52:55]
    s_waitcnt lgkmcnt(15)
    v_mfma_f32_16x16x32_bf16 v[56:59], v[96:99], v[132:135], v[56:59]
    v_mfma_f32_16x16x32_bf16 v[60:63], v[100:103], v[132:135], v[60:63]
    s_waitcnt lgkmcnt(15)
    v_mfma_f32_16x16x32_bf16 v[64:67], v[96:99], v[136:139], v[64:67]
    v_mfma_f32_16x16x32_bf16 v[68:71], v[100:103], v[136:139], v[68:71]
    s_waitcnt lgkmcnt(15)
    v_mfma_f32_16x16x32_bf16 v[72:75], v[96:99], v[140:143], v[72:75]
    v_mfma_f32_16x16x32_bf16 v[76:79], v[100:103], v[140:143], v[76:79]
    s_waitcnt vmcnt(5)
    s_barrier
    s_add_u32 m0, s46, 0x0
    s_nop 0
    buffer_load_dwordx4 v192, s[32:35], s45 offen lds
    s_add_u32 m0, s46, 0x2000
    s_nop 0
    buffer_load_dwordx4 v193, s[32:35], s45 offen lds
    s_add_u32 m0, s46, 0x4000
    s_nop 0
    buffer_load_dwordx4 v194, s[32:35], s45 offen lds
    s_add_u32 s45, s45, 122880
    ds_read_b128 v[96:99], v197 offset:0
    ds_read_b64_tr_b16 v[104:105], v199 offset:49152
    ds_read_b64_tr_b16 v[106:107], v199 offset:49664
    ds_read_b128 v[100:103], v197 offset:2048
    ds_read_b64_tr_b16 v[108:109], v201 offset:49152
    ds_read_b64_tr_b16 v[110:111], v201 offset:49664
    ds_read_b64_tr_b16 v[112:113], v203 offset:49152
    ds_read_b64_tr_b16 v[114:115], v203 offset:49664
    ds_read_b64_tr_b16 v[116:117], v205 offset:49152
    ds_read_b64_tr_b16 v[118:119], v205 offset:49664
    ds_read_b64_tr_b16 v[120:121], v199 offset:53248
    ds_read_b64_tr_b16 v[122:123], v199 offset:53760
    ds_read_b64_tr_b16 v[124:125], v199 offset:57344
    ds_read_b64_tr_b16 v[126:127], v199 offset:57856
    ds_read_b64_tr_b16 v[128:129], v201 offset:57344
    ds_read_b64_tr_b16 v[130:131], v201 offset:57856
    ds_read_b64_tr_b16 v[132:133], v203 offset:57344
    ds_read_b64_tr_b16 v[134:135], v203 offset:57856
    ds_read_b64_tr_b16 v[136:137], v205 offset:57344
    ds_read_b64_tr_b16 v[138:139], v205 offset:57856
    ds_read_b64_tr_b16 v[140:141], v199 offset:61440
    ds_read_b64_tr_b16 v[142:143], v199 offset:61952
    s_waitcnt lgkmcnt(15)
    v_mfma_f32_16x16x32_bf16 v[0:3], v[152:155], v[144:147], v[0:3]
    s_waitcnt lgkmcnt(15)
    v_mfma_f32_16x16x32_bf16 v[4:7], v[152:155], v[148:151], v[4:7]
    s_waitcnt lgkmcnt(15)
    v_mfma_f32_16x16x32_bf16 v[8:11], v[156:159], v[144:147], v[8:11]
    v_mfma_f32_16x16x32_bf16 v[12:15], v[156:159], v[148:151], v[12:15]
    s_waitcnt lgkmcnt(15)
    v_mfma_f32_16x16x32_bf16 v[16:19], v[160:163], v[144:147], v[16:19]
    v_mfma_f32_16x16x32_bf16 v[20:23], v[160:163], v[148:151], v[20:23]
    s_waitcnt lgkmcnt(15)
    v_mfma_f32_16x16x32_bf16 v[24:27], v[164:167], v[144:147], v[24:27]
    v_mfma_f32_16x16x32_bf16 v[28:31], v[164:167], v[148:151], v[28:31]
    s_waitcnt lgkmcnt(15)
    v_mfma_f32_16x16x32_bf16 v[32:35], v[168:171], v[144:147], v[32:35]
    v_mfma_f32_16x16x32_bf16 v[36:39], v[168:171], v[148:151], v[36:39]
    s_waitcnt lgkmcnt(15)
    v_mfma_f32_16x16x32_bf16 v[40:43], v[144:147], v[172:175], v[40:43]
    v_mfma_f32_16x16x32_bf16 v[44:47], v[148:151], v[172:175], v[44:47]
    s_waitcnt lgkmcnt(15)
    v_mfma_f32_16x16x32_bf16 v[48:51], v[144:147], v[176:179], v[48:51]
    v_mfma_f32_16x16x32_bf16 v[52:55], v[148:151], v[176:179], v[52:55]
    s_waitcnt lgkmcnt(15)
    v_mfma_f32_16x16x32_bf16 v[56:59], v[144:147], v[180:183], v[56:59]
    v_mfma_f32_16x16x32_bf16 v[60:63], v[148:151], v[180:183], v[60:63]
    s_waitcnt lgkmcnt(15)
    v_mfma_f32_16x16x32_bf16 v[64:67], v[144:147], v[184:187], v[64:67]
    v_mfma_f32_16x16x32_bf16 v[68:71], v[148:151], v[184:187], v[68:71]
    s_waitcnt lgkmcnt(15)
    v_mfma_f32_16x16x32_bf16 v[72:75], v[144:147], v[188:191], v[72:75]
    v_mfma_f32_16x16x32_bf16 v[76:79], v[148:151], v[188:191], v[76:79]
    s_waitcnt vmcnt(3)
    s_barrier
    s_add_u32 m0, s46, 0x20000
    s_nop 0
    buffer_load_dwordx4 v195, s[28:31], s44 offen lds
    s_add_u32 m0, s46, 0x22000
    s_nop 0
    buffer_load_dwordx4 v196, s[28:31], s44 offen lds
    s_add_u32 s44, s44, 128
    s_add_u32 m0, s46, 0x6000
    s_nop 0
    buffer_load_dwordx4 v192, s[32:35], s45 offen lds
    s_add_u32 m0, s46, 0x8000
    s_nop 0
    buffer_load_dwordx4 v193, s[32:35], s45 offen lds
    s_add_u32 m0, s46, 0xa000
    s_nop 0
    buffer_load_dwordx4 v194, s[32:35], s45 offen lds
    s_add_u32 s45, s45, 122880
    ds_read_b128 v[144:147], v198 offset:0
    ds_read_b64_tr_b16 v[152:153], v200 offset:8192
    ds_read_b64_tr_b16 v[154:155], v200 offset:8704
    ds_read_b128 v[148:151], v198 offset:2048
    ds_read_b64_tr_b16 v[156:157], v202 offset:8192
    ds_read_b64_tr_b16 v[158:159], v202 offset:8704
    ds_read_b64_tr_b16 v[160:161], v204 offset:8192
    ds_read_b64_tr_b16 v[162:163], v204 offset:8704
    ds_read_b64_tr_b16 v[164:165], v206 offset:8192
    ds_read_b64_tr_b16 v[166:167], v206 offset:8704
    ds_read_b64_tr_b16 v[168:169], v200 offset:12288
    ds_read_b64_tr_b16 v[170:171], v200 offset:12800
    ds_read_b64_tr_b16 v[172:173], v200 offset:16384
    ds_read_b64_tr_b16 v[174:175], v200 offset:16896
    ds_read_b64_tr_b16 v[176:177], v202 offset:16384
    ds_read_b64_tr_b16 v[178:179], v202 offset:16896
    ds_read_b64_tr_b16 v[180:181], v204 offset:16384
    ds_read_b64_tr_b16 v[182:183], v204 offset:16896
    ds_read_b64_tr_b16 v[184:185], v206 offset:16384
    ds_read_b64_tr_b16 v[186:187], v206 offset:16896
    ds_read_b64_tr_b16 v[188:189], v200 offset:20480
    ds_read_b64_tr_b16 v[190:191], v200 offset:20992
    s_waitcnt lgkmcnt(15)
    v_mfma_f32_16x16x32_bf16 v[0:3], v[104:107], v[96:99], v[0:3]
    s_waitcnt lgkmcnt(15)
    v_mfma_f32_16x16x32_bf16 v[4:7], v[104:107], v[100:103], v[4:7]
    s_waitcnt lgkmcnt(15)
    v_mfma_f32_16x16x32_bf16 v[8:11], v[108:111], v[96:99], v[8:11]
    v_mfma_f32_16x16x32_bf16 v[12:15], v[108:111], v[100:103], v[12:15]
    s_waitcnt lgkmcnt(15)
    v_mfma_f32_16x16x32_bf16 v[16:19], v[112:115], v[96:99], v[16:19]
    v_mfma_f32_16x16x32_bf16 v[20:23], v[112:115], v[100:103], v[20:23]
    s_waitcnt lgkmcnt(15)
    v_mfma_f32_16x16x32_bf16 v[24:27], v[116:119], v[96:99], v[24:27]
    v_mfma_f32_16x16x32_bf16 v[28:31], v[116:119], v[100:103], v[28:31]
    s_waitcnt lgkmcnt(15)
    v_mfma_f32_16x16x32_bf16 v[32:35], v[120:123], v[96:99], v[32:35]
    v_mfma_f32_16x16x32_bf16 v[36:39], v[120:123], v[100:103], v[36:39]
    s_waitcnt lgkmcnt(15)
    v_mfma_f32_16x16x32_bf16 v[40:43], v[96:99], v[124:127], v[40:43]
    v_mfma_f32_16x16x32_bf16 v[44:47], v[100:103], v[124:127], v[44:47]
    s_waitcnt lgkmcnt(15)
    v_mfma_f32_16x16x32_bf16 v[48:51], v[96:99], v[128:131], v[48:51]
    v_mfma_f32_16x16x32_bf16 v[52:55], v[100:103], v[128:131], v[52:55]
    s_waitcnt lgkmcnt(15)
    v_mfma_f32_16x16x32_bf16 v[56:59], v[96:99], v[132:135], v[56:59]
    v_mfma_f32_16x16x32_bf16 v[60:63], v[100:103], v[132:135], v[60:63]
    s_waitcnt lgkmcnt(15)
    v_mfma_f32_16x16x32_bf16 v[64:67], v[96:99], v[136:139], v[64:67]
    v_mfma_f32_16x16x32_bf16 v[68:71], v[100:103], v[136:139], v[68:71]
    s_waitcnt lgkmcnt(15)
    v_mfma_f32_16x16x32_bf16 v[72:75], v[96:99], v[140:143], v[72:75]
    v_mfma_f32_16x16x32_bf16 v[76:79], v[100:103], v[140:143], v[76:79]
    s_waitcnt vmcnt(5)
    s_barrier
    s_add_u32 m0, s46, 0xc000
    s_nop 0
    buffer_load_dwordx4 v192, s[32:35], s45 offen lds
    s_add_u32 m0, s46, 0xe000
    s_nop 0
    buffer_load_dwordx4 v193, s[32:35], s45 offen lds
    s_add_u32 m0, s46, 0x10000
    s_nop 0
    buffer_load_dwordx4 v194, s[32:35], s45 offen lds
    s_add_u32 s45, s45, 122880
    ds_read_b128 v[96:99], v197 offset:16384
    ds_read_b64_tr_b16 v[104:105], v199 offset:0
    ds_read_b64_tr_b16 v[106:107], v199 offset:512
    ds_read_b128 v[100:103], v197 offset:18432
    ds_read_b64_tr_b16 v[108:109], v201 offset:0
    ds_read_b64_tr_b16 v[110:111], v201 offset:512
    ds_read_b64_tr_b16 v[112:113], v203 offset:0
    ds_read_b64_tr_b16 v[114:115], v203 offset:512
    ds_read_b64_tr_b16 v[116:117], v205 offset:0
    ds_read_b64_tr_b16 v[118:119], v205 offset:512
    ds_read_b64_tr_b16 v[120:121], v199 offset:4096
    ds_read_b64_tr_b16 v[122:123], v199 offset:4608
    ds_read_b64_tr_b16 v[124:125], v199 offset:8192
    ds_read_b64_tr_b16 v[126:127], v199 offset:8704
    ds_read_b64_tr_b16 v[128:129], v201 offset:8192
    ds_read_b64_tr_b16 v[130:131], v201 offset:8704
    ds_read_b64_tr_b16 v[132:133], v203 offset:8192
    ds_read_b64_tr_b16 v[134:135], v203 offset:8704
    ds_read_b64_tr_b16 v[136:137], v205 offset:8192
    ds_read_b64_tr_b16 v[138:139], v205 offset:8704
    ds_read_b64_tr_b16 v[140:141], v199 offset:12288
    ds_read_b64_tr_b16 v[142:143], v199 offset:12800
    s_waitcnt lgkmcnt(15)
    v_mfma_f32_16x16x32_bf16 v[0:3], v[152:155], v[144:147], v[0:3]
    s_waitcnt lgkmcnt(15)
    v_mfma_f32_16x16x32_bf16 v[4:7], v[152:155], v[148:151], v[4:7]
    s_waitcnt lgkmcnt(15)
    v_mfma_f32_16x16x32_bf16 v[8:11], v[156:159], v[144:147], v[8:11]
    v_mfma_f32_16x16x32_bf16 v[12:15], v[156:159], v[148:151], v[12:15]
    s_waitcnt lgkmcnt(15)
    v_mfma_f32_16x16x32_bf16 v[16:19], v[160:163], v[144:147], v[16:19]
    v_mfma_f32_16x16x32_bf16 v[20:23], v[160:163], v[148:151], v[20:23]
    s_waitcnt lgkmcnt(15)
    v_mfma_f32_16x16x32_bf16 v[24:27], v[164:167], v[144:147], v[24:27]
    v_mfma_f32_16x16x32_bf16 v[28:31], v[164:167], v[148:151], v[28:31]
    s_waitcnt lgkmcnt(15)
    v_mfma_f32_16x16x32_bf16 v[32:35], v[168:171], v[144:147], v[32:35]
    v_mfma_f32_16x16x32_bf16 v[36:39], v[168:171], v[148:151], v[36:39]
    s_waitcnt lgkmcnt(15)
    v_mfma_f32_16x16x32_bf16 v[40:43], v[144:147], v[172:175], v[40:43]
    v_mfma_f32_16x16x32_bf16 v[44:47], v[148:151], v[172:175], v[44:47]
    s_waitcnt lgkmcnt(15)
    v_mfma_f32_16x16x32_bf16 v[48:51], v[144:147], v[176:179], v[48:51]
    v_mfma_f32_16x16x32_bf16 v[52:55], v[148:151], v[176:179], v[52:55]
    s_waitcnt lgkmcnt(15)
    v_mfma_f32_16x16x32_bf16 v[56:59], v[144:147], v[180:183], v[56:59]
    v_mfma_f32_16x16x32_bf16 v[60:63], v[148:151], v[180:183], v[60:63]
    s_waitcnt lgkmcnt(15)
    v_mfma_f32_16x16x32_bf16 v[64:67], v[144:147], v[184:187], v[64:67]
    v_mfma_f32_16x16x32_bf16 v[68:71], v[148:151], v[184:187], v[68:71]
    s_waitcnt lgkmcnt(15)
    v_mfma_f32_16x16x32_bf16 v[72:75], v[144:147], v[188:191], v[72:75]
    v_mfma_f32_16x16x32_bf16 v[76:79], v[148:151], v[188:191], v[76:79]
    s_waitcnt vmcnt(3)
    s_barrier
    s_add_u32 m0, s46, 0x18000
    s_nop 0
    buffer_load_dwordx4 v195, s[28:31], s44 offen lds
    s_add_u32 m0, s46, 0x1a000
    s_nop 0
    buffer_load_dwordx4 v196, s[28:31], s44 offen lds
    s_add_u32 s44, s44, 128
    s_add_u32 m0, s46, 0x12000
    s_nop 0
    buffer_load_dwordx4 v192, s[32:35], s45 offen lds
    s_add_u32 m0, s46, 0x14000
    s_nop 0
    buffer_load_dwordx4 v193, s[32:35], s45 offen lds
    s_add_u32 m0, s46, 0x16000
    s_nop 0
    buffer_load_dwordx4 v194, s[32:35], s45 offen lds
    s_add_u32 s45, s45, 122880
    ds_read_b128 v[144:147], v198 offset:16384
    ds_read_b64_tr_b16 v[152:153], v199 offset:24576
    ds_read_b64_tr_b16 v[154:155], v199 offset:25088
    ds_read_b128 v[148:151], v198 offset:18432
    ds_read_b64_tr_b16 v[156:157], v201 offset:24576
    ds_read_b64_tr_b16 v[158:159], v201 offset:25088
    ds_read_b64_tr_b16 v[160:161], v203 offset:24576
    ds_read_b64_tr_b16 v[162:163], v203 offset:25088
    ds_read_b64_tr_b16 v[164:165], v205 offset:24576
    ds_read_b64_tr_b16 v[166:167], v205 offset:25088
    ds_read_b64_tr_b16 v[168:169], v199 offset:28672
    ds_read_b64_tr_b16 v[170:171], v199 offset:29184
    ds_read_b64_tr_b16 v[172:173], v199 offset:32768
    ds_read_b64_tr_b16 v[174:175], v199 offset:33280
    ds_read_b64_tr_b16 v[176:177], v201 offset:32768
    ds_read_b64_tr_b16 v[178:179], v201 offset:33280
    ds_read_b64_tr_b16 v[180:181], v203 offset:32768
    ds_read_b64_tr_b16 v[182:183], v203 offset:33280
    ds_read_b64_tr_b16 v[184:185], v205 offset:32768
    ds_read_b64_tr_b16 v[186:187], v205 offset:33280
    ds_read_b64_tr_b16 v[188:189], v199 offset:36864
    ds_read_b64_tr_b16 v[190:191], v199 offset:37376
    s_waitcnt lgkmcnt(15)
    v_mfma_f32_16x16x32_bf16 v[0:3], v[104:107], v[96:99], v[0:3]
    s_waitcnt lgkmcnt(15)
    v_mfma_f32_16x16x32_bf16 v[4:7], v[104:107], v[100:103], v[4:7]
    s_waitcnt lgkmcnt(15)
    v_mfma_f32_16x16x32_bf16 v[8:11], v[108:111], v[96:99], v[8:11]
    v_mfma_f32_16x16x32_bf16 v[12:15], v[108:111], v[100:103], v[12:15]
    s_waitcnt lgkmcnt(15)
    v_mfma_f32_16x16x32_bf16 v[16:19], v[112:115], v[96:99], v[16:19]
    v_mfma_f32_16x16x32_bf16 v[20:23], v[112:115], v[100:103], v[20:23]
    s_waitcnt lgkmcnt(15)
    v_mfma_f32_16x16x32_bf16 v[24:27], v[116:119], v[96:99], v[24:27]
    v_mfma_f32_16x16x32_bf16 v[28:31], v[116:119], v[100:103], v[28:31]
    s_waitcnt lgkmcnt(15)
    v_mfma_f32_16x16x32_bf16 v[32:35], v[120:123], v[96:99], v[32:35]
    v_mfma_f32_16x16x32_bf16 v[36:39], v[120:123], v[100:103], v[36:39]
    s_waitcnt lgkmcnt(15)
    v_mfma_f32_16x16x32_bf16 v[40:43], v[96:99], v[124:127], v[40:43]
    v_mfma_f32_16x16x32_bf16 v[44:47], v[100:103], v[124:127], v[44:47]
    s_waitcnt lgkmcnt(15)
    v_mfma_f32_16x16x32_bf16 v[48:51], v[96:99], v[128:131], v[48:51]
    v_mfma_f32_16x16x32_bf16 v[52:55], v[100:103], v[128:131], v[52:55]
    s_waitcnt lgkmcnt(15)
    v_mfma_f32_16x16x32_bf16 v[56:59], v[96:99], v[132:135], v[56:59]
    v_mfma_f32_16x16x32_bf16 v[60:63], v[100:103], v[132:135], v[60:63]
    s_waitcnt lgkmcnt(15)
    v_mfma_f32_16x16x32_bf16 v[64:67], v[96:99], v[136:139], v[64:67]
    v_mfma_f32_16x16x32_bf16 v[68:71], v[100:103], v[136:139], v[68:71]
    s_waitcnt lgkmcnt(15)
    v_mfma_f32_16x16x32_bf16 v[72:75], v[96:99], v[140:143], v[72:75]
    v_mfma_f32_16x16x32_bf16 v[76:79], v[100:103], v[140:143], v[76:79]
    s_waitcnt vmcnt(5)
    s_barrier
    s_add_u32 m0, s46, 0x0
    s_nop 0
    buffer_load_dwordx4 v192, s[32:35], s45 offen lds
    s_add_u32 m0, s46, 0x2000
    s_nop 0
    buffer_load_dwordx4 v193, s[32:35], s45 offen lds
    s_add_u32 m0, s46, 0x4000
    s_nop 0
    buffer_load_dwordx4 v194, s[32:35], s45 offen lds
    s_add_u32 s45, s45, 122880
    ds_read_b128 v[96:99], v197 offset:32768
    ds_read_b64_tr_b16 v[104:105], v199 offset:49152
    ds_read_b64_tr_b16 v[106:107], v199 offset:49664
    ds_read_b128 v[100:103], v197 offset:34816
    ds_read_b64_tr_b16 v[108:109], v201 offset:49152
    ds_read_b64_tr_b16 v[110:111], v201 offset:49664
    ds_read_b64_tr_b16 v[112:113], v203 offset:49152
    ds_read_b64_tr_b16 v[114:115], v203 offset:49664
    ds_read_b64_tr_b16 v[116:117], v205 offset:49152
    ds_read_b64_tr_b16 v[118:119], v205 offset:49664
    ds_read_b64_tr_b16 v[120:121], v199 offset:53248
    ds_read_b64_tr_b16 v[122:123], v199 offset:53760
    ds_read_b64_tr_b16 v[124:125], v199 offset:57344
    ds_read_b64_tr_b16 v[126:127], v199 offset:57856
    ds_read_b64_tr_b16 v[128:129], v201 offset:57344
    ds_read_b64_tr_b16 v[130:131], v201 offset:57856
    ds_read_b64_tr_b16 v[132:133], v203 offset:57344
    ds_read_b64_tr_b16 v[134:135], v203 offset:57856
    ds_read_b64_tr_b16 v[136:137], v205 offset:57344
    ds_read_b64_tr_b16 v[138:139], v205 offset:57856
    ds_read_b64_tr_b16 v[140:141], v199 offset:61440
    ds_read_b64_tr_b16 v[142:143], v199 offset:61952
    s_waitcnt lgkmcnt(15)
    v_mfma_f32_16x16x32_bf16 v[0:3], v[152:155], v[144:147], v[0:3]
    s_waitcnt lgkmcnt(15)
    v_mfma_f32_16x16x32_bf16 v[4:7], v[152:155], v[148:151], v[4:7]
    s_waitcnt lgkmcnt(15)
    v_mfma_f32_16x16x32_bf16 v[8:11], v[156:159], v[144:147], v[8:11]
    v_mfma_f32_16x16x32_bf16 v[12:15], v[156:159], v[148:151], v[12:15]
    s_waitcnt lgkmcnt(15)
    v_mfma_f32_16x16x32_bf16 v[16:19], v[160:163], v[144:147], v[16:19]
    v_mfma_f32_16x16x32_bf16 v[20:23], v[160:163], v[148:151], v[20:23]
    s_waitcnt lgkmcnt(15)
    v_mfma_f32_16x16x32_bf16 v[24:27], v[164:167], v[144:147], v[24:27]
    v_mfma_f32_16x16x32_bf16 v[28:31], v[164:167], v[148:151], v[28:31]
    s_waitcnt lgkmcnt(15)
    v_mfma_f32_16x16x32_bf16 v[32:35], v[168:171], v[144:147], v[32:35]
    v_mfma_f32_16x16x32_bf16 v[36:39], v[168:171], v[148:151], v[36:39]
    s_waitcnt lgkmcnt(15)
    v_mfma_f32_16x16x32_bf16 v[40:43], v[144:147], v[172:175], v[40:43]
    v_mfma_f32_16x16x32_bf16 v[44:47], v[148:151], v[172:175], v[44:47]
    s_waitcnt lgkmcnt(15)
    v_mfma_f32_16x16x32_bf16 v[48:51], v[144:147], v[176:179], v[48:51]
    v_mfma_f32_16x16x32_bf16 v[52:55], v[148:151], v[176:179], v[52:55]
    s_waitcnt lgkmcnt(15)
    v_mfma_f32_16x16x32_bf16 v[56:59], v[144:147], v[180:183], v[56:59]
    v_mfma_f32_16x16x32_bf16 v[60:63], v[148:151], v[180:183], v[60:63]
    s_waitcnt lgkmcnt(15)
    v_mfma_f32_16x16x32_bf16 v[64:67], v[144:147], v[184:187], v[64:67]
    v_mfma_f32_16x16x32_bf16 v[68:71], v[148:151], v[184:187], v[68:71]
    s_waitcnt lgkmcnt(15)
    v_mfma_f32_16x16x32_bf16 v[72:75], v[144:147], v[188:191], v[72:75]
    v_mfma_f32_16x16x32_bf16 v[76:79], v[148:151], v[188:191], v[76:79]
    s_waitcnt vmcnt(3)
    s_barrier
    s_add_u32 m0, s46, 0x1c000
    s_nop 0
    buffer_load_dwordx4 v195, s[28:31], s44 offen lds
    s_add_u32 m0, s46, 0x1e000
    s_nop 0
    buffer_load_dwordx4 v196, s[28:31], s44 offen lds
    s_add_u32 s44, s44, 128
    s_add_u32 m0, s46, 0x6000
    s_nop 0
    buffer_load_dwordx4 v192, s[32:35], s45 offen lds
    s_add_u32 m0, s46, 0x8000
    s_nop 0
    buffer_load_dwordx4 v193, s[32:35], s45 offen lds
    s_add_u32 m0, s46, 0xa000
    s_nop 0
    buffer_load_dwordx4 v194, s[32:35], s45 offen lds
    s_add_u32 s45, s45, 122880
    ds_read_b128 v[144:147], v198 offset:32768
    ds_read_b64_tr_b16 v[152:153], v200 offset:8192
    ds_read_b64_tr_b16 v[154:155], v200 offset:8704
    ds_read_b128 v[148:151], v198 offset:34816
    ds_read_b64_tr_b16 v[156:157], v202 offset:8192
    ds_read_b64_tr_b16 v[158:159], v202 offset:8704
    ds_read_b64_tr_b16 v[160:161], v204 offset:8192
    ds_read_b64_tr_b16 v[162:163], v204 offset:8704
    ds_read_b64_tr_b16 v[164:165], v206 offset:8192
    ds_read_b64_tr_b16 v[166:167], v206 offset:8704
    ds_read_b64_tr_b16 v[168:169], v200 offset:12288
    ds_read_b64_tr_b16 v[170:171], v200 offset:12800
    ds_read_b64_tr_b16 v[172:173], v200 offset:16384
    ds_read_b64_tr_b16 v[174:175], v200 offset:16896
    ds_read_b64_tr_b16 v[176:177], v202 offset:16384
    ds_read_b64_tr_b16 v[178:179], v202 offset:16896
    ds_read_b64_tr_b16 v[180:181], v204 offset:16384
    ds_read_b64_tr_b16 v[182:183], v204 offset:16896
    ds_read_b64_tr_b16 v[184:185], v206 offset:16384
    ds_read_b64_tr_b16 v[186:187], v206 offset:16896
    ds_read_b64_tr_b16 v[188:189], v200 offset:20480
    ds_read_b64_tr_b16 v[190:191], v200 offset:20992
    s_waitcnt lgkmcnt(15)
    v_mfma_f32_16x16x32_bf16 v[0:3], v[104:107], v[96:99], v[0:3]
    s_waitcnt lgkmcnt(15)
    v_mfma_f32_16x16x32_bf16 v[4:7], v[104:107], v[100:103], v[4:7]
    s_waitcnt lgkmcnt(15)
    v_mfma_f32_16x16x32_bf16 v[8:11], v[108:111], v[96:99], v[8:11]
    v_mfma_f32_16x16x32_bf16 v[12:15], v[108:111], v[100:103], v[12:15]
    s_waitcnt lgkmcnt(15)
    v_mfma_f32_16x16x32_bf16 v[16:19], v[112:115], v[96:99], v[16:19]
    v_mfma_f32_16x16x32_bf16 v[20:23], v[112:115], v[100:103], v[20:23]
    s_waitcnt lgkmcnt(15)
    v_mfma_f32_16x16x32_bf16 v[24:27], v[116:119], v[96:99], v[24:27]
    v_mfma_f32_16x16x32_bf16 v[28:31], v[116:119], v[100:103], v[28:31]
    s_waitcnt lgkmcnt(15)
    v_mfma_f32_16x16x32_bf16 v[32:35], v[120:123], v[96:99], v[32:35]
    v_mfma_f32_16x16x32_bf16 v[36:39], v[120:123], v[100:103], v[36:39]
    s_waitcnt lgkmcnt(15)
    v_mfma_f32_16x16x32_bf16 v[40:43], v[96:99], v[124:127], v[40:43]
    v_mfma_f32_16x16x32_bf16 v[44:47], v[100:103], v[124:127], v[44:47]
    s_waitcnt lgkmcnt(15)
    v_mfma_f32_16x16x32_bf16 v[48:51], v[96:99], v[128:131], v[48:51]
    v_mfma_f32_16x16x32_bf16 v[52:55], v[100:103], v[128:131], v[52:55]
    s_waitcnt lgkmcnt(15)
    v_mfma_f32_16x16x32_bf16 v[56:59], v[96:99], v[132:135], v[56:59]
    v_mfma_f32_16x16x32_bf16 v[60:63], v[100:103], v[132:135], v[60:63]
    s_waitcnt lgkmcnt(15)
    v_mfma_f32_16x16x32_bf16 v[64:67], v[96:99], v[136:139], v[64:67]
    v_mfma_f32_16x16x32_bf16 v[68:71], v[100:103], v[136:139], v[68:71]
    s_waitcnt lgkmcnt(15)
    v_mfma_f32_16x16x32_bf16 v[72:75], v[96:99], v[140:143], v[72:75]
    v_mfma_f32_16x16x32_bf16 v[76:79], v[100:103], v[140:143], v[76:79]
    s_waitcnt vmcnt(5)
    s_barrier
    s_add_u32 m0, s46, 0xc000
    s_nop 0
    buffer_load_dwordx4 v192, s[32:35], s45 offen lds
    s_add_u32 m0, s46, 0xe000
    s_nop 0
    buffer_load_dwordx4 v193, s[32:35], s45 offen lds
    s_add_u32 m0, s46, 0x10000
    s_nop 0
    buffer_load_dwordx4 v194, s[32:35], s45 offen lds
    s_add_u32 s45, s45, 122880
    ds_read_b128 v[96:99], v197 offset:0
    ds_read_b64_tr_b16 v[104:105], v199 offset:0
    ds_read_b64_tr_b16 v[106:107], v199 offset:512
    ds_read_b128 v[100:103], v197 offset:2048
    ds_read_b64_tr_b16 v[108:109], v201 offset:0
    ds_read_b64_tr_b16 v[110:111], v201 offset:512
    ds_read_b64_tr_b16 v[112:113], v203 offset:0
    ds_read_b64_tr_b16 v[114:115], v203 offset:512
    ds_read_b64_tr_b16 v[116:117], v205 offset:0
    ds_read_b64_tr_b16 v[118:119], v205 offset:512
    ds_read_b64_tr_b16 v[120:121], v199 offset:4096
    ds_read_b64_tr_b16 v[122:123], v199 offset:4608
    ds_read_b64_tr_b16 v[124:125], v199 offset:8192
    ds_read_b64_tr_b16 v[126:127], v199 offset:8704
    ds_read_b64_tr_b16 v[128:129], v201 offset:8192
    ds_read_b64_tr_b16 v[130:131], v201 offset:8704
    ds_read_b64_tr_b16 v[132:133], v203 offset:8192
    ds_read_b64_tr_b16 v[134:135], v203 offset:8704
    ds_read_b64_tr_b16 v[136:137], v205 offset:8192
    ds_read_b64_tr_b16 v[138:139], v205 offset:8704
    ds_read_b64_tr_b16 v[140:141], v199 offset:12288
    ds_read_b64_tr_b16 v[142:143], v199 offset:12800
    s_waitcnt lgkmcnt(15)
    v_mfma_f32_16x16x32_bf16 v[0:3], v[152:155], v[144:147], v[0:3]
    s_waitcnt lgkmcnt(15)
    v_mfma_f32_16x16x32_bf16 v[4:7], v[152:155], v[148:151], v[4:7]
    s_waitcnt lgkmcnt(15)
    v_mfma_f32_16x16x32_bf16 v[8:11], v[156:159], v[144:147], v[8:11]
    v_mfma_f32_16x16x32_bf16 v[12:15], v[156:159], v[148:151], v[12:15]
    s_waitcnt lgkmcnt(15)
    v_mfma_f32_16x16x32_bf16 v[16:19], v[160:163], v[144:147], v[16:19]
    v_mfma_f32_16x16x32_bf16 v[20:23], v[160:163], v[148:151], v[20:23]
    s_waitcnt lgkmcnt(15)
    v_mfma_f32_16x16x32_bf16 v[24:27], v[164:167], v[144:147], v[24:27]
    v_mfma_f32_16x16x32_bf16 v[28:31], v[164:167], v[148:151], v[28:31]
    s_waitcnt lgkmcnt(15)
    v_mfma_f32_16x16x32_bf16 v[32:35], v[168:171], v[144:147], v[32:35]
    v_mfma_f32_16x16x32_bf16 v[36:39], v[168:171], v[148:151], v[36:39]
    s_waitcnt lgkmcnt(15)
    v_mfma_f32_16x16x32_bf16 v[40:43], v[144:147], v[172:175], v[40:43]
    v_mfma_f32_16x16x32_bf16 v[44:47], v[148:151], v[172:175], v[44:47]
    s_waitcnt lgkmcnt(15)
    v_mfma_f32_16x16x32_bf16 v[48:51], v[144:147], v[176:179], v[48:51]
    v_mfma_f32_16x16x32_bf16 v[52:55], v[148:151], v[176:179], v[52:55]
    s_waitcnt lgkmcnt(15)
    v_mfma_f32_16x16x32_bf16 v[56:59], v[144:147], v[180:183], v[56:59]
    v_mfma_f32_16x16x32_bf16 v[60:63], v[148:151], v[180:183], v[60:63]
    s_waitcnt lgkmcnt(15)
    v_mfma_f32_16x16x32_bf16 v[64:67], v[144:147], v[184:187], v[64:67]
    v_mfma_f32_16x16x32_bf16 v[68:71], v[148:151], v[184:187], v[68:71]
    s_waitcnt lgkmcnt(15)
    v_mfma_f32_16x16x32_bf16 v[72:75], v[144:147], v[188:191], v[72:75]
    v_mfma_f32_16x16x32_bf16 v[76:79], v[148:151], v[188:191], v[76:79]
    s_waitcnt vmcnt(3)
    s_barrier
    s_add_u32 m0, s46, 0x20000
    s_nop 0
    buffer_load_dwordx4 v195, s[28:31], s44 offen lds
    s_add_u32 m0, s46, 0x22000
    s_nop 0
    buffer_load_dwordx4 v196, s[28:31], s44 offen lds
    s_add_u32 s44, s44, 128
    s_add_u32 m0, s46, 0x12000
    s_nop 0
    buffer_load_dwordx4 v192, s[32:35], s45 offen lds
    s_add_u32 m0, s46, 0x14000
    s_nop 0
    buffer_load_dwordx4 v193, s[32:35], s45 offen lds
    s_add_u32 m0, s46, 0x16000
    s_nop 0
    buffer_load_dwordx4 v194, s[32:35], s45 offen lds
    s_add_u32 s45, s45, 122880
    ds_read_b128 v[144:147], v198 offset:0
    ds_read_b64_tr_b16 v[152:153], v199 offset:24576
    ds_read_b64_tr_b16 v[154:155], v199 offset:25088
    ds_read_b128 v[148:151], v198 offset:2048
    ds_read_b64_tr_b16 v[156:157], v201 offset:24576
    ds_read_b64_tr_b16 v[158:159], v201 offset:25088
    ds_read_b64_tr_b16 v[160:161], v203 offset:24576
    ds_read_b64_tr_b16 v[162:163], v203 offset:25088
    ds_read_b64_tr_b16 v[164:165], v205 offset:24576
    ds_read_b64_tr_b16 v[166:167], v205 offset:25088
    ds_read_b64_tr_b16 v[168:169], v199 offset:28672
    ds_read_b64_tr_b16 v[170:171], v199 offset:29184
    ds_read_b64_tr_b16 v[172:173], v199 offset:32768
    ds_read_b64_tr_b16 v[174:175], v199 offset:33280
    ds_read_b64_tr_b16 v[176:177], v201 offset:32768
    ds_read_b64_tr_b16 v[178:179], v201 offset:33280
    ds_read_b64_tr_b16 v[180:181], v203 offset:32768
    ds_read_b64_tr_b16 v[182:183], v203 offset:33280
    ds_read_b64_tr_b16 v[184:185], v205 offset:32768
    ds_read_b64_tr_b16 v[186:187], v205 offset:33280
    ds_read_b64_tr_b16 v[188:189], v199 offset:36864
    ds_read_b64_tr_b16 v[190:191], v199 offset:37376
    s_waitcnt lgkmcnt(15)
    v_mfma_f32_16x16x32_bf16 v[0:3], v[104:107], v[96:99], v[0:3]
    s_waitcnt lgkmcnt(15)
    v_mfma_f32_16x16x32_bf16 v[4:7], v[104:107], v[100:103], v[4:7]
    s_waitcnt lgkmcnt(15)
    v_mfma_f32_16x16x32_bf16 v[8:11], v[108:111], v[96:99], v[8:11]
    v_mfma_f32_16x16x32_bf16 v[12:15], v[108:111], v[100:103], v[12:15]
    s_waitcnt lgkmcnt(15)
    v_mfma_f32_16x16x32_bf16 v[16:19], v[112:115], v[96:99], v[16:19]
    v_mfma_f32_16x16x32_bf16 v[20:23], v[112:115], v[100:103], v[20:23]
    s_waitcnt lgkmcnt(15)
    v_mfma_f32_16x16x32_bf16 v[24:27], v[116:119], v[96:99], v[24:27]
    v_mfma_f32_16x16x32_bf16 v[28:31], v[116:119], v[100:103], v[28:31]
    s_waitcnt lgkmcnt(15)
    v_mfma_f32_16x16x32_bf16 v[32:35], v[120:123], v[96:99], v[32:35]
    v_mfma_f32_16x16x32_bf16 v[36:39], v[120:123], v[100:103], v[36:39]
    s_waitcnt lgkmcnt(15)
    v_mfma_f32_16x16x32_bf16 v[40:43], v[96:99], v[124:127], v[40:43]
    v_mfma_f32_16x16x32_bf16 v[44:47], v[100:103], v[124:127], v[44:47]
    s_waitcnt lgkmcnt(15)
    v_mfma_f32_16x16x32_bf16 v[48:51], v[96:99], v[128:131], v[48:51]
    v_mfma_f32_16x16x32_bf16 v[52:55], v[100:103], v[128:131], v[52:55]
    s_waitcnt lgkmcnt(15)
    v_mfma_f32_16x16x32_bf16 v[56:59], v[96:99], v[132:135], v[56:59]
    v_mfma_f32_16x16x32_bf16 v[60:63], v[100:103], v[132:135], v[60:63]
    s_waitcnt lgkmcnt(15)
    v_mfma_f32_16x16x32_bf16 v[64:67], v[96:99], v[136:139], v[64:67]
    v_mfma_f32_16x16x32_bf16 v[68:71], v[100:103], v[136:139], v[68:71]
    s_waitcnt lgkmcnt(15)
    v_mfma_f32_16x16x32_bf16 v[72:75], v[96:99], v[140:143], v[72:75]
    v_mfma_f32_16x16x32_bf16 v[76:79], v[100:103], v[140:143], v[76:79]
    s_waitcnt vmcnt(5)
    s_barrier
    s_add_u32 m0, s46, 0x0
    s_nop 0
    buffer_load_dwordx4 v192, s[32:35], s45 offen lds
    s_add_u32 m0, s46, 0x2000
    s_nop 0
    buffer_load_dwordx4 v193, s[32:35], s45 offen lds
    s_add_u32 m0, s46, 0x4000
    s_nop 0
    buffer_load_dwordx4 v194, s[32:35], s45 offen lds
    s_add_u32 s45, s45, 122880
    ds_read_b128 v[96:99], v197 offset:16384
    ds_read_b64_tr_b16 v[104:105], v199 offset:49152
    ds_read_b64_tr_b16 v[106:107], v199 offset:49664
    ds_read_b128 v[100:103], v197 offset:18432
    ds_read_b64_tr_b16 v[108:109], v201 offset:49152
    ds_read_b64_tr_b16 v[110:111], v201 offset:49664
    ds_read_b64_tr_b16 v[112:113], v203 offset:49152
    ds_read_b64_tr_b16 v[114:115], v203 offset:49664
    ds_read_b64_tr_b16 v[116:117], v205 offset:49152
    ds_read_b64_tr_b16 v[118:119], v205 offset:49664
    ds_read_b64_tr_b16 v[120:121], v199 offset:53248
    ds_read_b64_tr_b16 v[122:123], v199 offset:53760
    ds_read_b64_tr_b16 v[124:125], v199 offset:57344
    ds_read_b64_tr_b16 v[126:127], v199 offset:57856
    ds_read_b64_tr_b16 v[128:129], v201 offset:57344
    ds_read_b64_tr_b16 v[130:131], v201 offset:57856
    ds_read_b64_tr_b16 v[132:133], v203 offset:57344
    ds_read_b64_tr_b16 v[134:135], v203 offset:57856
    ds_read_b64_tr_b16 v[136:137], v205 offset:57344
    ds_read_b64_tr_b16 v[138:139], v205 offset:57856
    ds_read_b64_tr_b16 v[140:141], v199 offset:61440
    ds_read_b64_tr_b16 v[142:143], v199 offset:61952
    s_waitcnt lgkmcnt(15)
    v_mfma_f32_16x16x32_bf16 v[0:3], v[152:155], v[144:147], v[0:3]
    s_waitcnt lgkmcnt(15)
    v_mfma_f32_16x16x32_bf16 v[4:7], v[152:155], v[148:151], v[4:7]
    s_waitcnt lgkmcnt(15)
    v_mfma_f32_16x16x32_bf16 v[8:11], v[156:159], v[144:147], v[8:11]
    v_mfma_f32_16x16x32_bf16 v[12:15], v[156:159], v[148:151], v[12:15]
    s_waitcnt lgkmcnt(15)
    v_mfma_f32_16x16x32_bf16 v[16:19], v[160:163], v[144:147], v[16:19]
    v_mfma_f32_16x16x32_bf16 v[20:23], v[160:163], v[148:151], v[20:23]
    s_waitcnt lgkmcnt(15)
    v_mfma_f32_16x16x32_bf16 v[24:27], v[164:167], v[144:147], v[24:27]
    v_mfma_f32_16x16x32_bf16 v[28:31], v[164:167], v[148:151], v[28:31]
    s_waitcnt lgkmcnt(15)
    v_mfma_f32_16x16x32_bf16 v[32:35], v[168:171], v[144:147], v[32:35]
    v_mfma_f32_16x16x32_bf16 v[36:39], v[168:171], v[148:151], v[36:39]
    s_waitcnt lgkmcnt(15)
    v_mfma_f32_16x16x32_bf16 v[40:43], v[144:147], v[172:175], v[40:43]
    v_mfma_f32_16x16x32_bf16 v[44:47], v[148:151], v[172:175], v[44:47]
    s_waitcnt lgkmcnt(15)
    v_mfma_f32_16x16x32_bf16 v[48:51], v[144:147], v[176:179], v[48:51]
    v_mfma_f32_16x16x32_bf16 v[52:55], v[148:151], v[176:179], v[52:55]
    s_waitcnt lgkmcnt(15)
    v_mfma_f32_16x16x32_bf16 v[56:59], v[144:147], v[180:183], v[56:59]
    v_mfma_f32_16x16x32_bf16 v[60:63], v[148:151], v[180:183], v[60:63]
    s_waitcnt lgkmcnt(15)
    v_mfma_f32_16x16x32_bf16 v[64:67], v[144:147], v[184:187], v[64:67]
    v_mfma_f32_16x16x32_bf16 v[68:71], v[148:151], v[184:187], v[68:71]
    s_waitcnt lgkmcnt(15)
    v_mfma_f32_16x16x32_bf16 v[72:75], v[144:147], v[188:191], v[72:75]
    v_mfma_f32_16x16x32_bf16 v[76:79], v[148:151], v[188:191], v[76:79]
    s_waitcnt vmcnt(3)
    s_barrier
    s_add_u32 m0, s46, 0x18000
    s_nop 0
    buffer_load_dwordx4 v195, s[28:31], s44 offen lds
    s_add_u32 m0, s46, 0x1a000
    s_nop 0
    buffer_load_dwordx4 v196, s[28:31], s44 offen lds
    s_add_u32 s44, s44, 128
    s_add_u32 m0, s46, 0x6000
    s_nop 0
    buffer_load_dwordx4 v192, s[32:35], s45 offen lds
    s_add_u32 m0, s46, 0x8000
    s_nop 0
    buffer_load_dwordx4 v193, s[32:35], s45 offen lds
    s_add_u32 m0, s46, 0xa000
    s_nop 0
    buffer_load_dwordx4 v194, s[32:35], s45 offen lds
    s_add_u32 s45, s45, 122880
    ds_read_b128 v[144:147], v198 offset:16384
    ds_read_b64_tr_b16 v[152:153], v200 offset:8192
    ds_read_b64_tr_b16 v[154:155], v200 offset:8704
    ds_read_b128 v[148:151], v198 offset:18432
    ds_read_b64_tr_b16 v[156:157], v202 offset:8192
    ds_read_b64_tr_b16 v[158:159], v202 offset:8704
    ds_read_b64_tr_b16 v[160:161], v204 offset:8192
    ds_read_b64_tr_b16 v[162:163], v204 offset:8704
    ds_read_b64_tr_b16 v[164:165], v206 offset:8192
    ds_read_b64_tr_b16 v[166:167], v206 offset:8704
    ds_read_b64_tr_b16 v[168:169], v200 offset:12288
    ds_read_b64_tr_b16 v[170:171], v200 offset:12800
    ds_read_b64_tr_b16 v[172:173], v200 offset:16384
    ds_read_b64_tr_b16 v[174:175], v200 offset:16896
    ds_read_b64_tr_b16 v[176:177], v202 offset:16384
    ds_read_b64_tr_b16 v[178:179], v202 offset:16896
    ds_read_b64_tr_b16 v[180:181], v204 offset:16384
    ds_read_b64_tr_b16 v[182:183], v204 offset:16896
    ds_read_b64_tr_b16 v[184:185], v206 offset:16384
    ds_read_b64_tr_b16 v[186:187], v206 offset:16896
    ds_read_b64_tr_b16 v[188:189], v200 offset:20480
    ds_read_b64_tr_b16 v[190:191], v200 offset:20992
    s_waitcnt lgkmcnt(15)
    v_mfma_f32_16x16x32_bf16 v[0:3], v[104:107], v[96:99], v[0:3]
    s_waitcnt lgkmcnt(15)
    v_mfma_f32_16x16x32_bf16 v[4:7], v[104:107], v[100:103], v[4:7]
    s_waitcnt lgkmcnt(15)
    v_mfma_f32_16x16x32_bf16 v[8:11], v[108:111], v[96:99], v[8:11]
    v_mfma_f32_16x16x32_bf16 v[12:15], v[108:111], v[100:103], v[12:15]
    s_waitcnt lgkmcnt(15)
    v_mfma_f32_16x16x32_bf16 v[16:19], v[112:115], v[96:99], v[16:19]
    v_mfma_f32_16x16x32_bf16 v[20:23], v[112:115], v[100:103], v[20:23]
    s_waitcnt lgkmcnt(15)
    v_mfma_f32_16x16x32_bf16 v[24:27], v[116:119], v[96:99], v[24:27]
    v_mfma_f32_16x16x32_bf16 v[28:31], v[116:119], v[100:103], v[28:31]
    s_waitcnt lgkmcnt(15)
    v_mfma_f32_16x16x32_bf16 v[32:35], v[120:123], v[96:99], v[32:35]
    v_mfma_f32_16x16x32_bf16 v[36:39], v[120:123], v[100:103], v[36:39]
    s_waitcnt lgkmcnt(15)
    v_mfma_f32_16x16x32_bf16 v[40:43], v[96:99], v[124:127], v[40:43]
    v_mfma_f32_16x16x32_bf16 v[44:47], v[100:103], v[124:127], v[44:47]
    s_waitcnt lgkmcnt(15)
    v_mfma_f32_16x16x32_bf16 v[48:51], v[96:99], v[128:131], v[48:51]
    v_mfma_f32_16x16x32_bf16 v[52:55], v[100:103], v[128:131], v[52:55]
    s_waitcnt lgkmcnt(15)
    v_mfma_f32_16x16x32_bf16 v[56:59], v[96:99], v[132:135], v[56:59]
    v_mfma_f32_16x16x32_bf16 v[60:63], v[100:103], v[132:135], v[60:63]
    s_waitcnt lgkmcnt(15)
    v_mfma_f32_16x16x32_bf16 v[64:67], v[96:99], v[136:139], v[64:67]
    v_mfma_f32_16x16x32_bf16 v[68:71], v[100:103], v[136:139], v[68:71]
    s_waitcnt lgkmcnt(15)
    v_mfma_f32_16x16x32_bf16 v[72:75], v[96:99], v[140:143], v[72:75]
    v_mfma_f32_16x16x32_bf16 v[76:79], v[100:103], v[140:143], v[76:79]
    s_waitcnt vmcnt(5)
    s_barrier
    s_add_u32 m0, s46, 0xc000
    s_nop 0
    buffer_load_dwordx4 v192, s[32:35], s45 offen lds
    s_add_u32 m0, s46, 0xe000
    s_nop 0
    buffer_load_dwordx4 v193, s[32:35], s45 offen lds
    s_add_u32 m0, s46, 0x10000
    s_nop 0
    buffer_load_dwordx4 v194, s[32:35], s45 offen lds
    s_add_u32 s45, s45, 122880
    v_mov_b32 v210, 0
    buffer_load_dword v211, v210, s[60:63], 0 offen sc1
    ds_read_b128 v[96:99], v197 offset:32768
    ds_read_b64_tr_b16 v[104:105], v199 offset:0
    ds_read_b64_tr_b16 v[106:107], v199 offset:512
    ds_read_b128 v[100:103], v197 offset:34816
    ds_read_b64_tr_b16 v[108:109], v201 offset:0
    ds_read_b64_tr_b16 v[110:111], v201 offset:512
    ds_read_b64_tr_b16 v[112:113], v203 offset:0
    ds_read_b64_tr_b16 v[114:115], v203 offset:512
    ds_read_b64_tr_b16 v[116:117], v205 offset:0
    ds_read_b64_tr_b16 v[118:119], v205 offset:512
    ds_read_b64_tr_b16 v[120:121], v199 offset:4096
    ds_read_b64_tr_b16 v[122:123], v199 offset:4608
    ds_read_b64_tr_b16 v[124:125], v199 offset:8192
    ds_read_b64_tr_b16 v[126:127], v199 offset:8704
    ds_read_b64_tr_b16 v[128:129], v201 offset:8192
    ds_read_b64_tr_b16 v[130:131], v201 offset:8704
    ds_read_b64_tr_b16 v[132:133], v203 offset:8192
    ds_read_b64_tr_b16 v[134:135], v203 offset:8704
    ds_read_b64_tr_b16 v[136:137], v205 offset:8192
    ds_read_b64_tr_b16 v[138:139], v205 offset:8704
    ds_read_b64_tr_b16 v[140:141], v199 offset:12288
    ds_read_b64_tr_b16 v[142:143], v199 offset:12800
    s_waitcnt lgkmcnt(15)
    v_mfma_f32_16x16x32_bf16 v[0:3], v[152:155], v[144:147], v[0:3]
    s_waitcnt lgkmcnt(15)
    v_mfma_f32_16x16x32_bf16 v[4:7], v[152:155], v[148:151], v[4:7]
    s_waitcnt lgkmcnt(15)
    v_mfma_f32_16x16x32_bf16 v[8:11], v[156:159], v[144:147], v[8:11]
    v_mfma_f32_16x16x32_bf16 v[12:15], v[156:159], v[148:151], v[12:15]
    s_waitcnt lgkmcnt(15)
    v_mfma_f32_16x16x32_bf16 v[16:19], v[160:163], v[144:147], v[16:19]
    v_mfma_f32_16x16x32_bf16 v[20:23], v[160:163], v[148:151], v[20:23]
    s_waitcnt lgkmcnt(15)
    v_mfma_f32_16x16x32_bf16 v[24:27], v[164:167], v[144:147], v[24:27]
    v_mfma_f32_16x16x32_bf16 v[28:31], v[164:167], v[148:151], v[28:31]
    s_waitcnt lgkmcnt(15)
    v_mfma_f32_16x16x32_bf16 v[32:35], v[168:171], v[144:147], v[32:35]
    v_mfma_f32_16x16x32_bf16 v[36:39], v[168:171], v[148:151], v[36:39]
    s_waitcnt lgkmcnt(15)
    v_mfma_f32_16x16x32_bf16 v[40:43], v[144:147], v[172:175], v[40:43]
    v_mfma_f32_16x16x32_bf16 v[44:47], v[148:151], v[172:175], v[44:47]
    s_waitcnt lgkmcnt(15)
    v_mfma_f32_16x16x32_bf16 v[48:51], v[144:147], v[176:179], v[48:51]
    v_mfma_f32_16x16x32_bf16 v[52:55], v[148:151], v[176:179], v[52:55]
    s_waitcnt lgkmcnt(15)
    v_mfma_f32_16x16x32_bf16 v[56:59], v[144:147], v[180:183], v[56:59]
    v_mfma_f32_16x16x32_bf16 v[60:63], v[148:151], v[180:183], v[60:63]
    s_waitcnt lgkmcnt(15)
    v_mfma_f32_16x16x32_bf16 v[64:67], v[144:147], v[184:187], v[64:67]
    v_mfma_f32_16x16x32_bf16 v[68:71], v[148:151], v[184:187], v[68:71]
    s_waitcnt lgkmcnt(15)
    v_mfma_f32_16x16x32_bf16 v[72:75], v[144:147], v[188:191], v[72:75]
    v_mfma_f32_16x16x32_bf16 v[76:79], v[148:151], v[188:191], v[76:79]
    s_waitcnt vmcnt(4)
    s_barrier
    s_add_u32 m0, s46, 0x12000
    s_nop 0
    buffer_load_dwordx4 v192, s[32:35], s45 offen lds
    s_add_u32 m0, s46, 0x14000
    s_nop 0
    buffer_load_dwordx4 v193, s[32:35], s45 offen lds
    s_add_u32 m0, s46, 0x16000
    s_nop 0
    buffer_load_dwordx4 v194, s[32:35], s45 offen lds
    s_add_u32 s45, s45, 122880
    ds_read_b128 v[144:147], v198 offset:32768
    ds_read_b64_tr_b16 v[152:153], v199 offset:24576
    ds_read_b64_tr_b16 v[154:155], v199 offset:25088
    ds_read_b128 v[148:151], v198 offset:34816
    ds_read_b64_tr_b16 v[156:157], v201 offset:24576
    ds_read_b64_tr_b16 v[158:159], v201 offset:25088
    ds_read_b64_tr_b16 v[160:161], v203 offset:24576
    ds_read_b64_tr_b16 v[162:163], v203 offset:25088
    ds_read_b64_tr_b16 v[164:165], v205 offset:24576
    ds_read_b64_tr_b16 v[166:167], v205 offset:25088
    ds_read_b64_tr_b16 v[168:169], v199 offset:28672
    ds_read_b64_tr_b16 v[170:171], v199 offset:29184
    ds_read_b64_tr_b16 v[172:173], v199 offset:32768
    ds_read_b64_tr_b16 v[174:175], v199 offset:33280
    ds_read_b64_tr_b16 v[176:177], v201 offset:32768
    ds_read_b64_tr_b16 v[178:179], v201 offset:33280
    ds_read_b64_tr_b16 v[180:181], v203 offset:32768
    ds_read_b64_tr_b16 v[182:183], v203 offset:33280
    ds_read_b64_tr_b16 v[184:185], v205 offset:32768
    ds_read_b64_tr_b16 v[186:187], v205 offset:33280
    ds_read_b64_tr_b16 v[188:189], v199 offset:36864
    ds_read_b64_tr_b16 v[190:191], v199 offset:37376
    s_waitcnt lgkmcnt(15)
    v_mfma_f32_16x16x32_bf16 v[0:3], v[104:107], v[96:99], v[0:3]
    s_waitcnt lgkmcnt(15)
    v_mfma_f32_16x16x32_bf16 v[4:7], v[104:107], v[100:103], v[4:7]
    s_waitcnt lgkmcnt(15)
    v_mfma_f32_16x16x32_bf16 v[8:11], v[108:111], v[96:99], v[8:11]
    v_mfma_f32_16x16x32_bf16 v[12:15], v[108:111], v[100:103], v[12:15]
    s_waitcnt lgkmcnt(15)
    v_mfma_f32_16x16x32_bf16 v[16:19], v[112:115], v[96:99], v[16:19]
    v_mfma_f32_16x16x32_bf16 v[20:23], v[112:115], v[100:103], v[20:23]
    s_waitcnt lgkmcnt(15)
    v_mfma_f32_16x16x32_bf16 v[24:27], v[116:119], v[96:99], v[24:27]
    v_mfma_f32_16x16x32_bf16 v[28:31], v[116:119], v[100:103], v[28:31]
    s_waitcnt lgkmcnt(15)
    v_mfma_f32_16x16x32_bf16 v[32:35], v[120:123], v[96:99], v[32:35]
    v_mfma_f32_16x16x32_bf16 v[36:39], v[120:123], v[100:103], v[36:39]
    s_waitcnt lgkmcnt(15)
    v_mfma_f32_16x16x32_bf16 v[40:43], v[96:99], v[124:127], v[40:43]
    v_mfma_f32_16x16x32_bf16 v[44:47], v[100:103], v[124:127], v[44:47]
    s_waitcnt lgkmcnt(15)
    v_mfma_f32_16x16x32_bf16 v[48:51], v[96:99], v[128:131], v[48:51]
    v_mfma_f32_16x16x32_bf16 v[52:55], v[100:103], v[128:131], v[52:55]
    s_waitcnt lgkmcnt(15)
    v_mfma_f32_16x16x32_bf16 v[56:59], v[96:99], v[132:135], v[56:59]
    v_mfma_f32_16x16x32_bf16 v[60:63], v[100:103], v[132:135], v[60:63]
    s_waitcnt lgkmcnt(15)
    v_mfma_f32_16x16x32_bf16 v[64:67], v[96:99], v[136:139], v[64:67]
    v_mfma_f32_16x16x32_bf16 v[68:71], v[100:103], v[136:139], v[68:71]
    s_waitcnt lgkmcnt(15)
    v_mfma_f32_16x16x32_bf16 v[72:75], v[96:99], v[140:143], v[72:75]
    v_mfma_f32_16x16x32_bf16 v[76:79], v[100:103], v[140:143], v[76:79]
    s_waitcnt vmcnt(4)
    s_barrier
    ds_read_b128 v[96:99], v197 offset:0
    ds_read_b64_tr_b16 v[104:105], v199 offset:49152
    ds_read_b64_tr_b16 v[106:107], v199 offset:49664
    ds_read_b128 v[100:103], v197 offset:2048
    ds_read_b64_tr_b16 v[108:109], v201 offset:49152
    ds_read_b64_tr_b16 v[110:111], v201 offset:49664
    ds_read_b64_tr_b16 v[112:113], v203 offset:49152
    ds_read_b64_tr_b16 v[114:115], v203 offset:49664
    ds_read_b64_tr_b16 v[116:117], v205 offset:49152
    ds_read_b64_tr_b16 v[118:119], v205 offset:49664
    ds_read_b64_tr_b16 v[120:121], v199 offset:53248
    ds_read_b64_tr_b16 v[122:123], v199 offset:53760
    ds_read_b64_tr_b16 v[124:125], v199 offset:57344
    ds_read_b64_tr_b16 v[126:127], v199 offset:57856
    ds_read_b64_tr_b16 v[128:129], v201 offset:57344
    ds_read_b64_tr_b16 v[130:131], v201 offset:57856
    ds_read_b64_tr_b16 v[132:133], v203 offset:57344
    ds_read_b64_tr_b16 v[134:135], v203 offset:57856
    ds_read_b64_tr_b16 v[136:137], v205 offset:57344
    ds_read_b64_tr_b16 v[138:139], v205 offset:57856
    ds_read_b64_tr_b16 v[140:141], v199 offset:61440
    ds_read_b64_tr_b16 v[142:143], v199 offset:61952
    s_waitcnt lgkmcnt(15)
    v_mfma_f32_16x16x32_bf16 v[0:3], v[152:155], v[144:147], v[0:3]
    s_waitcnt lgkmcnt(15)
    v_mfma_f32_16x16x32_bf16 v[4:7], v[152:155], v[148:151], v[4:7]
    s_waitcnt lgkmcnt(15)
    v_mfma_f32_16x16x32_bf16 v[8:11], v[156:159], v[144:147], v[8:11]
    v_mfma_f32_16x16x32_bf16 v[12:15], v[156:159], v[148:151], v[12:15]
    s_waitcnt lgkmcnt(15)
    v_mfma_f32_16x16x32_bf16 v[16:19], v[160:163], v[144:147], v[16:19]
    v_mfma_f32_16x16x32_bf16 v[20:23], v[160:163], v[148:151], v[20:23]
    s_waitcnt lgkmcnt(15)
    v_mfma_f32_16x16x32_bf16 v[24:27], v[164:167], v[144:147], v[24:27]
    v_mfma_f32_16x16x32_bf16 v[28:31], v[164:167], v[148:151], v[28:31]
    s_waitcnt lgkmcnt(15)
    v_mfma_f32_16x16x32_bf16 v[32:35], v[168:171], v[144:147], v[32:35]
    v_mfma_f32_16x16x32_bf16 v[36:39], v[168:171], v[148:151], v[36:39]
    s_waitcnt lgkmcnt(15)
    v_mfma_f32_16x16x32_bf16 v[40:43], v[144:147], v[172:175], v[40:43]
    v_mfma_f32_16x16x32_bf16 v[44:47], v[148:151], v[172:175], v[44:47]
    s_waitcnt lgkmcnt(15)
    v_mfma_f32_16x16x32_bf16 v[48:51], v[144:147], v[176:179], v[48:51]
    v_mfma_f32_16x16x32_bf16 v[52:55], v[148:151], v[176:179], v[52:55]
    s_waitcnt lgkmcnt(15)
    v_mfma_f32_16x16x32_bf16 v[56:59], v[144:147], v[180:183], v[56:59]
    v_mfma_f32_16x16x32_bf16 v[60:63], v[148:151], v[180:183], v[60:63]
    s_waitcnt lgkmcnt(15)
    v_mfma_f32_16x16x32_bf16 v[64:67], v[144:147], v[184:187], v[64:67]
    v_mfma_f32_16x16x32_bf16 v[68:71], v[148:151], v[184:187], v[68:71]
    s_waitcnt lgkmcnt(15)
    v_mfma_f32_16x16x32_bf16 v[72:75], v[144:147], v[188:191], v[72:75]
    v_mfma_f32_16x16x32_bf16 v[76:79], v[148:151], v[188:191], v[76:79]
    s_waitcnt vmcnt(0)
    s_cmp_lg_u32 s47, 0
    s_cbranch_scc1 LKV_wf_ok
    v_readfirstlane_b32 s48, v211
    s_cmp_ge_u32 s48, 220
    s_cbranch_scc1 LKV_wf_ok
    v_mov_b32 v210, 0
    s_mov_b32 s49, 0
LKV_wf:
    buffer_load_dword v211, v210, s[60:63], 0 offen sc1
    s_waitcnt vmcnt(0)
    v_readfirstlane_b32 s48, v211
    s_cmp_ge_u32 s48, 220
    s_cbranch_scc1 LKV_wf_ok
    s_sleep 8
    s_add_u32 s49, s49, 1
    s_cmp_lt_u32 s49, 0x10000
    s_cbranch_scc1 LKV_wf
LKV_wf_ok:
    s_barrier
    s_add_u32 s56, s24, 0x1120000
    s_addc_u32 s57, s25, 0
    s_and_b32 s57, s57, 0xffff
    s_mov_b32 s58, 0x4000
    s_mov_b32 s59, 0x00020000
    s_add_u32 s64, s24, 0x1128000
    s_addc_u32 s65, s25, 0
    s_and_b32 s65, s65, 0xffff
    s_mov_b32 s66, 0x4e00
    s_mov_b32 s67, 0x00020000
    v_and_b32 v210, 15, v207
    v_lshrrev_b32 v213, 0, v208
    v_and_b32 v213, 3, v213
    v_and_b32 v214, 0, v208
    v_mul_u32_u24 v215, 32, v213
    v_add_u32 v215, v215, v210
    s_lshl_b32 s48, s51, 7
    v_add_u32 v215, s48, v215
    v_lshlrev_b32 v215, 3, v215
    buffer_load_dwordx2 v[230:231], v215, s[56:59], 0 offen offset:0 sc1
    buffer_load_dwordx2 v[232:233], v215, s[56:59], 0 offen offset:128 sc1
    s_mul_i32 s48, s52, 80
    s_add_u32 s48, s48, 640
    v_mul_u32_u24 v216, 80, v214
    v_add3_u32 v216, v216, v210, s48
    v_lshlrev_b32 v216, 2, v216
    v_add_u32 v217, 2560, v216
    buffer_load_dword v238, v216, s[64:67], 0 offen offset:0 sc1
    buffer_load_dword v239, v216, s[64:67], 0 offen offset:64 sc1
    buffer_load_dword v240, v216, s[64:67], 0 offen offset:128 sc1
    buffer_load_dword v241, v216, s[64:67], 0 offen offset:192 sc1
    buffer_load_dword v242, v216, s[64:67], 0 offen offset:256 sc1
    buffer_load_dword v243, v217, s[64:67], 0 offen offset:0 sc1
    buffer_load_dword v244, v217, s[64:67], 0 offen offset:64 sc1
    buffer_load_dword v245, v217, s[64:67], 0 offen offset:128 sc1
    buffer_load_dword v246, v217, s[64:67], 0 offen offset:192 sc1
    buffer_load_dword v247, v217, s[64:67], 0 offen offset:256 sc1
    ds_read_b128 v[144:147], v198 offset:0
    ds_read_b64_tr_b16 v[152:153], v200 offset:8192
    ds_read_b64_tr_b16 v[154:155], v200 offset:8704
    ds_read_b128 v[148:151], v198 offset:2048
    ds_read_b64_tr_b16 v[156:157], v202 offset:8192
    ds_read_b64_tr_b16 v[158:159], v202 offset:8704
    ds_read_b64_tr_b16 v[160:161], v204 offset:8192
    ds_read_b64_tr_b16 v[162:163], v204 offset:8704
    ds_read_b64_tr_b16 v[164:165], v206 offset:8192
    ds_read_b64_tr_b16 v[166:167], v206 offset:8704
    ds_read_b64_tr_b16 v[168:169], v200 offset:12288
    ds_read_b64_tr_b16 v[170:171], v200 offset:12800
    ds_read_b64_tr_b16 v[172:173], v200 offset:16384
    ds_read_b64_tr_b16 v[174:175], v200 offset:16896
    ds_read_b64_tr_b16 v[176:177], v202 offset:16384
    ds_read_b64_tr_b16 v[178:179], v202 offset:16896
    ds_read_b64_tr_b16 v[180:181], v204 offset:16384
    ds_read_b64_tr_b16 v[182:183], v204 offset:16896
    ds_read_b64_tr_b16 v[184:185], v206 offset:16384
    ds_read_b64_tr_b16 v[186:187], v206 offset:16896
    ds_read_b64_tr_b16 v[188:189], v200 offset:20480
    ds_read_b64_tr_b16 v[190:191], v200 offset:20992
    s_waitcnt lgkmcnt(15)
    v_mfma_f32_16x16x32_bf16 v[0:3], v[104:107], v[96:99], v[0:3]
    s_waitcnt lgkmcnt(15)
    v_mfma_f32_16x16x32_bf16 v[4:7], v[104:107], v[100:103], v[4:7]
    s_waitcnt lgkmcnt(15)
    v_mfma_f32_16x16x32_bf16 v[8:11], v[108:111], v[96:99], v[8:11]
    v_mfma_f32_16x16x32_bf16 v[12:15], v[108:111], v[100:103], v[12:15]
    s_waitcnt lgkmcnt(15)
    v_mfma_f32_16x16x32_bf16 v[16:19], v[112:115], v[96:99], v[16:19]
    v_mfma_f32_16x16x32_bf16 v[20:23], v[112:115], v[100:103], v[20:23]
    s_waitcnt lgkmcnt(15)
    v_mfma_f32_16x16x32_bf16 v[24:27], v[116:119], v[96:99], v[24:27]
    v_mfma_f32_16x16x32_bf16 v[28:31], v[116:119], v[100:103], v[28:31]
    s_waitcnt lgkmcnt(15)
    v_mfma_f32_16x16x32_bf16 v[32:35], v[120:123], v[96:99], v[32:35]
    v_mfma_f32_16x16x32_bf16 v[36:39], v[120:123], v[100:103], v[36:39]
    s_waitcnt lgkmcnt(15)
    v_mfma_f32_16x16x32_bf16 v[40:43], v[96:99], v[124:127], v[40:43]
    v_mfma_f32_16x16x32_bf16 v[44:47], v[100:103], v[124:127], v[44:47]
    s_waitcnt lgkmcnt(15)
    v_mfma_f32_16x16x32_bf16 v[48:51], v[96:99], v[128:131], v[48:51]
    v_mfma_f32_16x16x32_bf16 v[52:55], v[100:103], v[128:131], v[52:55]
    s_waitcnt lgkmcnt(15)
    v_mfma_f32_16x16x32_bf16 v[56:59], v[96:99], v[132:135], v[56:59]
    v_mfma_f32_16x16x32_bf16 v[60:63], v[100:103], v[132:135], v[60:63]
    s_waitcnt lgkmcnt(15)
    v_mfma_f32_16x16x32_bf16 v[64:67], v[96:99], v[136:139], v[64:67]
    v_mfma_f32_16x16x32_bf16 v[68:71], v[100:103], v[136:139], v[68:71]
    s_waitcnt lgkmcnt(15)
    v_mfma_f32_16x16x32_bf16 v[72:75], v[96:99], v[140:143], v[72:75]
    v_mfma_f32_16x16x32_bf16 v[76:79], v[100:103], v[140:143], v[76:79]
    s_waitcnt lgkmcnt(15)
    v_mfma_f32_16x16x32_bf16 v[0:3], v[152:155], v[144:147], v[0:3]
    s_waitcnt lgkmcnt(15)
    v_mfma_f32_16x16x32_bf16 v[4:7], v[152:155], v[148:151], v[4:7]
    s_waitcnt lgkmcnt(15)
    v_mfma_f32_16x16x32_bf16 v[8:11], v[156:159], v[144:147], v[8:11]
    v_mfma_f32_16x16x32_bf16 v[12:15], v[156:159], v[148:151], v[12:15]
    s_waitcnt lgkmcnt(14)
    v_mfma_f32_16x16x32_bf16 v[16:19], v[160:163], v[144:147], v[16:19]
    v_mfma_f32_16x16x32_bf16 v[20:23], v[160:163], v[148:151], v[20:23]
    s_waitcnt lgkmcnt(12)
    v_mfma_f32_16x16x32_bf16 v[24:27], v[164:167], v[144:147], v[24:27]
    v_mfma_f32_16x16x32_bf16 v[28:31], v[164:167], v[148:151], v[28:31]
    s_waitcnt lgkmcnt(10)
    v_mfma_f32_16x16x32_bf16 v[32:35], v[168:171], v[144:147], v[32:35]
    v_mfma_f32_16x16x32_bf16 v[36:39], v[168:171], v[148:151], v[36:39]
    s_waitcnt lgkmcnt(8)
    v_mfma_f32_16x16x32_bf16 v[40:43], v[144:147], v[172:175], v[40:43]
    v_mfma_f32_16x16x32_bf16 v[44:47], v[148:151], v[172:175], v[44:47]
    s_waitcnt lgkmcnt(6)
    v_mfma_f32_16x16x32_bf16 v[48:51], v[144:147], v[176:179], v[48:51]
    v_mfma_f32_16x16x32_bf16 v[52:55], v[148:151], v[176:179], v[52:55]
    s_waitcnt lgkmcnt(4)
    v_mfma_f32_16x16x32_bf16 v[56:59], v[144:147], v[180:183], v[56:59]
    v_mfma_f32_16x16x32_bf16 v[60:63], v[148:151], v[180:183], v[60:63]
    s_waitcnt lgkmcnt(2)
    v_mfma_f32_16x16x32_bf16 v[64:67], v[144:147], v[184:187], v[64:67]
    v_mfma_f32_16x16x32_bf16 v[68:71], v[148:151], v[184:187], v[68:71]
    s_waitcnt lgkmcnt(0)
    v_mfma_f32_16x16x32_bf16 v[72:75], v[144:147], v[188:191], v[72:75]
    v_mfma_f32_16x16x32_bf16 v[76:79], v[148:151], v[188:191], v[76:79]
    s_waitcnt vmcnt(0)
    v_cmp_gt_u32 vcc, 16, v207
    v_lshrrev_b32 v212, 16, v231
    v_xor_b32 v212, 0x8000, v212
    v_lshl_or_b32 v213, v212, 16, v212
    v_cndmask_b32 v136, 0, v213, vcc
    v_cndmask_b32 v137, 0, v212, vcc
    v_mov_b32 v138, 0
    v_mov_b32 v139, 0
    v_lshrrev_b32 v212, 16, v233
    v_xor_b32 v212, 0x8000, v212
    v_lshl_or_b32 v213, v212, 16, v212
    v_cndmask_b32 v140, 0, v213, vcc
    v_cndmask_b32 v141, 0, v212, vcc
    v_mov_b32 v142, 0
    v_mov_b32 v143, 0
    v_cvt_pk_bf16_f32 v210, v238, v238
    v_lshlrev_b32 v212, 16, v210
    v_sub_f32 v238, v238, v212
    v_cvt_pk_bf16_f32 v211, v238, v238
    v_lshlrev_b32 v212, 16, v211
    v_sub_f32 v238, v238, v212
    v_cvt_pk_bf16_f32 v212, v238, v238
    v_and_b32 v210, 0xffff, v210
    v_lshl_or_b32 v210, v211, 16, v210
    v_and_b32 v212, 0xffff, v212
    v_cndmask_b32 v96, 0, v210, vcc
    v_cndmask_b32 v97, 0, v212, vcc
    v_mov_b32 v98, 0
    v_mov_b32 v99, 0
    v_cvt_pk_bf16_f32 v213, v239, v239
    v_lshlrev_b32 v215, 16, v213
    v_sub_f32 v239, v239, v215
    v_cvt_pk_bf16_f32 v214, v239, v239
    v_lshlrev_b32 v215, 16, v214
    v_sub_f32 v239, v239, v215
    v_cvt_pk_bf16_f32 v215, v239, v239
    v_and_b32 v213, 0xffff, v213
    v_lshl_or_b32 v213, v214, 16, v213
    v_and_b32 v215, 0xffff, v215
    v_cndmask_b32 v100, 0, v213, vcc
    v_cndmask_b32 v101, 0, v215, vcc
    v_mov_b32 v102, 0
    v_mov_b32 v103, 0
    v_cvt_pk_bf16_f32 v216, v240, v240
    v_lshlrev_b32 v218, 16, v216
    v_sub_f32 v240, v240, v218
    v_cvt_pk_bf16_f32 v217, v240, v240
    v_lshlrev_b32 v218, 16, v217
    v_sub_f32 v240, v240, v218
    v_cvt_pk_bf16_f32 v218, v240, v240
    v_and_b32 v216, 0xffff, v216
    v_lshl_or_b32 v216, v217, 16, v216
    v_and_b32 v218, 0xffff, v218
    v_cndmask_b32 v104, 0, v216, vcc
    v_cndmask_b32 v105, 0, v218, vcc
    v_mov_b32 v106, 0
    v_mov_b32 v107, 0
    v_cvt_pk_bf16_f32 v210, v241, v241
    v_lshlrev_b32 v212, 16, v210
    v_sub_f32 v241, v241, v212
    v_cvt_pk_bf16_f32 v211, v241, v241
    v_lshlrev_b32 v212, 16, v211
    v_sub_f32 v241, v241, v212
    v_cvt_pk_bf16_f32 v212, v241, v241
    v_and_b32 v210, 0xffff, v210
    v_lshl_or_b32 v210, v211, 16, v210
    v_and_b32 v212, 0xffff, v212
    v_cndmask_b32 v108, 0, v210, vcc
    v_cndmask_b32 v109, 0, v212, vcc
    v_mov_b32 v110, 0
    v_mov_b32 v111, 0
    v_cvt_pk_bf16_f32 v213, v242, v242
    v_lshlrev_b32 v215, 16, v213
    v_sub_f32 v242, v242, v215
    v_cvt_pk_bf16_f32 v214, v242, v242
    v_lshlrev_b32 v215, 16, v214
    v_sub_f32 v242, v242, v215
    v_cvt_pk_bf16_f32 v215, v242, v242
    v_and_b32 v213, 0xffff, v213
    v_lshl_or_b32 v213, v214, 16, v213
    v_and_b32 v215, 0xffff, v215
    v_cndmask_b32 v112, 0, v213, vcc
    v_cndmask_b32 v113, 0, v215, vcc
    v_mov_b32 v114, 0
    v_mov_b32 v115, 0
    v_cvt_pk_bf16_f32 v216, v243, v243
    v_lshlrev_b32 v218, 16, v216
    v_sub_f32 v243, v243, v218
    v_cvt_pk_bf16_f32 v217, v243, v243
    v_lshlrev_b32 v218, 16, v217
    v_sub_f32 v243, v243, v218
    v_cvt_pk_bf16_f32 v218, v243, v243
    v_and_b32 v216, 0xffff, v216
    v_lshl_or_b32 v216, v217, 16, v216
    v_and_b32 v218, 0xffff, v218
    v_cndmask_b32 v116, 0, v216, vcc
    v_cndmask_b32 v117, 0, v218, vcc
    v_mov_b32 v118, 0
    v_mov_b32 v119, 0
    v_cvt_pk_bf16_f32 v210, v244, v244
    v_lshlrev_b32 v212, 16, v210
    v_sub_f32 v244, v244, v212
    v_cvt_pk_bf16_f32 v211, v244, v244
    v_lshlrev_b32 v212, 16, v211
    v_sub_f32 v244, v244, v212
    v_cvt_pk_bf16_f32 v212, v244, v244
    v_and_b32 v210, 0xffff, v210
    v_lshl_or_b32 v210, v211, 16, v210
    v_and_b32 v212, 0xffff, v212
    v_cndmask_b32 v120, 0, v210, vcc
    v_cndmask_b32 v121, 0, v212, vcc
    v_mov_b32 v122, 0
    v_mov_b32 v123, 0
    v_cvt_pk_bf16_f32 v213, v245, v245
    v_lshlrev_b32 v215, 16, v213
    v_sub_f32 v245, v245, v215
    v_cvt_pk_bf16_f32 v214, v245, v245
    v_lshlrev_b32 v215, 16, v214
    v_sub_f32 v245, v245, v215
    v_cvt_pk_bf16_f32 v215, v245, v245
    v_and_b32 v213, 0xffff, v213
    v_lshl_or_b32 v213, v214, 16, v213
    v_and_b32 v215, 0xffff, v215
    v_cndmask_b32 v124, 0, v213, vcc
    v_cndmask_b32 v125, 0, v215, vcc
    v_mov_b32 v126, 0
    v_mov_b32 v127, 0
    v_cvt_pk_bf16_f32 v216, v246, v246
    v_lshlrev_b32 v218, 16, v216
    v_sub_f32 v246, v246, v218
    v_cvt_pk_bf16_f32 v217, v246, v246
    v_lshlrev_b32 v218, 16, v217
    v_sub_f32 v246, v246, v218
    v_cvt_pk_bf16_f32 v218, v246, v246
    v_and_b32 v216, 0xffff, v216
    v_lshl_or_b32 v216, v217, 16, v216
    v_and_b32 v218, 0xffff, v218
    v_cndmask_b32 v128, 0, v216, vcc
    v_cndmask_b32 v129, 0, v218, vcc
    v_mov_b32 v130, 0
    v_mov_b32 v131, 0
    v_cvt_pk_bf16_f32 v210, v247, v247
    v_lshlrev_b32 v212, 16, v210
    v_sub_f32 v247, v247, v212
    v_cvt_pk_bf16_f32 v211, v247, v247
    v_lshlrev_b32 v212, 16, v211
    v_sub_f32 v247, v247, v212
    v_cvt_pk_bf16_f32 v212, v247, v247
    v_and_b32 v210, 0xffff, v210
    v_lshl_or_b32 v210, v211, 16, v210
    v_and_b32 v212, 0xffff, v212
    v_cndmask_b32 v132, 0, v210, vcc
    v_cndmask_b32 v133, 0, v212, vcc
    v_mov_b32 v134, 0
    v_mov_b32 v135, 0
    v_mfma_f32_16x16x32_bf16 v[0:3], v[96:99], v[136:139], v[0:3]
    v_mfma_f32_16x16x32_bf16 v[4:7], v[96:99], v[140:143], v[4:7]
    v_mfma_f32_16x16x32_bf16 v[8:11], v[100:103], v[136:139], v[8:11]
    v_mfma_f32_16x16x32_bf16 v[12:15], v[100:103], v[140:143], v[12:15]
    v_mfma_f32_16x16x32_bf16 v[16:19], v[104:107], v[136:139], v[16:19]
    v_mfma_f32_16x16x32_bf16 v[20:23], v[104:107], v[140:143], v[20:23]
    v_mfma_f32_16x16x32_bf16 v[24:27], v[108:111], v[136:139], v[24:27]
    v_mfma_f32_16x16x32_bf16 v[28:31], v[108:111], v[140:143], v[28:31]
    v_mfma_f32_16x16x32_bf16 v[32:35], v[112:115], v[136:139], v[32:35]
    v_mfma_f32_16x16x32_bf16 v[36:39], v[112:115], v[140:143], v[36:39]
    v_mfma_f32_16x16x32_bf16 v[40:43], v[136:139], v[116:119], v[40:43]
    v_mfma_f32_16x16x32_bf16 v[44:47], v[140:143], v[116:119], v[44:47]
    v_mfma_f32_16x16x32_bf16 v[48:51], v[136:139], v[120:123], v[48:51]
    v_mfma_f32_16x16x32_bf16 v[52:55], v[140:143], v[120:123], v[52:55]
    v_mfma_f32_16x16x32_bf16 v[56:59], v[136:139], v[124:127], v[56:59]
    v_mfma_f32_16x16x32_bf16 v[60:63], v[140:143], v[124:127], v[60:63]
    v_mfma_f32_16x16x32_bf16 v[64:67], v[136:139], v[128:131], v[64:67]
    v_mfma_f32_16x16x32_bf16 v[68:71], v[140:143], v[128:131], v[68:71]
    v_mfma_f32_16x16x32_bf16 v[72:75], v[136:139], v[132:135], v[72:75]
    v_mfma_f32_16x16x32_bf16 v[76:79], v[140:143], v[132:135], v[76:79]
    v_cmp_gt_u32 vcc, 16, v207
    v_mov_b32 v220, 0x3f803f80
    v_mov_b32 v221, 0x3f80
    v_cndmask_b32 v164, 0, v220, vcc
    v_cndmask_b32 v165, 0, v221, vcc
    v_mov_b32 v166, 0
    v_mov_b32 v167, 0
    v_mov_b32 v224, v230
    v_cvt_pk_bf16_f32 v220, v224, v224
    v_lshlrev_b32 v222, 16, v220
    v_sub_f32 v224, v224, v222
    v_cvt_pk_bf16_f32 v221, v224, v224
    v_lshlrev_b32 v222, 16, v221
    v_sub_f32 v224, v224, v222
    v_cvt_pk_bf16_f32 v222, v224, v224
    v_and_b32 v220, 0xffff, v220
    v_lshl_or_b32 v220, v221, 16, v220
    v_and_b32 v222, 0xffff, v222
    v_cndmask_b32 v168, 0, v220, vcc
    v_cndmask_b32 v169, 0, v222, vcc
    v_mov_b32 v170, 0
    v_mov_b32 v171, 0
    v_mov_b32 v224, v232
    v_cvt_pk_bf16_f32 v220, v224, v224
    v_lshlrev_b32 v222, 16, v220
    v_sub_f32 v224, v224, v222
    v_cvt_pk_bf16_f32 v221, v224, v224
    v_lshlrev_b32 v222, 16, v221
    v_sub_f32 v224, v224, v222
    v_cvt_pk_bf16_f32 v222, v224, v224
    v_and_b32 v220, 0xffff, v220
    v_lshl_or_b32 v220, v221, 16, v220
    v_and_b32 v222, 0xffff, v222
    v_cndmask_b32 v172, 0, v220, vcc
    v_cndmask_b32 v173, 0, v222, vcc
    v_mov_b32 v174, 0
    v_mov_b32 v175, 0
    v_mfma_f32_16x16x32_bf16 v[176:179], v[168:171], v[164:167], 0
    s_nop 0
    v_mfma_f32_16x16x32_bf16 v[180:183], v[172:175], v[164:167], 0
    v_and_b32 v210, 3, v207
    v_bfe_u32 v211, v207, 2, 2
    v_lshrrev_b32 v212, 4, v207
    v_and_b32 v213, 0, v208
    v_lshl_add_u32 v213, v213, 2, v210
    v_mul_u32_u24 v213, 800, v213
    v_add_u32 v213, 147456, v213
    v_mul_u32_u24 v214, 20, v210
    v_lshlrev_b32 v215, 2, v212
    v_sub_u32 v215, v215, v214
    v_mov_b32 v218, 160256
    v_add_u32 v216, 0, v215
    v_cmp_gt_u32 vcc, 20, v216
    v_add_u32 v216, v216, v211
    v_mul_u32_u24 v216, 40, v216
    v_add_u32 v216, v216, v213
    v_cndmask_b32 v156, v218, v216, vcc
    v_add_u32 v216, 16, v215
    v_cmp_gt_u32 vcc, 20, v216
    v_add_u32 v216, v216, v211
    v_mul_u32_u24 v216, 40, v216
    v_add_u32 v216, v216, v213
    v_cndmask_b32 v157, v218, v216, vcc
    v_add_u32 v216, 32, v215
    v_cmp_gt_u32 vcc, 20, v216
    v_add_u32 v216, v216, v211
    v_mul_u32_u24 v216, 40, v216
    v_add_u32 v216, v216, v213
    v_cndmask_b32 v158, v218, v216, vcc
    v_add_u32 v216, 48, v215
    v_cmp_gt_u32 vcc, 20, v216
    v_add_u32 v216, v216, v211
    v_mul_u32_u24 v216, 40, v216
    v_add_u32 v216, v216, v213
    v_cndmask_b32 v159, v218, v216, vcc
    v_add_u32 v216, 64, v215
    v_cmp_gt_u32 vcc, 20, v216
    v_add_u32 v216, v216, v211
    v_mul_u32_u24 v216, 40, v216
    v_add_u32 v216, v216, v213
    v_cndmask_b32 v160, v218, v216, vcc
    ds_read_b64_tr_b16 v[96:97], v156 offset:0
    ds_read_b64_tr_b16 v[98:99], v157 offset:0
    ds_read_b64_tr_b16 v[100:101], v158 offset:0
    ds_read_b64_tr_b16 v[102:103], v159 offset:0
    ds_read_b64_tr_b16 v[104:105], v160 offset:0
    v_mov_b32 v106, 0
    v_mov_b32 v107, 0
    ds_read_b64_tr_b16 v[108:109], v156 offset:8
    ds_read_b64_tr_b16 v[110:111], v157 offset:8
    ds_read_b64_tr_b16 v[112:113], v158 offset:8
    ds_read_b64_tr_b16 v[114:115], v159 offset:8
    ds_read_b64_tr_b16 v[116:117], v160 offset:8
    v_mov_b32 v118, 0
    v_mov_b32 v119, 0
    ds_read_b64_tr_b16 v[120:121], v156 offset:16
    ds_read_b64_tr_b16 v[122:123], v157 offset:16
    ds_read_b64_tr_b16 v[124:125], v158 offset:16
    ds_read_b64_tr_b16 v[126:127], v159 offset:16
    ds_read_b64_tr_b16 v[128:129], v160 offset:16
    v_mov_b32 v130, 0
    v_mov_b32 v131, 0
    ds_read_b64_tr_b16 v[132:133], v156 offset:24
    ds_read_b64_tr_b16 v[134:135], v157 offset:24
    ds_read_b64_tr_b16 v[136:137], v158 offset:24
    ds_read_b64_tr_b16 v[138:139], v159 offset:24
    ds_read_b64_tr_b16 v[140:141], v160 offset:24
    v_mov_b32 v142, 0
    v_mov_b32 v143, 0
    ds_read_b64_tr_b16 v[144:145], v156 offset:32
    ds_read_b64_tr_b16 v[146:147], v157 offset:32
    ds_read_b64_tr_b16 v[148:149], v158 offset:32
    ds_read_b64_tr_b16 v[150:151], v159 offset:32
    ds_read_b64_tr_b16 v[152:153], v160 offset:32
    v_mov_b32 v154, 0
    v_mov_b32 v155, 0
    v_pk_mul_f32 v[40:41], v[40:41], v[176:177]
    v_pk_mul_f32 v[42:43], v[42:43], v[178:179]
    v_pk_mul_f32 v[48:49], v[48:49], v[176:177]
    v_pk_mul_f32 v[50:51], v[50:51], v[178:179]
    v_pk_mul_f32 v[56:57], v[56:57], v[176:177]
    v_pk_mul_f32 v[58:59], v[58:59], v[178:179]
    v_pk_mul_f32 v[64:65], v[64:65], v[176:177]
    v_pk_mul_f32 v[66:67], v[66:67], v[178:179]
    v_pk_mul_f32 v[72:73], v[72:73], v[176:177]
    v_pk_mul_f32 v[74:75], v[74:75], v[178:179]
    v_pk_mul_f32 v[44:45], v[44:45], v[180:181]
    v_pk_mul_f32 v[46:47], v[46:47], v[182:183]
    v_pk_mul_f32 v[52:53], v[52:53], v[180:181]
    v_pk_mul_f32 v[54:55], v[54:55], v[182:183]
    v_pk_mul_f32 v[60:61], v[60:61], v[180:181]
    v_pk_mul_f32 v[62:63], v[62:63], v[182:183]
    v_pk_mul_f32 v[68:69], v[68:69], v[180:181]
    v_pk_mul_f32 v[70:71], v[70:71], v[182:183]
    v_pk_mul_f32 v[76:77], v[76:77], v[180:181]
    v_pk_mul_f32 v[78:79], v[78:79], v[182:183]
    v_cvt_pk_bf16_f32 v40, v40, v41
    v_cvt_pk_bf16_f32 v41, v42, v43
    v_cvt_pk_bf16_f32 v42, v44, v45
    v_cvt_pk_bf16_f32 v43, v46, v47
    v_cvt_pk_bf16_f32 v48, v48, v49
    v_cvt_pk_bf16_f32 v49, v50, v51
    v_cvt_pk_bf16_f32 v50, v52, v53
    v_cvt_pk_bf16_f32 v51, v54, v55
    v_cvt_pk_bf16_f32 v56, v56, v57
    v_cvt_pk_bf16_f32 v57, v58, v59
    v_cvt_pk_bf16_f32 v58, v60, v61
    v_cvt_pk_bf16_f32 v59, v62, v63
    v_cvt_pk_bf16_f32 v64, v64, v65
    v_cvt_pk_bf16_f32 v65, v66, v67
    v_cvt_pk_bf16_f32 v66, v68, v69
    v_cvt_pk_bf16_f32 v67, v70, v71
    v_cvt_pk_bf16_f32 v72, v72, v73
    v_cvt_pk_bf16_f32 v73, v74, v75
    v_cvt_pk_bf16_f32 v74, v76, v77
    v_cvt_pk_bf16_f32 v75, v78, v79
    v_pk_mul_f32 v[0:1], v[0:1], v[230:231] op_sel_hi:[1,0]
    v_pk_mul_f32 v[4:5], v[4:5], v[232:233] op_sel_hi:[1,0]
    v_pk_mul_f32 v[2:3], v[2:3], v[230:231] op_sel_hi:[1,0]
    v_pk_mul_f32 v[6:7], v[6:7], v[232:233] op_sel_hi:[1,0]
    v_cvt_pk_bf16_f32 v80, v0, v1
    v_cvt_pk_bf16_f32 v92, v4, v5
    v_cvt_pk_bf16_f32 v81, v2, v3
    v_cvt_pk_bf16_f32 v93, v6, v7
    v_pk_mul_f32 v[8:9], v[8:9], v[230:231] op_sel_hi:[1,0]
    v_pk_mul_f32 v[12:13], v[12:13], v[232:233] op_sel_hi:[1,0]
    v_pk_mul_f32 v[10:11], v[10:11], v[230:231] op_sel_hi:[1,0]
    v_pk_mul_f32 v[14:15], v[14:15], v[232:233] op_sel_hi:[1,0]
    v_cvt_pk_bf16_f32 v82, v8, v9
    v_cvt_pk_bf16_f32 v94, v12, v13
    v_cvt_pk_bf16_f32 v83, v10, v11
    v_cvt_pk_bf16_f32 v95, v14, v15
    v_pk_mul_f32 v[16:17], v[16:17], v[230:231] op_sel_hi:[1,0]
    v_pk_mul_f32 v[20:21], v[20:21], v[232:233] op_sel_hi:[1,0]
    v_pk_mul_f32 v[18:19], v[18:19], v[230:231] op_sel_hi:[1,0]
    v_pk_mul_f32 v[22:23], v[22:23], v[232:233] op_sel_hi:[1,0]
    v_cvt_pk_bf16_f32 v84, v16, v17
    v_cvt_pk_bf16_f32 v156, v20, v21
    v_cvt_pk_bf16_f32 v85, v18, v19
    v_cvt_pk_bf16_f32 v157, v22, v23
    v_pk_mul_f32 v[24:25], v[24:25], v[230:231] op_sel_hi:[1,0]
    v_pk_mul_f32 v[28:29], v[28:29], v[232:233] op_sel_hi:[1,0]
    v_pk_mul_f32 v[26:27], v[26:27], v[230:231] op_sel_hi:[1,0]
    v_pk_mul_f32 v[30:31], v[30:31], v[232:233] op_sel_hi:[1,0]
    v_cvt_pk_bf16_f32 v86, v24, v25
    v_cvt_pk_bf16_f32 v158, v28, v29
    v_cvt_pk_bf16_f32 v87, v26, v27
    v_cvt_pk_bf16_f32 v159, v30, v31
    v_pk_mul_f32 v[32:33], v[32:33], v[230:231] op_sel_hi:[1,0]
    v_pk_mul_f32 v[36:37], v[36:37], v[232:233] op_sel_hi:[1,0]
    v_pk_mul_f32 v[34:35], v[34:35], v[230:231] op_sel_hi:[1,0]
    v_pk_mul_f32 v[38:39], v[38:39], v[232:233] op_sel_hi:[1,0]
    v_cvt_pk_bf16_f32 v88, v32, v33
    v_cvt_pk_bf16_f32 v238, v36, v37
    v_cvt_pk_bf16_f32 v89, v34, v35
    v_cvt_pk_bf16_f32 v239, v38, v39
    v_mov_b32 v90, 0
    v_mov_b32 v240, 0
    v_mov_b32 v91, 0
    v_mov_b32 v241, 0
    s_waitcnt lgkmcnt(15)
    v_mfma_f32_16x16x32_bf16 v[164:167], v[96:99], v[80:83], 0
    v_mfma_f32_16x16x32_bf16 v[0:3], v[96:99], v[92:95], 0
    s_waitcnt lgkmcnt(15)
    v_mfma_f32_16x16x32_bf16 v[168:171], v[108:111], v[80:83], 0
    v_mfma_f32_16x16x32_bf16 v[8:11], v[108:111], v[92:95], 0
    s_waitcnt lgkmcnt(13)
    v_mfma_f32_16x16x32_bf16 v[172:175], v[120:123], v[80:83], 0
    v_mfma_f32_16x16x32_bf16 v[16:19], v[120:123], v[92:95], 0
    s_waitcnt lgkmcnt(8)
    v_mfma_f32_16x16x32_bf16 v[176:179], v[132:135], v[80:83], 0
    v_mfma_f32_16x16x32_bf16 v[24:27], v[132:135], v[92:95], 0
    s_waitcnt lgkmcnt(3)
    v_mfma_f32_16x16x32_bf16 v[180:183], v[144:147], v[80:83], 0
    v_mfma_f32_16x16x32_bf16 v[32:35], v[144:147], v[92:95], 0
    v_mfma_f32_16x16x32_bf16 v[164:167], v[100:103], v[84:87], v[164:167]
    v_mfma_f32_16x16x32_bf16 v[0:3], v[100:103], v[156:159], v[0:3]
    v_mfma_f32_16x16x32_bf16 v[168:171], v[112:115], v[84:87], v[168:171]
    v_mfma_f32_16x16x32_bf16 v[8:11], v[112:115], v[156:159], v[8:11]
    v_mfma_f32_16x16x32_bf16 v[172:175], v[124:127], v[84:87], v[172:175]
    v_mfma_f32_16x16x32_bf16 v[16:19], v[124:127], v[156:159], v[16:19]
    v_mfma_f32_16x16x32_bf16 v[176:179], v[136:139], v[84:87], v[176:179]
    v_mfma_f32_16x16x32_bf16 v[24:27], v[136:139], v[156:159], v[24:27]
    s_waitcnt lgkmcnt(1)
    v_mfma_f32_16x16x32_bf16 v[180:183], v[148:151], v[84:87], v[180:183]
    v_mfma_f32_16x16x32_bf16 v[32:35], v[148:151], v[156:159], v[32:35]
    v_mfma_f32_16x16x32_bf16 v[164:167], v[104:107], v[88:91], v[164:167]
    v_mfma_f32_16x16x32_bf16 v[0:3], v[104:107], v[238:241], v[0:3]
    v_mfma_f32_16x16x32_bf16 v[168:171], v[116:119], v[88:91], v[168:171]
    v_mfma_f32_16x16x32_bf16 v[8:11], v[116:119], v[238:241], v[8:11]
    v_mfma_f32_16x16x32_bf16 v[172:175], v[128:131], v[88:91], v[172:175]
    v_mfma_f32_16x16x32_bf16 v[16:19], v[128:131], v[238:241], v[16:19]
    v_mfma_f32_16x16x32_bf16 v[176:179], v[140:143], v[88:91], v[176:179]
    v_mfma_f32_16x16x32_bf16 v[24:27], v[140:143], v[238:241], v[24:27]
    s_waitcnt lgkmcnt(0)
    v_mfma_f32_16x16x32_bf16 v[180:183], v[152:155], v[88:91], v[180:183]
    v_mfma_f32_16x16x32_bf16 v[32:35], v[152:155], v[238:241], v[32:35]
    v_max3_f32 v210, v164, v165, v166
    v_max3_f32 v220, v0, v1, v2
    v_min3_f32 v212, v164, v165, v166
    v_min3_f32 v222, v0, v1, v2
    v_max3_f32 v210, v210, v167, v168
    v_max3_f32 v220, v220, v3, v8
    v_min3_f32 v212, v212, v167, v168
    v_min3_f32 v222, v222, v3, v8
    v_max3_f32 v210, v210, v169, v170
    v_max3_f32 v220, v220, v9, v10
    v_min3_f32 v212, v212, v169, v170
    v_min3_f32 v222, v222, v9, v10
    v_max3_f32 v210, v210, v171, v172
    v_max3_f32 v220, v220, v11, v16
    v_min3_f32 v212, v212, v171, v172
    v_min3_f32 v222, v222, v11, v16
    v_max3_f32 v210, v210, v173, v174
    v_max3_f32 v220, v220, v17, v18
    v_min3_f32 v212, v212, v173, v174
    v_min3_f32 v222, v222, v17, v18
    v_max3_f32 v210, v210, v175, v176
    v_max3_f32 v220, v220, v19, v24
    v_min3_f32 v212, v212, v175, v176
    v_min3_f32 v222, v222, v19, v24
    v_max3_f32 v210, v210, v177, v178
    v_max3_f32 v220, v220, v25, v26
    v_min3_f32 v212, v212, v177, v178
    v_min3_f32 v222, v222, v25, v26
    v_max3_f32 v210, v210, v179, v180
    v_max3_f32 v220, v220, v27, v32
    v_min3_f32 v212, v212, v179, v180
    v_min3_f32 v222, v222, v27, v32
    v_max3_f32 v210, v210, v181, v182
    v_max3_f32 v220, v220, v33, v34
    v_min3_f32 v212, v212, v181, v182
    v_min3_f32 v222, v222, v33, v34
    v_max_f32 v210, v210, v183
    v_max_f32 v220, v220, v35
    v_min_f32 v212, v212, v183
    v_min_f32 v222, v222, v35
    v_mov_b32 v214, 0x3fb8aa3b
    v_mov_b32 v224, 0x3fb8aa3b
    v_mul_f32 v210, v210, v214
    v_mul_f32 v220, v220, v224
    v_mul_f32 v212, v212, v214
    v_mul_f32 v222, v222, v224
    v_pk_fma_f32 v[184:185], v[164:165], v[214:215], v[210:211] op_sel_hi:[1,0,0] neg_lo:[0,0,1] neg_hi:[0,0,1]
    v_pk_fma_f32 v[4:5], v[0:1], v[224:225], v[220:221] op_sel_hi:[1,0,0] neg_lo:[0,0,1] neg_hi:[0,0,1]
    v_pk_fma_f32 v[164:165], v[164:165], v[214:215], v[212:213] op_sel_hi:[1,0,0] neg_lo:[1,0,0] neg_hi:[1,0,0]
    v_pk_fma_f32 v[0:1], v[0:1], v[224:225], v[222:223] op_sel_hi:[1,0,0] neg_lo:[1,0,0] neg_hi:[1,0,0]
    v_pk_fma_f32 v[186:187], v[166:167], v[214:215], v[210:211] op_sel_hi:[1,0,0] neg_lo:[0,0,1] neg_hi:[0,0,1]
    v_pk_fma_f32 v[6:7], v[2:3], v[224:225], v[220:221] op_sel_hi:[1,0,0] neg_lo:[0,0,1] neg_hi:[0,0,1]
    v_pk_fma_f32 v[166:167], v[166:167], v[214:215], v[212:213] op_sel_hi:[1,0,0] neg_lo:[1,0,0] neg_hi:[1,0,0]
    v_pk_fma_f32 v[2:3], v[2:3], v[224:225], v[222:223] op_sel_hi:[1,0,0] neg_lo:[1,0,0] neg_hi:[1,0,0]
    v_pk_fma_f32 v[188:189], v[168:169], v[214:215], v[210:211] op_sel_hi:[1,0,0] neg_lo:[0,0,1] neg_hi:[0,0,1]
    v_pk_fma_f32 v[12:13], v[8:9], v[224:225], v[220:221] op_sel_hi:[1,0,0] neg_lo:[0,0,1] neg_hi:[0,0,1]
    v_pk_fma_f32 v[168:169], v[168:169], v[214:215], v[212:213] op_sel_hi:[1,0,0] neg_lo:[1,0,0] neg_hi:[1,0,0]
    v_pk_fma_f32 v[8:9], v[8:9], v[224:225], v[222:223] op_sel_hi:[1,0,0] neg_lo:[1,0,0] neg_hi:[1,0,0]
    v_pk_fma_f32 v[190:191], v[170:171], v[214:215], v[210:211] op_sel_hi:[1,0,0] neg_lo:[0,0,1] neg_hi:[0,0,1]
    v_pk_fma_f32 v[14:15], v[10:11], v[224:225], v[220:221] op_sel_hi:[1,0,0] neg_lo:[0,0,1] neg_hi:[0,0,1]
    v_pk_fma_f32 v[170:171], v[170:171], v[214:215], v[212:213] op_sel_hi:[1,0,0] neg_lo:[1,0,0] neg_hi:[1,0,0]
    v_pk_fma_f32 v[10:11], v[10:11], v[224:225], v[222:223] op_sel_hi:[1,0,0] neg_lo:[1,0,0] neg_hi:[1,0,0]
    v_pk_fma_f32 v[192:193], v[172:173], v[214:215], v[210:211] op_sel_hi:[1,0,0] neg_lo:[0,0,1] neg_hi:[0,0,1]
    v_pk_fma_f32 v[20:21], v[16:17], v[224:225], v[220:221] op_sel_hi:[1,0,0] neg_lo:[0,0,1] neg_hi:[0,0,1]
    v_pk_fma_f32 v[172:173], v[172:173], v[214:215], v[212:213] op_sel_hi:[1,0,0] neg_lo:[1,0,0] neg_hi:[1,0,0]
    v_pk_fma_f32 v[16:17], v[16:17], v[224:225], v[222:223] op_sel_hi:[1,0,0] neg_lo:[1,0,0] neg_hi:[1,0,0]
    v_pk_fma_f32 v[194:195], v[174:175], v[214:215], v[210:211] op_sel_hi:[1,0,0] neg_lo:[0,0,1] neg_hi:[0,0,1]
    v_pk_fma_f32 v[22:23], v[18:19], v[224:225], v[220:221] op_sel_hi:[1,0,0] neg_lo:[0,0,1] neg_hi:[0,0,1]
    v_pk_fma_f32 v[174:175], v[174:175], v[214:215], v[212:213] op_sel_hi:[1,0,0] neg_lo:[1,0,0] neg_hi:[1,0,0]
    v_pk_fma_f32 v[18:19], v[18:19], v[224:225], v[222:223] op_sel_hi:[1,0,0] neg_lo:[1,0,0] neg_hi:[1,0,0]
    v_pk_fma_f32 v[196:197], v[176:177], v[214:215], v[210:211] op_sel_hi:[1,0,0] neg_lo:[0,0,1] neg_hi:[0,0,1]
    v_pk_fma_f32 v[28:29], v[24:25], v[224:225], v[220:221] op_sel_hi:[1,0,0] neg_lo:[0,0,1] neg_hi:[0,0,1]
    v_pk_fma_f32 v[176:177], v[176:177], v[214:215], v[212:213] op_sel_hi:[1,0,0] neg_lo:[1,0,0] neg_hi:[1,0,0]
    v_pk_fma_f32 v[24:25], v[24:25], v[224:225], v[222:223] op_sel_hi:[1,0,0] neg_lo:[1,0,0] neg_hi:[1,0,0]
    v_pk_fma_f32 v[198:199], v[178:179], v[214:215], v[210:211] op_sel_hi:[1,0,0] neg_lo:[0,0,1] neg_hi:[0,0,1]
    v_pk_fma_f32 v[30:31], v[26:27], v[224:225], v[220:221] op_sel_hi:[1,0,0] neg_lo:[0,0,1] neg_hi:[0,0,1]
    v_pk_fma_f32 v[178:179], v[178:179], v[214:215], v[212:213] op_sel_hi:[1,0,0] neg_lo:[1,0,0] neg_hi:[1,0,0]
    v_pk_fma_f32 v[26:27], v[26:27], v[224:225], v[222:223] op_sel_hi:[1,0,0] neg_lo:[1,0,0] neg_hi:[1,0,0]
    v_pk_fma_f32 v[200:201], v[180:181], v[214:215], v[210:211] op_sel_hi:[1,0,0] neg_lo:[0,0,1] neg_hi:[0,0,1]
    v_pk_fma_f32 v[36:37], v[32:33], v[224:225], v[220:221] op_sel_hi:[1,0,0] neg_lo:[0,0,1] neg_hi:[0,0,1]
    v_pk_fma_f32 v[180:181], v[180:181], v[214:215], v[212:213] op_sel_hi:[1,0,0] neg_lo:[1,0,0] neg_hi:[1,0,0]
    v_pk_fma_f32 v[32:33], v[32:33], v[224:225], v[222:223] op_sel_hi:[1,0,0] neg_lo:[1,0,0] neg_hi:[1,0,0]
    v_pk_fma_f32 v[202:203], v[182:183], v[214:215], v[210:211] op_sel_hi:[1,0,0] neg_lo:[0,0,1] neg_hi:[0,0,1]
    v_pk_fma_f32 v[38:39], v[34:35], v[224:225], v[220:221] op_sel_hi:[1,0,0] neg_lo:[0,0,1] neg_hi:[0,0,1]
    v_pk_fma_f32 v[182:183], v[182:183], v[214:215], v[212:213] op_sel_hi:[1,0,0] neg_lo:[1,0,0] neg_hi:[1,0,0]
    v_pk_fma_f32 v[34:35], v[34:35], v[224:225], v[222:223] op_sel_hi:[1,0,0] neg_lo:[1,0,0] neg_hi:[1,0,0]
    v_exp_f32 v184, v184
    v_exp_f32 v4, v4
    v_exp_f32 v164, v164
    v_exp_f32 v0, v0
    v_exp_f32 v185, v185
    v_exp_f32 v5, v5
    v_exp_f32 v165, v165
    v_exp_f32 v1, v1
    v_exp_f32 v186, v186
    v_exp_f32 v6, v6
    v_exp_f32 v166, v166
    v_exp_f32 v2, v2
    v_exp_f32 v187, v187
    v_exp_f32 v7, v7
    v_exp_f32 v167, v167
    v_exp_f32 v3, v3
    v_exp_f32 v188, v188
    v_exp_f32 v12, v12
    v_exp_f32 v168, v168
    v_exp_f32 v8, v8
    v_exp_f32 v189, v189
    v_exp_f32 v13, v13
    v_exp_f32 v169, v169
    v_exp_f32 v9, v9
    v_exp_f32 v190, v190
    v_exp_f32 v14, v14
    v_exp_f32 v170, v170
    v_exp_f32 v10, v10
    v_exp_f32 v191, v191
    v_exp_f32 v15, v15
    v_exp_f32 v171, v171
    v_exp_f32 v11, v11
    v_exp_f32 v192, v192
    v_exp_f32 v20, v20
    v_exp_f32 v172, v172
    v_exp_f32 v16, v16
    v_exp_f32 v193, v193
    v_exp_f32 v21, v21
    v_exp_f32 v173, v173
    v_exp_f32 v17, v17
    v_exp_f32 v194, v194
    v_exp_f32 v22, v22
    v_exp_f32 v174, v174
    v_exp_f32 v18, v18
    v_exp_f32 v195, v195
    v_exp_f32 v23, v23
    v_exp_f32 v175, v175
    v_exp_f32 v19, v19
    v_exp_f32 v196, v196
    v_exp_f32 v28, v28
    v_exp_f32 v176, v176
    v_exp_f32 v24, v24
    v_exp_f32 v197, v197
    v_exp_f32 v29, v29
    v_exp_f32 v177, v177
    v_exp_f32 v25, v25
    v_exp_f32 v198, v198
    v_exp_f32 v30, v30
    v_exp_f32 v178, v178
    v_exp_f32 v26, v26
    v_exp_f32 v199, v199
    v_exp_f32 v31, v31
    v_exp_f32 v179, v179
    v_exp_f32 v27, v27
    v_exp_f32 v200, v200
    v_exp_f32 v36, v36
    v_exp_f32 v180, v180
    v_exp_f32 v32, v32
    v_exp_f32 v201, v201
    v_exp_f32 v37, v37
    v_exp_f32 v181, v181
    v_exp_f32 v33, v33
    v_exp_f32 v202, v202
    v_exp_f32 v38, v38
    v_exp_f32 v182, v182
    v_exp_f32 v34, v34
    v_exp_f32 v203, v203
    v_exp_f32 v39, v39
    v_exp_f32 v183, v183
    v_exp_f32 v35, v35
    v_pk_add_f32 v[216:217], v[184:185], v[186:187]
    v_pk_add_f32 v[226:227], v[4:5], v[6:7]
    v_pk_add_f32 v[218:219], v[164:165], v[166:167]
    v_pk_add_f32 v[228:229], v[0:1], v[2:3]
    v_pk_add_f32 v[216:217], v[216:217], v[188:189]
    v_pk_add_f32 v[226:227], v[226:227], v[12:13]
    v_pk_add_f32 v[218:219], v[218:219], v[168:169]
    v_pk_add_f32 v[228:229], v[228:229], v[8:9]
    v_pk_add_f32 v[216:217], v[216:217], v[190:191]
    v_pk_add_f32 v[226:227], v[226:227], v[14:15]
    v_pk_add_f32 v[218:219], v[218:219], v[170:171]
    v_pk_add_f32 v[228:229], v[228:229], v[10:11]
    v_pk_add_f32 v[216:217], v[216:217], v[192:193]
    v_pk_add_f32 v[226:227], v[226:227], v[20:21]
    v_pk_add_f32 v[218:219], v[218:219], v[172:173]
    v_pk_add_f32 v[228:229], v[228:229], v[16:17]
    v_pk_add_f32 v[216:217], v[216:217], v[194:195]
    v_pk_add_f32 v[226:227], v[226:227], v[22:23]
    v_pk_add_f32 v[218:219], v[218:219], v[174:175]
    v_pk_add_f32 v[228:229], v[228:229], v[18:19]
    v_pk_add_f32 v[216:217], v[216:217], v[196:197]
    v_pk_add_f32 v[226:227], v[226:227], v[28:29]
    v_pk_add_f32 v[218:219], v[218:219], v[176:177]
    v_pk_add_f32 v[228:229], v[228:229], v[24:25]
    v_pk_add_f32 v[216:217], v[216:217], v[198:199]
    v_pk_add_f32 v[226:227], v[226:227], v[30:31]
    v_pk_add_f32 v[218:219], v[218:219], v[178:179]
    v_pk_add_f32 v[228:229], v[228:229], v[26:27]
    v_pk_add_f32 v[216:217], v[216:217], v[200:201]
    v_pk_add_f32 v[226:227], v[226:227], v[36:37]
    v_pk_add_f32 v[218:219], v[218:219], v[180:181]
    v_pk_add_f32 v[228:229], v[228:229], v[32:33]
    v_pk_add_f32 v[216:217], v[216:217], v[202:203]
    v_pk_add_f32 v[226:227], v[226:227], v[38:39]
    v_pk_add_f32 v[218:219], v[218:219], v[182:183]
    v_pk_add_f32 v[228:229], v[228:229], v[34:35]
    v_add_f32 v216, v216, v217
    v_add_f32 v226, v226, v227
    v_add_f32 v218, v218, v219
    v_add_f32 v228, v228, v229
    v_rcp_f32 v216, v216
    v_rcp_f32 v226, v226
    v_rcp_f32 v218, v218
    v_rcp_f32 v228, v228
    v_pk_mul_f32 v[184:185], v[184:185], v[216:217] op_sel_hi:[1,0]
    v_pk_mul_f32 v[4:5], v[4:5], v[226:227] op_sel_hi:[1,0]
    v_pk_mul_f32 v[164:165], v[164:165], v[218:219] op_sel_hi:[1,0]
    v_pk_mul_f32 v[0:1], v[0:1], v[228:229] op_sel_hi:[1,0]
    v_pk_mul_f32 v[186:187], v[186:187], v[216:217] op_sel_hi:[1,0]
    v_pk_mul_f32 v[6:7], v[6:7], v[226:227] op_sel_hi:[1,0]
    v_pk_mul_f32 v[166:167], v[166:167], v[218:219] op_sel_hi:[1,0]
    v_pk_mul_f32 v[2:3], v[2:3], v[228:229] op_sel_hi:[1,0]
    v_pk_mul_f32 v[188:189], v[188:189], v[216:217] op_sel_hi:[1,0]
    v_pk_mul_f32 v[12:13], v[12:13], v[226:227] op_sel_hi:[1,0]
    v_pk_mul_f32 v[168:169], v[168:169], v[218:219] op_sel_hi:[1,0]
    v_pk_mul_f32 v[8:9], v[8:9], v[228:229] op_sel_hi:[1,0]
    v_pk_mul_f32 v[190:191], v[190:191], v[216:217] op_sel_hi:[1,0]
    v_pk_mul_f32 v[14:15], v[14:15], v[226:227] op_sel_hi:[1,0]
    v_pk_mul_f32 v[170:171], v[170:171], v[218:219] op_sel_hi:[1,0]
    v_pk_mul_f32 v[10:11], v[10:11], v[228:229] op_sel_hi:[1,0]
    v_pk_mul_f32 v[192:193], v[192:193], v[216:217] op_sel_hi:[1,0]
    v_pk_mul_f32 v[20:21], v[20:21], v[226:227] op_sel_hi:[1,0]
    v_pk_mul_f32 v[172:173], v[172:173], v[218:219] op_sel_hi:[1,0]
    v_pk_mul_f32 v[16:17], v[16:17], v[228:229] op_sel_hi:[1,0]
    v_pk_mul_f32 v[194:195], v[194:195], v[216:217] op_sel_hi:[1,0]
    v_pk_mul_f32 v[22:23], v[22:23], v[226:227] op_sel_hi:[1,0]
    v_pk_mul_f32 v[174:175], v[174:175], v[218:219] op_sel_hi:[1,0]
    v_pk_mul_f32 v[18:19], v[18:19], v[228:229] op_sel_hi:[1,0]
    v_pk_mul_f32 v[196:197], v[196:197], v[216:217] op_sel_hi:[1,0]
    v_pk_mul_f32 v[28:29], v[28:29], v[226:227] op_sel_hi:[1,0]
    v_pk_mul_f32 v[176:177], v[176:177], v[218:219] op_sel_hi:[1,0]
    v_pk_mul_f32 v[24:25], v[24:25], v[228:229] op_sel_hi:[1,0]
    v_pk_mul_f32 v[198:199], v[198:199], v[216:217] op_sel_hi:[1,0]
    v_pk_mul_f32 v[30:31], v[30:31], v[226:227] op_sel_hi:[1,0]
    v_pk_mul_f32 v[178:179], v[178:179], v[218:219] op_sel_hi:[1,0]
    v_pk_mul_f32 v[26:27], v[26:27], v[228:229] op_sel_hi:[1,0]
    v_pk_mul_f32 v[200:201], v[200:201], v[216:217] op_sel_hi:[1,0]
    v_pk_mul_f32 v[36:37], v[36:37], v[226:227] op_sel_hi:[1,0]
    v_pk_mul_f32 v[180:181], v[180:181], v[218:219] op_sel_hi:[1,0]
    v_pk_mul_f32 v[32:33], v[32:33], v[228:229] op_sel_hi:[1,0]
    v_pk_mul_f32 v[202:203], v[202:203], v[216:217] op_sel_hi:[1,0]
    v_pk_mul_f32 v[38:39], v[38:39], v[226:227] op_sel_hi:[1,0]
    v_pk_mul_f32 v[182:183], v[182:183], v[218:219] op_sel_hi:[1,0]
    v_pk_mul_f32 v[34:35], v[34:35], v[228:229] op_sel_hi:[1,0]
    v_cvt_pk_bf16_f32 v184, v184, v185
    v_cvt_pk_bf16_f32 v4, v4, v5
    v_cvt_pk_bf16_f32 v185, v186, v187
    v_cvt_pk_bf16_f32 v5, v6, v7
    v_cvt_pk_bf16_f32 v186, v188, v189
    v_cvt_pk_bf16_f32 v6, v12, v13
    v_cvt_pk_bf16_f32 v187, v190, v191
    v_cvt_pk_bf16_f32 v7, v14, v15
    v_cvt_pk_bf16_f32 v188, v192, v193
    v_cvt_pk_bf16_f32 v12, v20, v21
    v_cvt_pk_bf16_f32 v189, v194, v195
    v_cvt_pk_bf16_f32 v13, v22, v23
    v_cvt_pk_bf16_f32 v190, v196, v197
    v_cvt_pk_bf16_f32 v14, v28, v29
    v_cvt_pk_bf16_f32 v191, v198, v199
    v_cvt_pk_bf16_f32 v15, v30, v31
    v_cvt_pk_bf16_f32 v192, v200, v201
    v_cvt_pk_bf16_f32 v20, v36, v37
    v_cvt_pk_bf16_f32 v193, v202, v203
    v_cvt_pk_bf16_f32 v21, v38, v39
    v_cvt_pk_bf16_f32 v194, v164, v165
    v_cvt_pk_bf16_f32 v22, v0, v1
    v_cvt_pk_bf16_f32 v195, v166, v167
    v_cvt_pk_bf16_f32 v23, v2, v3
    v_cvt_pk_bf16_f32 v196, v168, v169
    v_cvt_pk_bf16_f32 v28, v8, v9
    v_cvt_pk_bf16_f32 v197, v170, v171
    v_cvt_pk_bf16_f32 v29, v10, v11
    v_cvt_pk_bf16_f32 v198, v172, v173
    v_cvt_pk_bf16_f32 v30, v16, v17
    v_cvt_pk_bf16_f32 v199, v174, v175
    v_cvt_pk_bf16_f32 v31, v18, v19
    v_cvt_pk_bf16_f32 v200, v176, v177
    v_cvt_pk_bf16_f32 v36, v24, v25
    v_cvt_pk_bf16_f32 v201, v178, v179
    v_cvt_pk_bf16_f32 v37, v26, v27
    v_cvt_pk_bf16_f32 v202, v180, v181
    v_cvt_pk_bf16_f32 v38, v32, v33
    v_cvt_pk_bf16_f32 v203, v182, v183
    v_cvt_pk_bf16_f32 v39, v34, v35
    v_and_b32 v210, 15, v207
    v_lshrrev_b32 v211, 4, v207
    v_lshrrev_b32 v212, 3, v210
    v_and_b32 v213, 7, v210
    v_and_b32 v214, 1, v213
    v_lshlrev_b32 v214, 4, v214
    v_mov_b32 v215, 0x3f80
    v_lshlrev_b32 v215, v214, v215
    v_lshrrev_b32 v213, 1, v213
    v_add_u32 v216, 0, v212
    v_cmp_eq_u32 s[54:55], v216, v211
    s_nop 1
    v_cndmask_b32 v217, 0, v215, s[54:55]
    v_cmp_eq_u32 vcc, 0, v213
    s_nop 1
    v_cndmask_b32 v144, 0, v217, vcc
    v_cmp_eq_u32 vcc, 1, v213
    s_nop 1
    v_cndmask_b32 v145, 0, v217, vcc
    v_cmp_eq_u32 vcc, 2, v213
    s_nop 1
    v_cndmask_b32 v146, 0, v217, vcc
    v_cmp_eq_u32 vcc, 3, v213
    s_nop 1
    v_cndmask_b32 v147, 0, v217, vcc
    v_add_u32 v216, 2, v212
    v_cmp_eq_u32 s[54:55], v216, v211
    s_nop 1
    v_cndmask_b32 v217, 0, v215, s[54:55]
    v_cmp_eq_u32 vcc, 0, v213
    s_nop 1
    v_cndmask_b32 v148, 0, v217, vcc
    v_cmp_eq_u32 vcc, 1, v213
    s_nop 1
    v_cndmask_b32 v149, 0, v217, vcc
    v_cmp_eq_u32 vcc, 2, v213
    s_nop 1
    v_cndmask_b32 v150, 0, v217, vcc
    v_cmp_eq_u32 vcc, 3, v213
    s_nop 1
    v_cndmask_b32 v151, 0, v217, vcc
    v_mov_b32 v152, 0x3f803f80
    v_mov_b32 v153, 0x3f803f80
    v_mov_b32 v154, 0x3f803f80
    v_mov_b32 v155, 0x3f803f80
    v_mfma_f32_16x16x32_bf16 v[156:159], v[184:187], v[144:147], 0
    v_mul_u32_u24 v218, 13440, v208
    v_mfma_f32_16x16x32_bf16 v[160:163], v[4:7], v[144:147], 0
    v_and_b32 v219, 1, v211
    v_mfma_f32_16x16x32_bf16 v[164:167], v[184:187], v[148:151], 0
    v_lshl_add_u32 v218, v219, 4, v218
    v_mfma_f32_16x16x32_bf16 v[168:171], v[4:7], v[148:151], 0
    v_lshrrev_b32 v219, 1, v211
    v_mfma_f32_16x16x32_bf16 v[172:175], v[188:191], v[144:147], 0
    v_mov_b32 v220, 160320
    v_mfma_f32_16x16x32_bf16 v[176:179], v[12:15], v[144:147], 0
    v_add_u32 v221, 0, v219
    v_cvt_pk_bf16_f32 v104, v156, v157
    v_mul_u32_u24 v222, 3360, v221
    v_cvt_pk_bf16_f32 v105, v158, v159
    v_add_u32 v222, v222, v218
    v_cvt_pk_bf16_f32 v106, v160, v161
    v_mul_u32_u24 v223, 20, v221
    v_cvt_pk_bf16_f32 v107, v162, v163
    v_add_u32 v224, 0, v210
    v_mfma_f32_16x16x32_bf16 v[156:159], v[188:191], v[148:151], 0
    v_sub_u32 v224, v224, v223
    v_mfma_f32_16x16x32_bf16 v[160:163], v[12:15], v[148:151], 0
    v_cvt_pk_bf16_f32 v108, v164, v165
    v_cmp_gt_u32 vcc, 20, v224
    v_cvt_pk_bf16_f32 v109, v166, v167
    v_mul_u32_u24 v224, 160, v224
    v_cvt_pk_bf16_f32 v110, v168, v169
    v_add_u32 v224, v224, v222
    v_cvt_pk_bf16_f32 v111, v170, v171
    v_cndmask_b32 v96, v220, v224, vcc
    v_mfma_f32_16x16x32_bf16 v[164:167], v[192:195], v[144:147], 0
    v_add_u32 v224, 16, v210
    v_mfma_f32_16x16x32_bf16 v[168:171], v[20:23], v[144:147], 0
    v_sub_u32 v224, v224, v223
    v_cvt_pk_bf16_f32 v112, v172, v173
    v_cmp_gt_u32 vcc, 20, v224
    v_cvt_pk_bf16_f32 v113, v174, v175
    v_mul_u32_u24 v224, 160, v224
    v_cvt_pk_bf16_f32 v114, v176, v177
    v_add_u32 v224, v224, v222
    v_cvt_pk_bf16_f32 v115, v178, v179
    v_cndmask_b32 v97, v220, v224, vcc
    v_mfma_f32_16x16x32_bf16 v[172:175], v[192:195], v[148:151], 0
    v_add_u32 v224, 32, v210
    v_mfma_f32_16x16x32_bf16 v[176:179], v[20:23], v[148:151], 0
    v_cvt_pk_bf16_f32 v116, v156, v157
    v_sub_u32 v224, v224, v223
    v_cvt_pk_bf16_f32 v117, v158, v159
    v_cmp_gt_u32 vcc, 20, v224
    v_cvt_pk_bf16_f32 v118, v160, v161
    v_mul_u32_u24 v224, 160, v224
    v_cvt_pk_bf16_f32 v119, v162, v163
    v_add_u32 v224, v224, v222
    v_mfma_f32_16x16x32_bf16 v[156:159], v[196:199], v[144:147], 0
    v_cndmask_b32 v98, v220, v224, vcc
    v_mfma_f32_16x16x32_bf16 v[160:163], v[28:31], v[144:147], 0
    v_cmp_eq_u32 vcc, 0, v210
    v_cvt_pk_bf16_f32 v120, v164, v165
    v_add_u32 v224, 3200, v222
    v_cvt_pk_bf16_f32 v121, v166, v167
    v_cndmask_b32 v102, v220, v224, vcc
    v_cvt_pk_bf16_f32 v122, v168, v169
    v_add_u32 v221, 2, v219
    v_cvt_pk_bf16_f32 v123, v170, v171
    v_mul_u32_u24 v222, 3360, v221
    v_mfma_f32_16x16x32_bf16 v[164:167], v[196:199], v[148:151], 0
    v_add_u32 v222, v222, v218
    v_mfma_f32_16x16x32_bf16 v[168:171], v[28:31], v[148:151], 0
    v_cvt_pk_bf16_f32 v124, v172, v173
    v_mul_u32_u24 v223, 20, v221
    v_cvt_pk_bf16_f32 v125, v174, v175
    v_add_u32 v224, 32, v210
    v_cvt_pk_bf16_f32 v126, v176, v177
    v_sub_u32 v224, v224, v223
    v_cvt_pk_bf16_f32 v127, v178, v179
    v_cmp_gt_u32 vcc, 20, v224
    v_mfma_f32_16x16x32_bf16 v[172:175], v[200:203], v[144:147], 0
    v_mul_u32_u24 v224, 160, v224
    v_mfma_f32_16x16x32_bf16 v[176:179], v[36:39], v[144:147], 0
    v_add_u32 v224, v224, v222
    v_cvt_pk_bf16_f32 v128, v156, v157
    v_cndmask_b32 v99, v220, v224, vcc
    v_cvt_pk_bf16_f32 v129, v158, v159
    v_add_u32 v224, 48, v210
    v_cvt_pk_bf16_f32 v130, v160, v161
    v_sub_u32 v224, v224, v223
    v_cvt_pk_bf16_f32 v131, v162, v163
    v_cmp_gt_u32 vcc, 20, v224
    v_mfma_f32_16x16x32_bf16 v[156:159], v[200:203], v[148:151], 0
    v_mul_u32_u24 v224, 160, v224
    v_mfma_f32_16x16x32_bf16 v[160:163], v[36:39], v[148:151], 0
    v_cvt_pk_bf16_f32 v132, v164, v165
    v_add_u32 v224, v224, v222
    v_cvt_pk_bf16_f32 v133, v166, v167
    v_cndmask_b32 v100, v220, v224, vcc
    v_cvt_pk_bf16_f32 v134, v168, v169
    v_add_u32 v224, 64, v210
    v_cvt_pk_bf16_f32 v135, v170, v171
    v_sub_u32 v224, v224, v223
    v_cvt_pk_bf16_f32 v136, v172, v173
    v_cmp_gt_u32 vcc, 20, v224
    v_cvt_pk_bf16_f32 v137, v174, v175
    v_mul_u32_u24 v224, 160, v224
    v_cvt_pk_bf16_f32 v138, v176, v177
    v_add_u32 v224, v224, v222
    v_cvt_pk_bf16_f32 v139, v178, v179
    v_cndmask_b32 v101, v220, v224, vcc
    v_cvt_pk_bf16_f32 v140, v156, v157
    v_cmp_eq_u32 vcc, 0, v210
    v_cvt_pk_bf16_f32 v141, v158, v159
    v_add_u32 v224, 3200, v222
    v_cvt_pk_bf16_f32 v142, v160, v161
    v_cndmask_b32 v103, v220, v224, vcc
    v_cvt_pk_bf16_f32 v143, v162, v163
    s_waitcnt lgkmcnt(0)
    s_barrier
    v_mfma_f32_16x16x32_bf16 v[156:159], v[104:107], v[40:43], 0
    v_mfma_f32_16x16x32_bf16 v[160:163], v[104:107], v[48:51], 0
    v_mfma_f32_16x16x32_bf16 v[164:167], v[104:107], v[56:59], 0
    v_mfma_f32_16x16x32_bf16 v[168:171], v[104:107], v[152:155], 0
    v_mfma_f32_16x16x32_bf16 v[230:233], v[108:111], v[56:59], 0
    v_mfma_f32_16x16x32_bf16 v[234:237], v[108:111], v[64:67], 0
    v_mfma_f32_16x16x32_bf16 v[238:241], v[108:111], v[72:75], 0
    v_mfma_f32_16x16x32_bf16 v[242:245], v[108:111], v[152:155], 0
    s_nop 0
    ds_write_b128 v96, v[156:159] offset:0
    ds_write_b128 v97, v[160:163] offset:0
    ds_write_b128 v98, v[164:167] offset:0
    ds_write_b128 v102, v[168:171] offset:0
    v_mfma_f32_16x16x32_bf16 v[156:159], v[112:115], v[40:43], 0
    v_mfma_f32_16x16x32_bf16 v[160:163], v[112:115], v[48:51], 0
    v_mfma_f32_16x16x32_bf16 v[164:167], v[112:115], v[56:59], 0
    v_mfma_f32_16x16x32_bf16 v[168:171], v[112:115], v[152:155], 0
    ds_write_b128 v99, v[230:233] offset:0
    ds_write_b128 v100, v[234:237] offset:0
    ds_write_b128 v101, v[238:241] offset:0
    ds_write_b128 v103, v[242:245] offset:0
    v_mfma_f32_16x16x32_bf16 v[230:233], v[116:119], v[56:59], 0
    v_mfma_f32_16x16x32_bf16 v[234:237], v[116:119], v[64:67], 0
    v_mfma_f32_16x16x32_bf16 v[238:241], v[116:119], v[72:75], 0
    v_mfma_f32_16x16x32_bf16 v[242:245], v[116:119], v[152:155], 0
    ds_write_b128 v96, v[156:159] offset:32
    ds_write_b128 v97, v[160:163] offset:32
    ds_write_b128 v98, v[164:167] offset:32
    ds_write_b128 v102, v[168:171] offset:32
    v_mfma_f32_16x16x32_bf16 v[156:159], v[120:123], v[40:43], 0
    v_mfma_f32_16x16x32_bf16 v[160:163], v[120:123], v[48:51], 0
    v_mfma_f32_16x16x32_bf16 v[164:167], v[120:123], v[56:59], 0
    v_mfma_f32_16x16x32_bf16 v[168:171], v[120:123], v[152:155], 0
    ds_write_b128 v99, v[230:233] offset:32
    ds_write_b128 v100, v[234:237] offset:32
    ds_write_b128 v101, v[238:241] offset:32
    ds_write_b128 v103, v[242:245] offset:32
    v_mfma_f32_16x16x32_bf16 v[230:233], v[124:127], v[56:59], 0
    v_mfma_f32_16x16x32_bf16 v[234:237], v[124:127], v[64:67], 0
    v_mfma_f32_16x16x32_bf16 v[238:241], v[124:127], v[72:75], 0
    v_mfma_f32_16x16x32_bf16 v[242:245], v[124:127], v[152:155], 0
    ds_write_b128 v96, v[156:159] offset:64
    ds_write_b128 v97, v[160:163] offset:64
    ds_write_b128 v98, v[164:167] offset:64
    ds_write_b128 v102, v[168:171] offset:64
    v_mfma_f32_16x16x32_bf16 v[156:159], v[128:131], v[40:43], 0
    v_mfma_f32_16x16x32_bf16 v[160:163], v[128:131], v[48:51], 0
    v_mfma_f32_16x16x32_bf16 v[164:167], v[128:131], v[56:59], 0
    v_mfma_f32_16x16x32_bf16 v[168:171], v[128:131], v[152:155], 0
    ds_write_b128 v99, v[230:233] offset:64
    ds_write_b128 v100, v[234:237] offset:64
    ds_write_b128 v101, v[238:241] offset:64
    ds_write_b128 v103, v[242:245] offset:64
    v_mfma_f32_16x16x32_bf16 v[230:233], v[132:135], v[56:59], 0
    v_mfma_f32_16x16x32_bf16 v[234:237], v[132:135], v[64:67], 0
    v_mfma_f32_16x16x32_bf16 v[238:241], v[132:135], v[72:75], 0
    v_mfma_f32_16x16x32_bf16 v[242:245], v[132:135], v[152:155], 0
    ds_write_b128 v96, v[156:159] offset:96
    ds_write_b128 v97, v[160:163] offset:96
    ds_write_b128 v98, v[164:167] offset:96
    ds_write_b128 v102, v[168:171] offset:96
    v_mfma_f32_16x16x32_bf16 v[156:159], v[136:139], v[40:43], 0
    v_mfma_f32_16x16x32_bf16 v[160:163], v[136:139], v[48:51], 0
    v_mfma_f32_16x16x32_bf16 v[164:167], v[136:139], v[56:59], 0
    v_mfma_f32_16x16x32_bf16 v[168:171], v[136:139], v[152:155], 0
    ds_write_b128 v99, v[230:233] offset:96
    ds_write_b128 v100, v[234:237] offset:96
    ds_write_b128 v101, v[238:241] offset:96
    ds_write_b128 v103, v[242:245] offset:96
    v_mfma_f32_16x16x32_bf16 v[230:233], v[140:143], v[56:59], 0
    v_mfma_f32_16x16x32_bf16 v[234:237], v[140:143], v[64:67], 0
    v_mfma_f32_16x16x32_bf16 v[238:241], v[140:143], v[72:75], 0
    v_mfma_f32_16x16x32_bf16 v[242:245], v[140:143], v[152:155], 0
    ds_write_b128 v96, v[156:159] offset:128
    ds_write_b128 v97, v[160:163] offset:128
    ds_write_b128 v98, v[164:167] offset:128
    ds_write_b128 v102, v[168:171] offset:128
    s_nop 0
    ds_write_b128 v99, v[230:233] offset:128
    ds_write_b128 v100, v[234:237] offset:128
    ds_write_b128 v101, v[238:241] offset:128
    ds_write_b128 v103, v[242:245] offset:128
    s_waitcnt lgkmcnt(0)
    s_barrier
    s_add_u32 s40, s24, 0x1100000
    s_addc_u32 s41, s25, 0
    s_and_b32 s41, s41, 0xffff
    s_mov_b32 s42, 0x1a400
    s_mov_b32 s43, 0x00020000
    s_mul_i32 s48, s52, 13440
    v_lshlrev_b32 v210, 2, v209
    ds_read_b32 v32, v210 offset:0
    ds_read_b32 v33, v210 offset:13440
    ds_read_b32 v34, v210 offset:26880
    ds_read_b32 v35, v210 offset:40320
    ds_read_b32 v36, v210 offset:1024
    ds_read_b32 v37, v210 offset:14464
    ds_read_b32 v38, v210 offset:27904
    ds_read_b32 v39, v210 offset:41344
    ds_read_b32 v40, v210 offset:2048
    ds_read_b32 v41, v210 offset:15488
    ds_read_b32 v42, v210 offset:28928
    ds_read_b32 v43, v210 offset:42368
    ds_read_b32 v44, v210 offset:3072
    ds_read_b32 v45, v210 offset:16512
    ds_read_b32 v46, v210 offset:29952
    ds_read_b32 v47, v210 offset:43392
    ds_read_b32 v48, v210 offset:4096
    ds_read_b32 v49, v210 offset:17536
    ds_read_b32 v50, v210 offset:30976
    ds_read_b32 v51, v210 offset:44416
    ds_read_b32 v52, v210 offset:5120
    ds_read_b32 v53, v210 offset:18560
    ds_read_b32 v54, v210 offset:32000
    ds_read_b32 v55, v210 offset:45440
    ds_read_b32 v56, v210 offset:6144
    ds_read_b32 v57, v210 offset:19584
    ds_read_b32 v58, v210 offset:33024
    ds_read_b32 v59, v210 offset:46464
    ds_read_b32 v60, v210 offset:7168
    ds_read_b32 v61, v210 offset:20608
    ds_read_b32 v62, v210 offset:34048
    ds_read_b32 v63, v210 offset:47488
    ds_read_b32 v64, v210 offset:8192
    ds_read_b32 v65, v210 offset:21632
    ds_read_b32 v66, v210 offset:35072
    ds_read_b32 v67, v210 offset:48512
    ds_read_b32 v68, v210 offset:9216
    ds_read_b32 v69, v210 offset:22656
    ds_read_b32 v70, v210 offset:36096
    ds_read_b32 v71, v210 offset:49536
    ds_read_b32 v72, v210 offset:10240
    ds_read_b32 v73, v210 offset:23680
    ds_read_b32 v74, v210 offset:37120
    ds_read_b32 v75, v210 offset:50560
    ds_read_b32 v76, v210 offset:11264
    ds_read_b32 v77, v210 offset:24704
    ds_read_b32 v78, v210 offset:38144
    ds_read_b32 v79, v210 offset:51584
    ds_read_b32 v80, v210 offset:12288
    ds_read_b32 v81, v210 offset:25728
    ds_read_b32 v82, v210 offset:39168
    ds_read_b32 v83, v210 offset:52608
    ds_read_b32 v84, v210 offset:13312
    ds_read_b32 v85, v210 offset:26752
    ds_read_b32 v86, v210 offset:40192
    ds_read_b32 v87, v210 offset:53632
    v_mov_b32 v213, 0x7fffff00
    v_cmp_gt_u32 vcc, 32, v209
    s_nop 1
    v_cndmask_b32 v212, v213, v210, vcc
    s_waitcnt lgkmcnt(15)
    v_add_f32 v32, v32, v33
    s_waitcnt lgkmcnt(15)
    v_add_f32 v34, v34, v35
    v_add_f32 v32, v32, v34
    buffer_atomic_add_f32 v32, v210, s[40:43], s48 offen offset:0 sc1
    s_waitcnt lgkmcnt(15)
    v_add_f32 v36, v36, v37
    s_waitcnt lgkmcnt(15)
    v_add_f32 v38, v38, v39
    v_add_f32 v36, v36, v38
    buffer_atomic_add_f32 v36, v210, s[40:43], s48 offen offset:1024 sc1
    s_waitcnt lgkmcnt(15)
    v_add_f32 v40, v40, v41
    s_waitcnt lgkmcnt(15)
    v_add_f32 v42, v42, v43
    v_add_f32 v40, v40, v42
    buffer_atomic_add_f32 v40, v210, s[40:43], s48 offen offset:2048 sc1
    s_waitcnt lgkmcnt(15)
    v_add_f32 v44, v44, v45
    s_waitcnt lgkmcnt(15)
    v_add_f32 v46, v46, v47
    v_add_f32 v44, v44, v46
    buffer_atomic_add_f32 v44, v210, s[40:43], s48 offen offset:3072 sc1
    s_add_u32 s48, s48, 4096
    s_waitcnt lgkmcnt(15)
    v_add_f32 v48, v48, v49
    s_waitcnt lgkmcnt(15)
    v_add_f32 v50, v50, v51
    v_add_f32 v48, v48, v50
    buffer_atomic_add_f32 v48, v210, s[40:43], s48 offen offset:0 sc1
    s_waitcnt lgkmcnt(15)
    v_add_f32 v52, v52, v53
    s_waitcnt lgkmcnt(15)
    v_add_f32 v54, v54, v55
    v_add_f32 v52, v52, v54
    buffer_atomic_add_f32 v52, v210, s[40:43], s48 offen offset:1024 sc1
    s_waitcnt lgkmcnt(15)
    v_add_f32 v56, v56, v57
    s_waitcnt lgkmcnt(15)
    v_add_f32 v58, v58, v59
    v_add_f32 v56, v56, v58
    buffer_atomic_add_f32 v56, v210, s[40:43], s48 offen offset:2048 sc1
    s_waitcnt lgkmcnt(15)
    v_add_f32 v60, v60, v61
    s_waitcnt lgkmcnt(15)
    v_add_f32 v62, v62, v63
    v_add_f32 v60, v60, v62
    buffer_atomic_add_f32 v60, v210, s[40:43], s48 offen offset:3072 sc1
    s_add_u32 s48, s48, 4096
    s_waitcnt lgkmcnt(15)
    v_add_f32 v64, v64, v65
    s_waitcnt lgkmcnt(15)
    v_add_f32 v66, v66, v67
    v_add_f32 v64, v64, v66
    buffer_atomic_add_f32 v64, v210, s[40:43], s48 offen offset:0 sc1
    s_waitcnt lgkmcnt(15)
    v_add_f32 v68, v68, v69
    s_waitcnt lgkmcnt(15)
    v_add_f32 v70, v70, v71
    v_add_f32 v68, v68, v70
    buffer_atomic_add_f32 v68, v210, s[40:43], s48 offen offset:1024 sc1
    s_waitcnt lgkmcnt(14)
    v_add_f32 v72, v72, v73
    s_waitcnt lgkmcnt(12)
    v_add_f32 v74, v74, v75
    v_add_f32 v72, v72, v74
    buffer_atomic_add_f32 v72, v210, s[40:43], s48 offen offset:2048 sc1
    s_waitcnt lgkmcnt(10)
    v_add_f32 v76, v76, v77
    s_waitcnt lgkmcnt(8)
    v_add_f32 v78, v78, v79
    v_add_f32 v76, v76, v78
    buffer_atomic_add_f32 v76, v210, s[40:43], s48 offen offset:3072 sc1
    s_add_u32 s48, s48, 4096
    s_waitcnt lgkmcnt(6)
    v_add_f32 v80, v80, v81
    s_waitcnt lgkmcnt(4)
    v_add_f32 v82, v82, v83
    v_add_f32 v80, v80, v82
    buffer_atomic_add_f32 v80, v210, s[40:43], s48 offen offset:0 sc1
    s_waitcnt lgkmcnt(2)
    v_add_f32 v84, v84, v85
    s_waitcnt lgkmcnt(0)
    v_add_f32 v86, v86, v87
    v_add_f32 v84, v84, v86
    buffer_atomic_add_f32 v84, v212, s[40:43], s48 offen offset:1024 sc1
    s_waitcnt vmcnt(0)
    s_endpgm
Lk1_q:
    v_mov_b32 v209, v0
    v_and_b32 v207, 63, v0
    v_lshrrev_b32 v208, 6, v0
    s_nop 0
    v_readfirstlane_b32 s47, v208
    s_lshl_b32 s46, s47, 10
    s_mov_b32 s28, s4
    s_and_b32 s29, s5, 0xffff
    s_mov_b32 s30, 0x280000
    s_mov_b32 s31, 0x00020000
    v_lshrrev_b32 v210, 3, v207
    v_and_b32 v211, 7, v207
    v_xor_b32 v212, v211, v210
    s_lshl_b32 s48, s51, 7
    v_lshl_add_u32 v213, v208, 3, v210
    v_add_u32 v213, s48, v213
    s_movk_i32 s49, 1280
    v_mul_lo_u32 v213, v213, s49
    v_lshl_add_u32 v195, v212, 4, v213
    v_add_u32 v196, 81920, v195
    v_and_b32 v213, 3, v208
    v_bfe_u32 v214, v210, 1, 1
    v_and_b32 v215, 1, v213
    v_lshl_add_u32 v214, v215, 1, v214
    v_lshlrev_b32 v214, 1, v214
    v_xor_b32 v214, v211, v214
    v_lshl_add_u32 v215, v213, 3, v210
    s_movk_i32 s49, 3840
    v_mul_lo_u32 v215, v215, s49
    v_lshl_add_u32 v215, v214, 4, v215
    v_lshrrev_b32 v216, 2, v208
    v_lshl_add_u32 v215, v216, 7, v215
    s_mul_i32 s48, s52, 80
    s_and_b32 s48, s48, 0xffc0
    s_lshl_b32 s48, s48, 1
    v_add_u32 v192, s48, v215
    v_add_u32 v193, 1280, v192
    v_add_u32 v194, 2560, v192
    s_mov_b32 s32, s6
    s_and_b32 s33, s7, 0xffff
    s_mov_b32 s34, 0x258000
    s_mov_b32 s35, 0x00020000
    s_mov_b32 s44, 0
    s_mov_b32 s45, 0
    s_add_u32 m0, s46, 0x18000
    s_nop 0
    buffer_load_dwordx4 v195, s[28:31], s44 offen lds
    s_add_u32 m0, s46, 0x1a000
    s_nop 0
    buffer_load_dwordx4 v196, s[28:31], s44 offen lds
    s_add_u32 s44, s44, 128
    s_add_u32 m0, s46, 0x0
    s_nop 0
    buffer_load_dwordx4 v192, s[32:35], s45 offen lds
    s_add_u32 m0, s46, 0x2000
    s_nop 0
    buffer_load_dwordx4 v193, s[32:35], s45 offen lds
    s_add_u32 m0, s46, 0x4000
    s_nop 0
    buffer_load_dwordx4 v194, s[32:35], s45 offen lds
    s_add_u32 s45, s45, 122880
    s_add_u32 m0, s46, 0x1c000
    s_nop 0
    buffer_load_dwordx4 v195, s[28:31], s44 offen lds
    s_add_u32 m0, s46, 0x1e000
    s_nop 0
    buffer_load_dwordx4 v196, s[28:31], s44 offen lds
    s_add_u32 s44, s44, 128
    s_add_u32 m0, s46, 0x6000
    s_nop 0
    buffer_load_dwordx4 v192, s[32:35], s45 offen lds
    s_add_u32 m0, s46, 0x8000
    s_nop 0
    buffer_load_dwordx4 v193, s[32:35], s45 offen lds
    s_add_u32 m0, s46, 0xa000
    s_nop 0
    buffer_load_dwordx4 v194, s[32:35], s45 offen lds
    s_add_u32 s45, s45, 122880
    s_add_u32 m0, s46, 0xc000
    s_nop 0
    buffer_load_dwordx4 v192, s[32:35], s45 offen lds
    s_add_u32 m0, s46, 0xe000
    s_nop 0
    buffer_load_dwordx4 v193, s[32:35], s45 offen lds
    s_add_u32 m0, s46, 0x10000
    s_nop 0
    buffer_load_dwordx4 v194, s[32:35], s45 offen lds
    s_add_u32 s45, s45, 122880
    v_and_b32 v210, 15, v207
    v_lshrrev_b32 v211, 4, v207
    v_lshrrev_b32 v213, 0, v208
    v_and_b32 v213, 3, v213
    v_and_b32 v214, 0, v208
    v_and_b32 v215, 7, v210
    v_mul_u32_u24 v216, 4096, v213
    v_lshl_add_u32 v216, v210, 7, v216
    v_add_u32 v216, 98304, v216
    v_add_u32 v217, 0, v211
    v_xor_b32 v217, v217, v215
    v_lshl_add_u32 v197, v217, 4, v216
    v_add_u32 v217, 4, v211
    v_xor_b32 v217, v217, v215
    v_lshl_add_u32 v198, v217, 4, v216
    v_bfe_u32 v215, v210, 3, 1
    v_and_b32 v216, 1, v211
    v_lshl_add_u32 v215, v216, 1, v215
    v_lshrrev_b32 v216, 2, v210
    v_lshl_add_u32 v216, v211, 3, v216
    v_lshlrev_b32 v216, 7, v216
    v_and_b32 v217, 3, v210
    v_lshl_add_u32 v216, v217, 3, v216
    v_mul_u32_u24 v217, 5, v214
    s_mul_i32 s48, s52, 5
    s_and_b32 s48, s48, 3
    v_add_u32 v217, s48, v217
    v_add_u32 v218, 0, v217
    v_and_b32 v219, 3, v218
    v_xor_b32 v219, v219, v215
    v_lshl_add_u32 v219, v219, 5, v216
    v_lshrrev_b32 v218, 2, v218
    v_lshl_add_u32 v199, v218, 12, v219
    v_add_u32 v200, 0x10000, v199
    v_add_u32 v218, 1, v217
    v_and_b32 v219, 3, v218
    v_xor_b32 v219, v219, v215
    v_lshl_add_u32 v219, v219, 5, v216
    v_lshrrev_b32 v218, 2, v218
    v_lshl_add_u32 v201, v218, 12, v219
    v_add_u32 v202, 0x10000, v201
    v_add_u32 v218, 2, v217
    v_and_b32 v219, 3, v218
    v_xor_b32 v219, v219, v215
    v_lshl_add_u32 v219, v219, 5, v216
    v_lshrrev_b32 v218, 2, v218
    v_lshl_add_u32 v203, v218, 12, v219
    v_add_u32 v204, 0x10000, v203
    v_add_u32 v218, 3, v217
    v_and_b32 v219, 3, v218
    v_xor_b32 v219, v219, v215
    v_lshl_add_u32 v219, v219, 5, v216
    v_lshrrev_b32 v218, 2, v218
    v_lshl_add_u32 v205, v218, 12, v219
    v_add_u32 v206, 0x10000, v205
    s_mov_b32 s36, s8
    s_and_b32 s37, s9, 0xffff
    s_mov_b32 s38, 0x6400
    s_mov_b32 s39, 0x00020000
    s_mul_i32 s48, s52, 3200
    v_lshlrev_b32 v210, 4, v209
    v_add_u32 v211, s48, v210
    buffer_load_dwordx4 v[96:99], v211, s[36:39], 0 offen
    s_mov_b32 s60, s22
    s_and_b32 s61, s23, 0xffff
    s_mov_b32 s62, 0x100
    s_mov_b32 s63, 0x00020000
    s_cmp_lg_u32 s2, 220
    s_cbranch_scc1 LQ_pp_nf
    s_add_u32 s56, s24, 0x1130000
    s_addc_u32 s57, s25, 0
    s_and_b32 s57, s57, 0xffff
    s_mov_b32 s58, 0x1000
    s_mov_b32 s59, 0x00020000
    v_lshlrev_b32 v1, 4, v209
    v_mov_b32 v8, 0
    v_mov_b32 v9, 0
    v_mov_b32 v10, 0
    v_mov_b32 v11, 0
    buffer_store_dwordx4 v[8:11], v1, s[56:59], 0 offen
LQ_pp_nf:
    s_cmp_ge_u32 s2, 220
    s_cbranch_scc1 LQ_pp_done
    s_cmp_ge_u32 s2, 206
    s_cbranch_scc1 LQ_pp_zero
    s_cmp_ge_u32 s2, 78
    s_cbranch_scc1 LQ_pp_stats
    s_mov_b32 s56, s6
    s_and_b32 s57, s7, 0xffff
    s_mov_b32 s58, 0x258000
    s_mov_b32 s59, 0x00020000
    s_movk_i32 s54, 3840
    s_lshl_b32 s55, s2, 7
    s_cmp_lt_u32 s2, 30
    s_cbranch_scc1 LQ_pp_cs
    s_mov_b32 s56, s14
    s_and_b32 s57, s15, 0xffff
    s_mov_b32 s58, 0x1e0000
    s_mov_b32 s59, 0x00020000
    s_movk_i32 s54, 3072
    s_sub_u32 s55, s55, 3840
    s_cmp_lt_u32 s2, 54
    s_cbranch_scc1 LQ_pp_cs
    s_mov_b32 s56, s16
    s_and_b32 s57, s17, 0xffff
    s_mov_b32 s58, 0x1e0000
    s_mov_b32 s59, 0x00020000
    s_sub_u32 s55, s55, 3072
LQ_pp_cs:
    v_and_b32 v1, 7, v209
    v_lshrrev_b32 v2, 3, v209
    v_mul_lo_u32 v2, v2, s54
    v_lshl_add_u32 v2, v1, 4, v2
    v_add_u32 v2, s55, v2
    s_lshl_b32 s54, s54, 6
    s_mov_b32 s55, 0
    buffer_load_dwordx4 v[214:217], v2, s[56:59], s55 offen
    s_add_u32 s55, s55, s54
    buffer_load_dwordx4 v[218:221], v2, s[56:59], s55 offen
    s_add_u32 s55, s55, s54
    buffer_load_dwordx4 v[222:225], v2, s[56:59], s55 offen
    s_add_u32 s55, s55, s54
    buffer_load_dwordx4 v[226:229], v2, s[56:59], s55 offen
    s_add_u32 s55, s55, s54
    buffer_load_dwordx4 v[230:233], v2, s[56:59], s55 offen
    s_add_u32 s55, s55, s54
    buffer_load_dwordx4 v[234:237], v2, s[56:59], s55 offen
    s_add_u32 s55, s55, s54
    buffer_load_dwordx4 v[238:241], v2, s[56:59], s55 offen
    s_add_u32 s55, s55, s54
    buffer_load_dwordx4 v[242:245], v2, s[56:59], s55 offen
    s_add_u32 s55, s55, s54
    buffer_load_dwordx4 v[246:249], v2, s[56:59], s55 offen
    s_add_u32 s55, s55, s54
    buffer_load_dwordx4 v[250:253], v2, s[56:59], s55 offen
    s_branch LQ_pp_done
LQ_pp_stats:
    s_sub_u32 s54, s2, 78
    s_lshl_b32 s54, s54, 4
    v_lshrrev_b32 v1, 5, v209
    v_add_u32 v1, s54, v1
    v_and_b32 v2, 31, v209
    v_mul_u32_u24 v3, 40, v2
    s_movk_i32 s55, 1280
    v_mul_lo_u32 v4, v1, s55
    v_add_u32 v3, v3, v4
    s_waitcnt vmcnt(9)
    buffer_load_dwordx4 v[214:217], v3, s[28:31], 0 offen
    s_waitcnt vmcnt(9)
    buffer_load_dwordx4 v[218:221], v3, s[28:31], 0 offen offset:16
    s_waitcnt vmcnt(9)
    buffer_load_dwordx2 v[222:223], v3, s[28:31], 0 offen offset:32
    s_branch LQ_pp_done
LQ_pp_zero:
    s_add_u32 s56, s24, 0x1100000
    s_addc_u32 s57, s25, 0
    s_and_b32 s57, s57, 0xffff
    s_mov_b32 s58, 0x1a400
    s_mov_b32 s59, 0x00020000
    s_sub_u32 s54, s2, 206
    s_mul_i32 s54, s54, 7680
    v_lshlrev_b32 v1, 4, v209
    v_add_u32 v1, s54, v1
    v_mov_b32 v3, 0x7fffff00
    v_cmp_gt_u32 vcc, 480, v209
    s_nop 1
    v_cndmask_b32 v1, v3, v1, vcc
    v_mov_b32 v8, 0
    v_mov_b32 v9, 0
    v_mov_b32 v10, 0
    v_mov_b32 v11, 0
    buffer_store_dwordx4 v[8:11], v1, s[56:59], 0 offen sc1
LQ_pp_done:
    s_waitcnt vmcnt(0)
    v_lshlrev_b32 v210, 4, v209
    v_add_u32 v211, 147456, v210
    v_mov_b32 v213, 160320
    v_cmp_gt_u32 vcc, 3200, v210
    s_nop 1
    v_cndmask_b32 v211, v213, v211, vcc
    ds_write_b128 v211, v[96:99]
    v_mov_b32 v104, 0
    v_mov_b32 v105, 0
    v_mov_b32 v106, 0
    v_mov_b32 v107, 0
    v_and_b32 v210, 3, v209
    v_lshlrev_b32 v210, 4, v210
    v_add_u32 v210, 160256, v210
    ds_write_b128 v210, v[104:107]
    s_waitcnt lgkmcnt(0)
    v_mov_b32 v0, 0
    v_mov_b32 v1, 0
    v_mov_b32 v2, 0
    v_mov_b32 v3, 0
    v_mov_b32 v4, 0
    v_mov_b32 v5, 0
    v_mov_b32 v6, 0
    v_mov_b32 v7, 0
    v_mov_b32 v8, 0
    v_mov_b32 v9, 0
    v_mov_b32 v10, 0
    v_mov_b32 v11, 0
    v_mov_b32 v12, 0
    v_mov_b32 v13, 0
    v_mov_b32 v14, 0
    v_mov_b32 v15, 0
    v_mov_b32 v16, 0
    v_mov_b32 v17, 0
    v_mov_b32 v18, 0
    v_mov_b32 v19, 0
    v_mov_b32 v20, 0
    v_mov_b32 v21, 0
    v_mov_b32 v22, 0
    v_mov_b32 v23, 0
    v_mov_b32 v24, 0
    v_mov_b32 v25, 0
    v_mov_b32 v26, 0
    v_mov_b32 v27, 0
    v_mov_b32 v28, 0
    v_mov_b32 v29, 0
    v_mov_b32 v30, 0
    v_mov_b32 v31, 0
    v_mov_b32 v32, 0
    v_mov_b32 v33, 0
    v_mov_b32 v34, 0
    v_mov_b32 v35, 0
    v_mov_b32 v36, 0
    v_mov_b32 v37, 0
    v_mov_b32 v38, 0
    v_mov_b32 v39, 0
    s_waitcnt vmcnt(8)
    s_barrier
    ds_read_b128 v[96:99], v197 offset:0
    ds_read_b64_tr_b16 v[104:105], v199 offset:0
    ds_read_b64_tr_b16 v[106:107], v199 offset:512
    ds_read_b128 v[100:103], v197 offset:2048
    ds_read_b64_tr_b16 v[108:109], v201 offset:0
    ds_read_b64_tr_b16 v[110:111], v201 offset:512
    ds_read_b64_tr_b16 v[112:113], v203 offset:0
    ds_read_b64_tr_b16 v[114:115], v203 offset:512
    ds_read_b64_tr_b16 v[116:117], v205 offset:0
    ds_read_b64_tr_b16 v[118:119], v205 offset:512
    ds_read_b64_tr_b16 v[120:121], v199 offset:4096
    ds_read_b64_tr_b16 v[122:123], v199 offset:4608
    s_waitcnt vmcnt(3)
    s_barrier
    s_waitcnt vmcnt(0)
    s_cmp_ge_u32 s2, 206
    s_cbranch_scc1 LQ_p1_done
    s_cmp_ge_u32 s2, 78
    s_cbranch_scc1 LQ_p1_stats
    v_lshlrev_b32 v144, 16, v214
    v_and_b32 v145, 0xffff0000, v214
    v_lshlrev_b32 v146, 16, v215
    v_and_b32 v147, 0xffff0000, v215
    v_lshlrev_b32 v148, 16, v216
    v_and_b32 v149, 0xffff0000, v216
    v_lshlrev_b32 v150, 16, v217
    v_and_b32 v151, 0xffff0000, v217
    v_lshlrev_b32 v152, 16, v218
    v_and_b32 v153, 0xffff0000, v218
    v_lshlrev_b32 v154, 16, v219
    v_and_b32 v155, 0xffff0000, v219
    v_lshlrev_b32 v156, 16, v220
    v_and_b32 v157, 0xffff0000, v220
    v_lshlrev_b32 v158, 16, v221
    v_and_b32 v159, 0xffff0000, v221
    v_pk_add_f32 v[144:145], v[144:145], v[152:153]
    v_pk_add_f32 v[146:147], v[146:147], v[154:155]
    v_pk_add_f32 v[148:149], v[148:149], v[156:157]
    v_pk_add_f32 v[150:151], v[150:151], v[158:159]
    v_lshlrev_b32 v152, 16, v222
    v_and_b32 v153, 0xffff0000, v222
    v_lshlrev_b32 v154, 16, v223
    v_and_b32 v155, 0xffff0000, v223
    v_lshlrev_b32 v156, 16, v224
    v_and_b32 v157, 0xffff0000, v224
    v_lshlrev_b32 v158, 16, v225
    v_and_b32 v159, 0xffff0000, v225
    v_pk_add_f32 v[144:145], v[144:145], v[152:153]
    v_pk_add_f32 v[146:147], v[146:147], v[154:155]
    v_pk_add_f32 v[148:149], v[148:149], v[156:157]
    v_pk_add_f32 v[150:151], v[150:151], v[158:159]
    v_lshlrev_b32 v152, 16, v226
    v_and_b32 v153, 0xffff0000, v226
    v_lshlrev_b32 v154, 16, v227
    v_and_b32 v155, 0xffff0000, v227
    v_lshlrev_b32 v156, 16, v228
    v_and_b32 v157, 0xffff0000, v228
    v_lshlrev_b32 v158, 16, v229
    v_and_b32 v159, 0xffff0000, v229
    v_pk_add_f32 v[144:145], v[144:145], v[152:153]
    v_pk_add_f32 v[146:147], v[146:147], v[154:155]
    v_pk_add_f32 v[148:149], v[148:149], v[156:157]
    v_pk_add_f32 v[150:151], v[150:151], v[158:159]
    v_lshlrev_b32 v152, 16, v230
    v_and_b32 v153, 0xffff0000, v230
    v_lshlrev_b32 v154, 16, v231
    v_and_b32 v155, 0xffff0000, v231
    v_lshlrev_b32 v156, 16, v232
    v_and_b32 v157, 0xffff0000, v232
    v_lshlrev_b32 v158, 16, v233
    v_and_b32 v159, 0xffff0000, v233
    v_pk_add_f32 v[144:145], v[144:145], v[152:153]
    v_pk_add_f32 v[146:147], v[146:147], v[154:155]
    v_pk_add_f32 v[148:149], v[148:149], v[156:157]
    v_pk_add_f32 v[150:151], v[150:151], v[158:159]
    v_lshlrev_b32 v152, 16, v234
    v_and_b32 v153, 0xffff0000, v234
    v_lshlrev_b32 v154, 16, v235
    v_and_b32 v155, 0xffff0000, v235
    v_lshlrev_b32 v156, 16, v236
    v_and_b32 v157, 0xffff0000, v236
    v_lshlrev_b32 v158, 16, v237
    v_and_b32 v159, 0xffff0000, v237
    v_pk_add_f32 v[144:145], v[144:145], v[152:153]
    v_pk_add_f32 v[146:147], v[146:147], v[154:155]
    v_pk_add_f32 v[148:149], v[148:149], v[156:157]
    v_pk_add_f32 v[150:151], v[150:151], v[158:159]
    v_lshlrev_b32 v152, 16, v238
    v_and_b32 v153, 0xffff0000, v238
    v_lshlrev_b32 v154, 16, v239
    v_and_b32 v155, 0xffff0000, v239
    v_lshlrev_b32 v156, 16, v240
    v_and_b32 v157, 0xffff0000, v240
    v_lshlrev_b32 v158, 16, v241
    v_and_b32 v159, 0xffff0000, v241
    v_pk_add_f32 v[144:145], v[144:145], v[152:153]
    v_pk_add_f32 v[146:147], v[146:147], v[154:155]
    v_pk_add_f32 v[148:149], v[148:149], v[156:157]
    v_pk_add_f32 v[150:151], v[150:151], v[158:159]
    v_lshlrev_b32 v152, 16, v242
    v_and_b32 v153, 0xffff0000, v242
    v_lshlrev_b32 v154, 16, v243
    v_and_b32 v155, 0xffff0000, v243
    v_lshlrev_b32 v156, 16, v244
    v_and_b32 v157, 0xffff0000, v244
    v_lshlrev_b32 v158, 16, v245
    v_and_b32 v159, 0xffff0000, v245
    v_pk_add_f32 v[144:145], v[144:145], v[152:153]
    v_pk_add_f32 v[146:147], v[146:147], v[154:155]
    v_pk_add_f32 v[148:149], v[148:149], v[156:157]
    v_pk_add_f32 v[150:151], v[150:151], v[158:159]
    v_lshlrev_b32 v152, 16, v246
    v_and_b32 v153, 0xffff0000, v246
    v_lshlrev_b32 v154, 16, v247
    v_and_b32 v155, 0xffff0000, v247
    v_lshlrev_b32 v156, 16, v248
    v_and_b32 v157, 0xffff0000, v248
    v_lshlrev_b32 v158, 16, v249
    v_and_b32 v159, 0xffff0000, v249
    v_pk_add_f32 v[144:145], v[144:145], v[152:153]
    v_pk_add_f32 v[146:147], v[146:147], v[154:155]
    v_pk_add_f32 v[148:149], v[148:149], v[156:157]
    v_pk_add_f32 v[150:151], v[150:151], v[158:159]
    v_lshlrev_b32 v152, 16, v250
    v_and_b32 v153, 0xffff0000, v250
    v_lshlrev_b32 v154, 16, v251
    v_and_b32 v155, 0xffff0000, v251
    v_lshlrev_b32 v156, 16, v252
    v_and_b32 v157, 0xffff0000, v252
    v_lshlrev_b32 v158, 16, v253
    v_and_b32 v159, 0xffff0000, v253
    v_pk_add_f32 v[144:145], v[144:145], v[152:153]
    v_pk_add_f32 v[146:147], v[146:147], v[154:155]
    v_pk_add_f32 v[148:149], v[148:149], v[156:157]
    v_pk_add_f32 v[150:151], v[150:151], v[158:159]
    v_add_f32_dpp v144, v144, v144 row_ror:8 row_mask:0xf bank_mask:0xf
    v_add_f32_dpp v145, v145, v145 row_ror:8 row_mask:0xf bank_mask:0xf
    v_add_f32_dpp v146, v146, v146 row_ror:8 row_mask:0xf bank_mask:0xf
    v_add_f32_dpp v147, v147, v147 row_ror:8 row_mask:0xf bank_mask:0xf
    v_add_f32_dpp v148, v148, v148 row_ror:8 row_mask:0xf bank_mask:0xf
    v_add_f32_dpp v149, v149, v149 row_ror:8 row_mask:0xf bank_mask:0xf
    v_add_f32_dpp v150, v150, v150 row_ror:8 row_mask:0xf bank_mask:0xf
    v_add_f32_dpp v151, v151, v151 row_ror:8 row_mask:0xf bank_mask:0xf
    v_mov_b32 v152, v144
    v_mov_b32 v153, v144
    s_nop 1
    v_permlane16_swap_b32 v152, v153
    v_add_f32 v144, v152, v153
    v_mov_b32 v154, v145
    v_mov_b32 v155, v145
    s_nop 1
    v_permlane16_swap_b32 v154, v155
    v_add_f32 v145, v154, v155
    v_mov_b32 v156, v146
    v_mov_b32 v157, v146
    s_nop 1
    v_permlane16_swap_b32 v156, v157
    v_add_f32 v146, v156, v157
    v_mov_b32 v158, v147
    v_mov_b32 v159, v147
    s_nop 1
    v_permlane16_swap_b32 v158, v159
    v_add_f32 v147, v158, v159
    v_mov_b32 v152, v148
    v_mov_b32 v153, v148
    s_nop 1
    v_permlane16_swap_b32 v152, v153
    v_add_f32 v148, v152, v153
    v_mov_b32 v154, v149
    v_mov_b32 v155, v149
    s_nop 1
    v_permlane16_swap_b32 v154, v155
    v_add_f32 v149, v154, v155
    v_mov_b32 v156, v150
    v_mov_b32 v157, v150
    s_nop 1
    v_permlane16_swap_b32 v156, v157
    v_add_f32 v150, v156, v157
    v_mov_b32 v158, v151
    v_mov_b32 v159, v151
    s_nop 1
    v_permlane16_swap_b32 v158, v159
    v_add_f32 v151, v158, v159
    v_mov_b32 v152, v144
    v_mov_b32 v153, v144
    s_nop 1
    v_permlane32_swap_b32 v152, v153
    v_add_f32 v144, v152, v153
    v_mov_b32 v154, v145
    v_mov_b32 v155, v145
    s_nop 1
    v_permlane32_swap_b32 v154, v155
    v_add_f32 v145, v154, v155
    v_mov_b32 v156, v146
    v_mov_b32 v157, v146
    s_nop 1
    v_permlane32_swap_b32 v156, v157
    v_add_f32 v146, v156, v157
    v_mov_b32 v158, v147
    v_mov_b32 v159, v147
    s_nop 1
    v_permlane32_swap_b32 v158, v159
    v_add_f32 v147, v158, v159
    v_mov_b32 v152, v148
    v_mov_b32 v153, v148
    s_nop 1
    v_permlane32_swap_b32 v152, v153
    v_add_f32 v148, v152, v153
    v_mov_b32 v154, v149
    v_mov_b32 v155, v149
    s_nop 1
    v_permlane32_swap_b32 v154, v155
    v_add_f32 v149, v154, v155
    v_mov_b32 v156, v150
    v_mov_b32 v157, v150
    s_nop 1
    v_permlane32_swap_b32 v156, v157
    v_add_f32 v150, v156, v157
    v_mov_b32 v158, v151
    v_mov_b32 v159, v151
    s_nop 1
    v_permlane32_swap_b32 v158, v159
    v_add_f32 v151, v158, v159
    v_and_b32 v214, 31, v209
    v_lshlrev_b32 v214, 3, v214
    v_lshlrev_b32 v212, 5, v207
    v_lshl_add_u32 v212, v208, 8, v212
    v_add_u32 v212, 147456, v212
    v_mov_b32 v213, 160320
    v_cmp_gt_u32 vcc, 8, v207
    s_nop 1
    v_cndmask_b32 v212, v213, v212, vcc
    ds_write_b128 v212, v[144:147]
    ds_write_b128 v212, v[148:151] offset:16
    s_waitcnt lgkmcnt(0)
    s_branch LQ_p1_done
LQ_p1_stats:
    v_mov_b32 v226, 0
    v_mov_b32 v227, 0
    v_mov_b32 v228, 0
    v_mov_b32 v229, 0
    v_lshlrev_b32 v210, 16, v214
    v_and_b32 v211, 0xffff0000, v214
    v_pk_add_f32 v[226:227], v[226:227], v[210:211]
    v_pk_fma_f32 v[228:229], v[210:211], v[210:211], v[228:229]
    v_lshlrev_b32 v210, 16, v215
    v_and_b32 v211, 0xffff0000, v215
    v_pk_add_f32 v[226:227], v[226:227], v[210:211]
    v_pk_fma_f32 v[228:229], v[210:211], v[210:211], v[228:229]
    v_lshlrev_b32 v210, 16, v216
    v_and_b32 v211, 0xffff0000, v216
    v_pk_add_f32 v[226:227], v[226:227], v[210:211]
    v_pk_fma_f32 v[228:229], v[210:211], v[210:211], v[228:229]
    v_lshlrev_b32 v210, 16, v217
    v_and_b32 v211, 0xffff0000, v217
    v_pk_add_f32 v[226:227], v[226:227], v[210:211]
    v_pk_fma_f32 v[228:229], v[210:211], v[210:211], v[228:229]
    v_lshlrev_b32 v210, 16, v218
    v_and_b32 v211, 0xffff0000, v218
    v_pk_add_f32 v[226:227], v[226:227], v[210:211]
    v_pk_fma_f32 v[228:229], v[210:211], v[210:211], v[228:229]
    v_lshlrev_b32 v210, 16, v219
    v_and_b32 v211, 0xffff0000, v219
    v_pk_add_f32 v[226:227], v[226:227], v[210:211]
    v_pk_fma_f32 v[228:229], v[210:211], v[210:211], v[228:229]
    v_lshlrev_b32 v210, 16, v220
    v_and_b32 v211, 0xffff0000, v220
    v_pk_add_f32 v[226:227], v[226:227], v[210:211]
    v_pk_fma_f32 v[228:229], v[210:211], v[210:211], v[228:229]
    v_lshlrev_b32 v210, 16, v221
    v_and_b32 v211, 0xffff0000, v221
    v_pk_add_f32 v[226:227], v[226:227], v[210:211]
    v_pk_fma_f32 v[228:229], v[210:211], v[210:211], v[228:229]
    v_lshlrev_b32 v210, 16, v222
    v_and_b32 v211, 0xffff0000, v222
    v_pk_add_f32 v[226:227], v[226:227], v[210:211]
    v_pk_fma_f32 v[228:229], v[210:211], v[210:211], v[228:229]
    v_lshlrev_b32 v210, 16, v223
    v_and_b32 v211, 0xffff0000, v223
    v_pk_add_f32 v[226:227], v[226:227], v[210:211]
    v_pk_fma_f32 v[228:229], v[210:211], v[210:211], v[228:229]
    v_add_f32 v226, v226, v227
    v_add_f32 v228, v228, v229
    s_nop 0
    v_add_f32_dpp v226, v226, v226 row_ror:8 row_mask:0xf bank_mask:0xf
    v_add_f32_dpp v228, v228, v228 row_ror:8 row_mask:0xf bank_mask:0xf
    s_nop 0
    v_add_f32_dpp v226, v226, v226 row_ror:4 row_mask:0xf bank_mask:0xf
    v_add_f32_dpp v228, v228, v228 row_ror:4 row_mask:0xf bank_mask:0xf
    s_nop 0
    v_add_f32_dpp v226, v226, v226 row_ror:2 row_mask:0xf bank_mask:0xf
    v_add_f32_dpp v228, v228, v228 row_ror:2 row_mask:0xf bank_mask:0xf
    s_nop 0
    v_add_f32_dpp v226, v226, v226 row_ror:1 row_mask:0xf bank_mask:0xf
    v_add_f32_dpp v228, v228, v228 row_ror:1 row_mask:0xf bank_mask:0xf
    v_mov_b32 v210, v226
    v_mov_b32 v211, v226
    s_nop 1
    v_permlane16_swap_b32 v210, v211
    v_add_f32 v226, v210, v211
    v_mov_b32 v210, v228
    v_mov_b32 v211, v228
    s_nop 1
    v_permlane16_swap_b32 v210, v211
    v_add_f32 v228, v210, v211
    s_mov_b32 s55, 0x3acccccd
    v_mul_f32 v226, s55, v226
    v_mul_f32 v228, s55, v228
    v_fma_f32 v228, -v226, v226, v228
    v_max_f32 v228, 0, v228
    v_cvt_pk_bf16_f32 v210, v226, v228
    v_lshlrev_b32 v215, 16, v210
    v_and_b32 v211, 0xffff0000, v210
    v_add_f32 v211, 0x3727c5ac, v211
    v_cvt_pk_bf16_f32 v211, v211, v211
    v_lshlrev_b32 v211, 16, v211
    v_sqrt_f32 v211, v211
    s_nop 0
    v_cvt_pk_bf16_f32 v211, v211, v211
    v_lshlrev_b32 v211, 16, v211
    v_rcp_f32 v214, v211
    s_add_u32 s56, s24, 0x1120000
    s_addc_u32 s57, s25, 0
    s_and_b32 s57, s57, 0xffff
    s_mov_b32 s58, 0x4000
    s_mov_b32 s59, 0x00020000
    s_sub_u32 s54, s2, 78
    s_lshl_b32 s54, s54, 4
    v_lshrrev_b32 v212, 5, v209
    v_add_u32 v212, s54, v212
    v_lshlrev_b32 v212, 3, v212
    v_and_b32 v210, 31, v209
    v_mov_b32 v213, 0x7fffff00
    v_cmp_eq_u32 vcc, 0, v210
    s_nop 1
    v_cndmask_b32 v212, v213, v212, vcc
    buffer_store_dwordx2 v[214:215], v212, s[56:59], 0 offen sc1
LQ_p1_done:
    s_add_u32 m0, s46, 0x20000
    s_nop 0
    buffer_load_dwordx4 v195, s[28:31], s44 offen lds
    s_add_u32 m0, s46, 0x22000
    s_nop 0
    buffer_load_dwordx4 v196, s[28:31], s44 offen lds
    s_add_u32 s44, s44, 128
    s_add_u32 m0, s46, 0x12000
    s_nop 0
    buffer_load_dwordx4 v192, s[32:35], s45 offen lds
    s_add_u32 m0, s46, 0x14000
    s_nop 0
    buffer_load_dwordx4 v193, s[32:35], s45 offen lds
    s_add_u32 m0, s46, 0x16000
    s_nop 0
    buffer_load_dwordx4 v194, s[32:35], s45 offen lds
    s_add_u32 s45, s45, 122880
    ds_read_b128 v[144:147], v198 offset:0
    ds_read_b64_tr_b16 v[152:153], v199 offset:24576
    ds_read_b64_tr_b16 v[154:155], v199 offset:25088
    ds_read_b128 v[148:151], v198 offset:2048
    ds_read_b64_tr_b16 v[156:157], v201 offset:24576
    ds_read_b64_tr_b16 v[158:159], v201 offset:25088
    ds_read_b64_tr_b16 v[160:161], v203 offset:24576
    ds_read_b64_tr_b16 v[162:163], v203 offset:25088
    ds_read_b64_tr_b16 v[164:165], v205 offset:24576
    ds_read_b64_tr_b16 v[166:167], v205 offset:25088
    ds_read_b64_tr_b16 v[168:169], v199 offset:28672
    ds_read_b64_tr_b16 v[170:171], v199 offset:29184
    s_waitcnt lgkmcnt(15)
    v_mfma_f32_16x16x32_bf16 v[0:3], v[104:107], v[96:99], v[0:3]
    s_waitcnt lgkmcnt(15)
    v_mfma_f32_16x16x32_bf16 v[4:7], v[104:107], v[100:103], v[4:7]
    s_waitcnt lgkmcnt(15)
    v_mfma_f32_16x16x32_bf16 v[8:11], v[108:111], v[96:99], v[8:11]
    v_mfma_f32_16x16x32_bf16 v[12:15], v[108:111], v[100:103], v[12:15]
    s_waitcnt lgkmcnt(15)
    v_mfma_f32_16x16x32_bf16 v[16:19], v[112:115], v[96:99], v[16:19]
    v_mfma_f32_16x16x32_bf16 v[20:23], v[112:115], v[100:103], v[20:23]
    s_waitcnt lgkmcnt(14)
    v_mfma_f32_16x16x32_bf16 v[24:27], v[116:119], v[96:99], v[24:27]
    v_mfma_f32_16x16x32_bf16 v[28:31], v[116:119], v[100:103], v[28:31]
    s_waitcnt lgkmcnt(12)
    v_mfma_f32_16x16x32_bf16 v[32:35], v[120:123], v[96:99], v[32:35]
    v_mfma_f32_16x16x32_bf16 v[36:39], v[120:123], v[100:103], v[36:39]
    s_waitcnt vmcnt(5)
    s_barrier
    s_cmp_ge_u32 s2, 78
    s_cbranch_scc1 LQ_p2_done
    s_waitcnt lgkmcnt(0)
    v_add_u32 v212, 147456, v214
    ds_read_b64 v[216:217], v212 offset:0
    ds_read_b64 v[218:219], v212 offset:256
    ds_read_b64 v[220:221], v212 offset:512
    ds_read_b64 v[222:223], v212 offset:768
    ds_read_b64 v[224:225], v212 offset:1024
    ds_read_b64 v[226:227], v212 offset:1280
    ds_read_b64 v[228:229], v212 offset:1536
    ds_read_b64 v[230:231], v212 offset:1792
    s_waitcnt lgkmcnt(6)
    v_pk_add_f32 v[216:217], v[216:217], v[218:219]
    s_waitcnt lgkmcnt(5)
    v_pk_add_f32 v[216:217], v[216:217], v[220:221]
    s_waitcnt lgkmcnt(4)
    v_pk_add_f32 v[216:217], v[216:217], v[222:223]
    s_waitcnt lgkmcnt(3)
    v_pk_add_f32 v[216:217], v[216:217], v[224:225]
    s_waitcnt lgkmcnt(2)
    v_pk_add_f32 v[216:217], v[216:217], v[226:227]
    s_waitcnt lgkmcnt(1)
    v_pk_add_f32 v[216:217], v[216:217], v[228:229]
    s_waitcnt lgkmcnt(0)
    v_pk_add_f32 v[216:217], v[216:217], v[230:231]
    s_add_u32 s56, s24, 0x1128000
    s_addc_u32 s57, s25, 0
    s_and_b32 s57, s57, 0xffff
    s_mov_b32 s58, 0x4e00
    s_mov_b32 s59, 0x00020000
    s_lshl_b32 s55, s2, 8
    v_add_u32 v210, s55, v214
    v_mov_b32 v213, 0x7fffff00
    v_cmp_gt_u32 vcc, 32, v209
    s_nop 1
    v_cndmask_b32 v210, v213, v210, vcc
    buffer_store_dwordx2 v[216:217], v210, s[56:59], 0 offen sc1
LQ_p2_done:
    s_add_u32 m0, s46, 0x0
    s_nop 0
    buffer_load_dwordx4 v192, s[32:35], s45 offen lds
    s_add_u32 m0, s46, 0x2000
    s_nop 0
    buffer_load_dwordx4 v193, s[32:35], s45 offen lds
    s_add_u32 m0, s46, 0x4000
    s_nop 0
    buffer_load_dwordx4 v194, s[32:35], s45 offen lds
    s_add_u32 s45, s45, 122880
    ds_read_b128 v[96:99], v197 offset:16384
    ds_read_b64_tr_b16 v[104:105], v199 offset:49152
    ds_read_b64_tr_b16 v[106:107], v199 offset:49664
    ds_read_b128 v[100:103], v197 offset:18432
    ds_read_b64_tr_b16 v[108:109], v201 offset:49152
    ds_read_b64_tr_b16 v[110:111], v201 offset:49664
    ds_read_b64_tr_b16 v[112:113], v203 offset:49152
    ds_read_b64_tr_b16 v[114:115], v203 offset:49664
    ds_read_b64_tr_b16 v[116:117], v205 offset:49152
    ds_read_b64_tr_b16 v[118:119], v205 offset:49664
    ds_read_b64_tr_b16 v[120:121], v199 offset:53248
    ds_read_b64_tr_b16 v[122:123], v199 offset:53760
    s_waitcnt lgkmcnt(15)
    v_mfma_f32_16x16x32_bf16 v[0:3], v[152:155], v[144:147], v[0:3]
    s_waitcnt lgkmcnt(15)
    v_mfma_f32_16x16x32_bf16 v[4:7], v[152:155], v[148:151], v[4:7]
    s_waitcnt lgkmcnt(15)
    v_mfma_f32_16x16x32_bf16 v[8:11], v[156:159], v[144:147], v[8:11]
    v_mfma_f32_16x16x32_bf16 v[12:15], v[156:159], v[148:151], v[12:15]
    s_waitcnt lgkmcnt(15)
    v_mfma_f32_16x16x32_bf16 v[16:19], v[160:163], v[144:147], v[16:19]
    v_mfma_f32_16x16x32_bf16 v[20:23], v[160:163], v[148:151], v[20:23]
    s_waitcnt lgkmcnt(14)
    v_mfma_f32_16x16x32_bf16 v[24:27], v[164:167], v[144:147], v[24:27]
    v_mfma_f32_16x16x32_bf16 v[28:31], v[164:167], v[148:151], v[28:31]
    s_waitcnt lgkmcnt(12)
    v_mfma_f32_16x16x32_bf16 v[32:35], v[168:171], v[144:147], v[32:35]
    v_mfma_f32_16x16x32_bf16 v[36:39], v[168:171], v[148:151], v[36:39]
    s_waitcnt vmcnt(3)
    s_barrier
    s_add_u32 m0, s46, 0x18000
    s_nop 0
    buffer_load_dwordx4 v195, s[28:31], s44 offen lds
    s_add_u32 m0, s46, 0x1a000
    s_nop 0
    buffer_load_dwordx4 v196, s[28:31], s44 offen lds
    s_add_u32 s44, s44, 128
    s_add_u32 m0, s46, 0x6000
    s_nop 0
    buffer_load_dwordx4 v192, s[32:35], s45 offen lds
    s_add_u32 m0, s46, 0x8000
    s_nop 0
    buffer_load_dwordx4 v193, s[32:35], s45 offen lds
    s_add_u32 m0, s46, 0xa000
    s_nop 0
    buffer_load_dwordx4 v194, s[32:35], s45 offen lds
    s_add_u32 s45, s45, 122880
    ds_read_b128 v[144:147], v198 offset:16384
    ds_read_b64_tr_b16 v[152:153], v200 offset:8192
    ds_read_b64_tr_b16 v[154:155], v200 offset:8704
    ds_read_b128 v[148:151], v198 offset:18432
    ds_read_b64_tr_b16 v[156:157], v202 offset:8192
    ds_read_b64_tr_b16 v[158:159], v202 offset:8704
    ds_read_b64_tr_b16 v[160:161], v204 offset:8192
    ds_read_b64_tr_b16 v[162:163], v204 offset:8704
    ds_read_b64_tr_b16 v[164:165], v206 offset:8192
    ds_read_b64_tr_b16 v[166:167], v206 offset:8704
    ds_read_b64_tr_b16 v[168:169], v200 offset:12288
    ds_read_b64_tr_b16 v[170:171], v200 offset:12800
    s_waitcnt lgkmcnt(15)
    v_mfma_f32_16x16x32_bf16 v[0:3], v[104:107], v[96:99], v[0:3]
    s_waitcnt lgkmcnt(15)
    v_mfma_f32_16x16x32_bf16 v[4:7], v[104:107], v[100:103], v[4:7]
    s_waitcnt lgkmcnt(15)
    v_mfma_f32_16x16x32_bf16 v[8:11], v[108:111], v[96:99], v[8:11]
    v_mfma_f32_16x16x32_bf16 v[12:15], v[108:111], v[100:103], v[12:15]
    s_waitcnt lgkmcnt(15)
    v_mfma_f32_16x16x32_bf16 v[16:19], v[112:115], v[96:99], v[16:19]
    v_mfma_f32_16x16x32_bf16 v[20:23], v[112:115], v[100:103], v[20:23]
    s_waitcnt lgkmcnt(14)
    v_mfma_f32_16x16x32_bf16 v[24:27], v[116:119], v[96:99], v[24:27]
    v_mfma_f32_16x16x32_bf16 v[28:31], v[116:119], v[100:103], v[28:31]
    s_waitcnt lgkmcnt(12)
    v_mfma_f32_16x16x32_bf16 v[32:35], v[120:123], v[96:99], v[32:35]
    v_mfma_f32_16x16x32_bf16 v[36:39], v[120:123], v[100:103], v[36:39]
    s_waitcnt vmcnt(5)
    s_barrier
    s_add_u32 m0, s46, 0xc000
    s_nop 0
    buffer_load_dwordx4 v192, s[32:35], s45 offen lds
    s_add_u32 m0, s46, 0xe000
    s_nop 0
    buffer_load_dwordx4 v193, s[32:35], s45 offen lds
    s_add_u32 m0, s46, 0x10000
    s_nop 0
    buffer_load_dwordx4 v194, s[32:35], s45 offen lds
    s_add_u32 s45, s45, 122880
    ds_read_b128 v[96:99], v197 offset:32768
    ds_read_b64_tr_b16 v[104:105], v199 offset:0
    ds_read_b64_tr_b16 v[106:107], v199 offset:512
    ds_read_b128 v[100:103], v197 offset:34816
    ds_read_b64_tr_b16 v[108:109], v201 offset:0
    ds_read_b64_tr_b16 v[110:111], v201 offset:512
    ds_read_b64_tr_b16 v[112:113], v203 offset:0
    ds_read_b64_tr_b16 v[114:115], v203 offset:512
    ds_read_b64_tr_b16 v[116:117], v205 offset:0
    ds_read_b64_tr_b16 v[118:119], v205 offset:512
    ds_read_b64_tr_b16 v[120:121], v199 offset:4096
    ds_read_b64_tr_b16 v[122:123], v199 offset:4608
    s_waitcnt lgkmcnt(15)
    v_mfma_f32_16x16x32_bf16 v[0:3], v[152:155], v[144:147], v[0:3]
    s_waitcnt lgkmcnt(15)
    v_mfma_f32_16x16x32_bf16 v[4:7], v[152:155], v[148:151], v[4:7]
    s_waitcnt lgkmcnt(15)
    v_mfma_f32_16x16x32_bf16 v[8:11], v[156:159], v[144:147], v[8:11]
    v_mfma_f32_16x16x32_bf16 v[12:15], v[156:159], v[148:151], v[12:15]
    s_waitcnt lgkmcnt(15)
    v_mfma_f32_16x16x32_bf16 v[16:19], v[160:163], v[144:147], v[16:19]
    v_mfma_f32_16x16x32_bf16 v[20:23], v[160:163], v[148:151], v[20:23]
    s_waitcnt lgkmcnt(14)
    v_mfma_f32_16x16x32_bf16 v[24:27], v[164:167], v[144:147], v[24:27]
    v_mfma_f32_16x16x32_bf16 v[28:31], v[164:167], v[148:151], v[28:31]
    s_waitcnt lgkmcnt(12)
    v_mfma_f32_16x16x32_bf16 v[32:35], v[168:171], v[144:147], v[32:35]
    v_mfma_f32_16x16x32_bf16 v[36:39], v[168:171], v[148:151], v[36:39]
    s_waitcnt vmcnt(3)
    s_barrier
    s_cmp_ge_u32 s2, 220
    s_cbranch_scc1 LQ_sig
    s_cmp_lg_u32 s47, 0
    s_cbranch_scc1 LQ_sig
    v_mov_b32 v210, 1
    v_mov_b32 v211, 0
    s_mov_b64 exec, 1
    buffer_atomic_add v210, v211, s[60:63], 0 offen sc1
    s_mov_b64 exec, -1
LQ_sig:
    s_add_u32 m0, s46, 0x1c000
    s_nop 0
    buffer_load_dwordx4 v195, s[28:31], s44 offen lds
    s_add_u32 m0, s46, 0x1e000
    s_nop 0
    buffer_load_dwordx4 v196, s[28:31], s44 offen lds
    s_add_u32 s44, s44, 128
    s_add_u32 m0, s46, 0x12000
    s_nop 0
    buffer_load_dwordx4 v192, s[32:35], s45 offen lds
    s_add_u32 m0, s46, 0x14000
    s_nop 0
    buffer_load_dwordx4 v193, s[32:35], s45 offen lds
    s_add_u32 m0, s46, 0x16000
    s_nop 0
    buffer_load_dwordx4 v194, s[32:35], s45 offen lds
    s_add_u32 s45, s45, 122880
    ds_read_b128 v[144:147], v198 offset:32768
    ds_read_b64_tr_b16 v[152:153], v199 offset:24576
    ds_read_b64_tr_b16 v[154:155], v199 offset:25088
    ds_read_b128 v[148:151], v198 offset:34816
    ds_read_b64_tr_b16 v[156:157], v201 offset:24576
    ds_read_b64_tr_b16 v[158:159], v201 offset:25088
    ds_read_b64_tr_b16 v[160:161], v203 offset:24576
    ds_read_b64_tr_b16 v[162:163], v203 offset:25088
    ds_read_b64_tr_b16 v[164:165], v205 offset:24576
    ds_read_b64_tr_b16 v[166:167], v205 offset:25088
    ds_read_b64_tr_b16 v[168:169], v199 offset:28672
    ds_read_b64_tr_b16 v[170:171], v199 offset:29184
    s_waitcnt lgkmcnt(15)
    v_mfma_f32_16x16x32_bf16 v[0:3], v[104:107], v[96:99], v[0:3]
    s_waitcnt lgkmcnt(15)
    v_mfma_f32_16x16x32_bf16 v[4:7], v[104:107], v[100:103], v[4:7]
    s_waitcnt lgkmcnt(15)
    v_mfma_f32_16x16x32_bf16 v[8:11], v[108:111], v[96:99], v[8:11]
    v_mfma_f32_16x16x32_bf16 v[12:15], v[108:111], v[100:103], v[12:15]
    s_waitcnt lgkmcnt(15)
    v_mfma_f32_16x16x32_bf16 v[16:19], v[112:115], v[96:99], v[16:19]
    v_mfma_f32_16x16x32_bf16 v[20:23], v[112:115], v[100:103], v[20:23]
    s_waitcnt lgkmcnt(14)
    v_mfma_f32_16x16x32_bf16 v[24:27], v[116:119], v[96:99], v[24:27]
    v_mfma_f32_16x16x32_bf16 v[28:31], v[116:119], v[100:103], v[28:31]
    s_waitcnt lgkmcnt(12)
    v_mfma_f32_16x16x32_bf16 v[32:35], v[120:123], v[96:99], v[32:35]
    v_mfma_f32_16x16x32_bf16 v[36:39], v[120:123], v[100:103], v[36:39]
    s_waitcnt vmcnt(5)
    s_barrier
    s_add_u32 m0, s46, 0x0
    s_nop 0
    buffer_load_dwordx4 v192, s[32:35], s45 offen lds
    s_add_u32 m0, s46, 0x2000
    s_nop 0
    buffer_load_dwordx4 v193, s[32:35], s45 offen lds
    s_add_u32 m0, s46, 0x4000
    s_nop 0
    buffer_load_dwordx4 v194, s[32:35], s45 offen lds
    s_add_u32 s45, s45, 122880
    ds_read_b128 v[96:99], v197 offset:0
    ds_read_b64_tr_b16 v[104:105], v199 offset:49152
    ds_read_b64_tr_b16 v[106:107], v199 offset:49664
    ds_read_b128 v[100:103], v197 offset:2048
    ds_read_b64_tr_b16 v[108:109], v201 offset:49152
    ds_read_b64_tr_b16 v[110:111], v201 offset:49664
    ds_read_b64_tr_b16 v[112:113], v203 offset:49152
    ds_read_b64_tr_b16 v[114:115], v203 offset:49664
    ds_read_b64_tr_b16 v[116:117], v205 offset:49152
    ds_read_b64_tr_b16 v[118:119], v205 offset:49664
    ds_read_b64_tr_b16 v[120:121], v199 offset:53248
    ds_read_b64_tr_b16 v[122:123], v199 offset:53760
    s_waitcnt lgkmcnt(15)
    v_mfma_f32_16x16x32_bf16 v[0:3], v[152:155], v[144:147], v[0:3]
    s_waitcnt lgkmcnt(15)
    v_mfma_f32_16x16x32_bf16 v[4:7], v[152:155], v[148:151], v[4:7]
    s_waitcnt lgkmcnt(15)
    v_mfma_f32_16x16x32_bf16 v[8:11], v[156:159], v[144:147], v[8:11]
    v_mfma_f32_16x16x32_bf16 v[12:15], v[156:159], v[148:151], v[12:15]
    s_waitcnt lgkmcnt(15)
    v_mfma_f32_16x16x32_bf16 v[16:19], v[160:163], v[144:147], v[16:19]
    v_mfma_f32_16x16x32_bf16 v[20:23], v[160:163], v[148:151], v[20:23]
    s_waitcnt lgkmcnt(14)
    v_mfma_f32_16x16x32_bf16 v[24:27], v[164:167], v[144:147], v[24:27]
    v_mfma_f32_16x16x32_bf16 v[28:31], v[164:167], v[148:151], v[28:31]
    s_waitcnt lgkmcnt(12)
    v_mfma_f32_16x16x32_bf16 v[32:35], v[168:171], v[144:147], v[32:35]
    v_mfma_f32_16x16x32_bf16 v[36:39], v[168:171], v[148:151], v[36:39]
    s_waitcnt vmcnt(3)
    s_barrier
    s_add_u32 m0, s46, 0x20000
    s_nop 0
    buffer_load_dwordx4 v195, s[28:31], s44 offen lds
    s_add_u32 m0, s46, 0x22000
    s_nop 0
    buffer_load_dwordx4 v196, s[28:31], s44 offen lds
    s_add_u32 s44, s44, 128
    s_add_u32 m0, s46, 0x6000
    s_nop 0
    buffer_load_dwordx4 v192, s[32:35], s45 offen lds
    s_add_u32 m0, s46, 0x8000
    s_nop 0
    buffer_load_dwordx4 v193, s[32:35], s45 offen lds
    s_add_u32 m0, s46, 0xa000
    s_nop 0
    buffer_load_dwordx4 v194, s[32:35], s45 offen lds
    s_add_u32 s45, s45, 122880
    ds_read_b128 v[144:147], v198 offset:0
    ds_read_b64_tr_b16 v[152:153], v200 offset:8192
    ds_read_b64_tr_b16 v[154:155], v200 offset:8704
    ds_read_b128 v[148:151], v198 offset:2048
    ds_read_b64_tr_b16 v[156:157], v202 offset:8192
    ds_read_b64_tr_b16 v[158:159], v202 offset:8704
    ds_read_b64_tr_b16 v[160:161], v204 offset:8192
    ds_read_b64_tr_b16 v[162:163], v204 offset:8704
    ds_read_b64_tr_b16 v[164:165], v206 offset:8192
    ds_read_b64_tr_b16 v[166:167], v206 offset:8704
    ds_read_b64_tr_b16 v[168:169], v200 offset:12288
    ds_read_b64_tr_b16 v[170:171], v200 offset:12800
    s_waitcnt lgkmcnt(15)
    v_mfma_f32_16x16x32_bf16 v[0:3], v[104:107], v[96:99], v[0:3]
    s_waitcnt lgkmcnt(15)
    v_mfma_f32_16x16x32_bf16 v[4:7], v[104:107], v[100:103], v[4:7]
    s_waitcnt lgkmcnt(15)
    v_mfma_f32_16x16x32_bf16 v[8:11], v[108:111], v[96:99], v[8:11]
    v_mfma_f32_16x16x32_bf16 v[12:15], v[108:111], v[100:103], v[12:15]
    s_waitcnt lgkmcnt(15)
    v_mfma_f32_16x16x32_bf16 v[16:19], v[112:115], v[96:99], v[16:19]
    v_mfma_f32_16x16x32_bf16 v[20:23], v[112:115], v[100:103], v[20:23]
    s_waitcnt lgkmcnt(14)
    v_mfma_f32_16x16x32_bf16 v[24:27], v[116:119], v[96:99], v[24:27]
    v_mfma_f32_16x16x32_bf16 v[28:31], v[116:119], v[100:103], v[28:31]
    s_waitcnt lgkmcnt(12)
    v_mfma_f32_16x16x32_bf16 v[32:35], v[120:123], v[96:99], v[32:35]
    v_mfma_f32_16x16x32_bf16 v[36:39], v[120:123], v[100:103], v[36:39]
    s_waitcnt vmcnt(5)
    s_barrier
    s_add_u32 m0, s46, 0xc000
    s_nop 0
    buffer_load_dwordx4 v192, s[32:35], s45 offen lds
    s_add_u32 m0, s46, 0xe000
    s_nop 0
    buffer_load_dwordx4 v193, s[32:35], s45 offen lds
    s_add_u32 m0, s46, 0x10000
    s_nop 0
    buffer_load_dwordx4 v194, s[32:35], s45 offen lds
    s_add_u32 s45, s45, 122880
    ds_read_b128 v[96:99], v197 offset:16384
    ds_read_b64_tr_b16 v[104:105], v199 offset:0
    ds_read_b64_tr_b16 v[106:107], v199 offset:512
    ds_read_b128 v[100:103], v197 offset:18432
    ds_read_b64_tr_b16 v[108:109], v201 offset:0
    ds_read_b64_tr_b16 v[110:111], v201 offset:512
    ds_read_b64_tr_b16 v[112:113], v203 offset:0
    ds_read_b64_tr_b16 v[114:115], v203 offset:512
    ds_read_b64_tr_b16 v[116:117], v205 offset:0
    ds_read_b64_tr_b16 v[118:119], v205 offset:512
    ds_read_b64_tr_b16 v[120:121], v199 offset:4096
    ds_read_b64_tr_b16 v[122:123], v199 offset:4608
    s_waitcnt lgkmcnt(15)
    v_mfma_f32_16x16x32_bf16 v[0:3], v[152:155], v[144:147], v[0:3]
    s_waitcnt lgkmcnt(15)
    v_mfma_f32_16x16x32_bf16 v[4:7], v[152:155], v[148:151], v[4:7]
    s_waitcnt lgkmcnt(15)
    v_mfma_f32_16x16x32_bf16 v[8:11], v[156:159], v[144:147], v[8:11]
    v_mfma_f32_16x16x32_bf16 v[12:15], v[156:159], v[148:151], v[12:15]
    s_waitcnt lgkmcnt(15)
    v_mfma_f32_16x16x32_bf16 v[16:19], v[160:163], v[144:147], v[16:19]
    v_mfma_f32_16x16x32_bf16 v[20:23], v[160:163], v[148:151], v[20:23]
    s_waitcnt lgkmcnt(14)
    v_mfma_f32_16x16x32_bf16 v[24:27], v[164:167], v[144:147], v[24:27]
    v_mfma_f32_16x16x32_bf16 v[28:31], v[164:167], v[148:151], v[28:31]
    s_waitcnt lgkmcnt(12)
    v_mfma_f32_16x16x32_bf16 v[32:35], v[168:171], v[144:147], v[32:35]
    v_mfma_f32_16x16x32_bf16 v[36:39], v[168:171], v[148:151], v[36:39]
    s_waitcnt vmcnt(3)
    s_barrier
    s_add_u32 m0, s46, 0x18000
    s_nop 0
    buffer_load_dwordx4 v195, s[28:31], s44 offen lds
    s_add_u32 m0, s46, 0x1a000
    s_nop 0
    buffer_load_dwordx4 v196, s[28:31], s44 offen lds
    s_add_u32 s44, s44, 128
    s_add_u32 m0, s46, 0x12000
    s_nop 0
    buffer_load_dwordx4 v192, s[32:35], s45 offen lds
    s_add_u32 m0, s46, 0x14000
    s_nop 0
    buffer_load_dwordx4 v193, s[32:35], s45 offen lds
    s_add_u32 m0, s46, 0x16000
    s_nop 0
    buffer_load_dwordx4 v194, s[32:35], s45 offen lds
    s_add_u32 s45, s45, 122880
    ds_read_b128 v[144:147], v198 offset:16384
    ds_read_b64_tr_b16 v[152:153], v199 offset:24576
    ds_read_b64_tr_b16 v[154:155], v199 offset:25088
    ds_read_b128 v[148:151], v198 offset:18432
    ds_read_b64_tr_b16 v[156:157], v201 offset:24576
    ds_read_b64_tr_b16 v[158:159], v201 offset:25088
    ds_read_b64_tr_b16 v[160:161], v203 offset:24576
    ds_read_b64_tr_b16 v[162:163], v203 offset:25088
    ds_read_b64_tr_b16 v[164:165], v205 offset:24576
    ds_read_b64_tr_b16 v[166:167], v205 offset:25088
    ds_read_b64_tr_b16 v[168:169], v199 offset:28672
    ds_read_b64_tr_b16 v[170:171], v199 offset:29184
    s_waitcnt lgkmcnt(15)
    v_mfma_f32_16x16x32_bf16 v[0:3], v[104:107], v[96:99], v[0:3]
    s_waitcnt lgkmcnt(15)
    v_mfma_f32_16x16x32_bf16 v[4:7], v[104:107], v[100:103], v[4:7]
    s_waitcnt lgkmcnt(15)
    v_mfma_f32_16x16x32_bf16 v[8:11], v[108:111], v[96:99], v[8:11]
    v_mfma_f32_16x16x32_bf16 v[12:15], v[108:111], v[100:103], v[12:15]
    s_waitcnt lgkmcnt(15)
    v_mfma_f32_16x16x32_bf16 v[16:19], v[112:115], v[96:99], v[16:19]
    v_mfma_f32_16x16x32_bf16 v[20:23], v[112:115], v[100:103], v[20:23]
    s_waitcnt lgkmcnt(14)
    v_mfma_f32_16x16x32_bf16 v[24:27], v[116:119], v[96:99], v[24:27]
    v_mfma_f32_16x16x32_bf16 v[28:31], v[116:119], v[100:103], v[28:31]
    s_waitcnt lgkmcnt(12)
    v_mfma_f32_16x16x32_bf16 v[32:35], v[120:123], v[96:99], v[32:35]
    v_mfma_f32_16x16x32_bf16 v[36:39], v[120:123], v[100:103], v[36:39]
    s_waitcnt vmcnt(5)
    s_barrier
    s_add_u32 m0, s46, 0x0
    s_nop 0
    buffer_load_dwordx4 v192, s[32:35], s45 offen lds
    s_add_u32 m0, s46, 0x2000
    s_nop 0
    buffer_load_dwordx4 v193, s[32:35], s45 offen lds
    s_add_u32 m0, s46, 0x4000
    s_nop 0
    buffer_load_dwordx4 v194, s[32:35], s45 offen lds
    s_add_u32 s45, s45, 122880
    ds_read_b128 v[96:99], v197 offset:32768
    ds_read_b64_tr_b16 v[104:105], v199 offset:49152
    ds_read_b64_tr_b16 v[106:107], v199 offset:49664
    ds_read_b128 v[100:103], v197 offset:34816
    ds_read_b64_tr_b16 v[108:109], v201 offset:49152
    ds_read_b64_tr_b16 v[110:111], v201 offset:49664
    ds_read_b64_tr_b16 v[112:113], v203 offset:49152
    ds_read_b64_tr_b16 v[114:115], v203 offset:49664
    ds_read_b64_tr_b16 v[116:117], v205 offset:49152
    ds_read_b64_tr_b16 v[118:119], v205 offset:49664
    ds_read_b64_tr_b16 v[120:121], v199 offset:53248
    ds_read_b64_tr_b16 v[122:123], v199 offset:53760
    s_waitcnt lgkmcnt(15)
    v_mfma_f32_16x16x32_bf16 v[0:3], v[152:155], v[144:147], v[0:3]
    s_waitcnt lgkmcnt(15)
    v_mfma_f32_16x16x32_bf16 v[4:7], v[152:155], v[148:151], v[4:7]
    s_waitcnt lgkmcnt(15)
    v_mfma_f32_16x16x32_bf16 v[8:11], v[156:159], v[144:147], v[8:11]
    v_mfma_f32_16x16x32_bf16 v[12:15], v[156:159], v[148:151], v[12:15]
    s_waitcnt lgkmcnt(15)
    v_mfma_f32_16x16x32_bf16 v[16:19], v[160:163], v[144:147], v[16:19]
    v_mfma_f32_16x16x32_bf16 v[20:23], v[160:163], v[148:151], v[20:23]
    s_waitcnt lgkmcnt(14)
    v_mfma_f32_16x16x32_bf16 v[24:27], v[164:167], v[144:147], v[24:27]
    v_mfma_f32_16x16x32_bf16 v[28:31], v[164:167], v[148:151], v[28:31]
    s_waitcnt lgkmcnt(12)
    v_mfma_f32_16x16x32_bf16 v[32:35], v[168:171], v[144:147], v[32:35]
    v_mfma_f32_16x16x32_bf16 v[36:39], v[168:171], v[148:151], v[36:39]
    s_waitcnt vmcnt(3)
    s_barrier
    s_add_u32 m0, s46, 0x1c000
    s_nop 0
    buffer_load_dwordx4 v195, s[28:31], s44 offen lds
    s_add_u32 m0, s46, 0x1e000
    s_nop 0
    buffer_load_dwordx4 v196, s[28:31], s44 offen lds
    s_add_u32 s44, s44, 128
    s_add_u32 m0, s46, 0x6000
    s_nop 0
    buffer_load_dwordx4 v192, s[32:35], s45 offen lds
    s_add_u32 m0, s46, 0x8000
    s_nop 0
    buffer_load_dwordx4 v193, s[32:35], s45 offen lds
    s_add_u32 m0, s46, 0xa000
    s_nop 0
    buffer_load_dwordx4 v194, s[32:35], s45 offen lds
    s_add_u32 s45, s45, 122880
    ds_read_b128 v[144:147], v198 offset:32768
    ds_read_b64_tr_b16 v[152:153], v200 offset:8192
    ds_read_b64_tr_b16 v[154:155], v200 offset:8704
    ds_read_b128 v[148:151], v198 offset:34816
    ds_read_b64_tr_b16 v[156:157], v202 offset:8192
    ds_read_b64_tr_b16 v[158:159], v202 offset:8704
    ds_read_b64_tr_b16 v[160:161], v204 offset:8192
    ds_read_b64_tr_b16 v[162:163], v204 offset:8704
    ds_read_b64_tr_b16 v[164:165], v206 offset:8192
    ds_read_b64_tr_b16 v[166:167], v206 offset:8704
    ds_read_b64_tr_b16 v[168:169], v200 offset:12288
    ds_read_b64_tr_b16 v[170:171], v200 offset:12800
    s_waitcnt lgkmcnt(15)
    v_mfma_f32_16x16x32_bf16 v[0:3], v[104:107], v[96:99], v[0:3]
    s_waitcnt lgkmcnt(15)
    v_mfma_f32_16x16x32_bf16 v[4:7], v[104:107], v[100:103], v[4:7]
    s_waitcnt lgkmcnt(15)
    v_mfma_f32_16x16x32_bf16 v[8:11], v[108:111], v[96:99], v[8:11]
    v_mfma_f32_16x16x32_bf16 v[12:15], v[108:111], v[100:103], v[12:15]
    s_waitcnt lgkmcnt(15)
    v_mfma_f32_16x16x32_bf16 v[16:19], v[112:115], v[96:99], v[16:19]
    v_mfma_f32_16x16x32_bf16 v[20:23], v[112:115], v[100:103], v[20:23]
    s_waitcnt lgkmcnt(14)
    v_mfma_f32_16x16x32_bf16 v[24:27], v[116:119], v[96:99], v[24:27]
    v_mfma_f32_16x16x32_bf16 v[28:31], v[116:119], v[100:103], v[28:31]
    s_waitcnt lgkmcnt(12)
    v_mfma_f32_16x16x32_bf16 v[32:35], v[120:123], v[96:99], v[32:35]
    v_mfma_f32_16x16x32_bf16 v[36:39], v[120:123], v[100:103], v[36:39]
    s_waitcnt vmcnt(5)
    s_barrier
    s_add_u32 m0, s46, 0xc000
    s_nop 0
    buffer_load_dwordx4 v192, s[32:35], s45 offen lds
    s_add_u32 m0, s46, 0xe000
    s_nop 0
    buffer_load_dwordx4 v193, s[32:35], s45 offen lds
    s_add_u32 m0, s46, 0x10000
    s_nop 0
    buffer_load_dwordx4 v194, s[32:35], s45 offen lds
    s_add_u32 s45, s45, 122880
    ds_read_b128 v[96:99], v197 offset:0
    ds_read_b64_tr_b16 v[104:105], v199 offset:0
    ds_read_b64_tr_b16 v[106:107], v199 offset:512
    ds_read_b128 v[100:103], v197 offset:2048
    ds_read_b64_tr_b16 v[108:109], v201 offset:0
    ds_read_b64_tr_b16 v[110:111], v201 offset:512
    ds_read_b64_tr_b16 v[112:113], v203 offset:0
    ds_read_b64_tr_b16 v[114:115], v203 offset:512
    ds_read_b64_tr_b16 v[116:117], v205 offset:0
    ds_read_b64_tr_b16 v[118:119], v205 offset:512
    ds_read_b64_tr_b16 v[120:121], v199 offset:4096
    ds_read_b64_tr_b16 v[122:123], v199 offset:4608
    s_waitcnt lgkmcnt(15)
    v_mfma_f32_16x16x32_bf16 v[0:3], v[152:155], v[144:147], v[0:3]
    s_waitcnt lgkmcnt(15)
    v_mfma_f32_16x16x32_bf16 v[4:7], v[152:155], v[148:151], v[4:7]
    s_waitcnt lgkmcnt(15)
    v_mfma_f32_16x16x32_bf16 v[8:11], v[156:159], v[144:147], v[8:11]
    v_mfma_f32_16x16x32_bf16 v[12:15], v[156:159], v[148:151], v[12:15]
    s_waitcnt lgkmcnt(15)
    v_mfma_f32_16x16x32_bf16 v[16:19], v[160:163], v[144:147], v[16:19]
    v_mfma_f32_16x16x32_bf16 v[20:23], v[160:163], v[148:151], v[20:23]
    s_waitcnt lgkmcnt(14)
    v_mfma_f32_16x16x32_bf16 v[24:27], v[164:167], v[144:147], v[24:27]
    v_mfma_f32_16x16x32_bf16 v[28:31], v[164:167], v[148:151], v[28:31]
    s_waitcnt lgkmcnt(12)
    v_mfma_f32_16x16x32_bf16 v[32:35], v[168:171], v[144:147], v[32:35]
    v_mfma_f32_16x16x32_bf16 v[36:39], v[168:171], v[148:151], v[36:39]
    s_waitcnt vmcnt(3)
    s_barrier
    s_add_u32 m0, s46, 0x20000
    s_nop 0
    buffer_load_dwordx4 v195, s[28:31], s44 offen lds
    s_add_u32 m0, s46, 0x22000
    s_nop 0
    buffer_load_dwordx4 v196, s[28:31], s44 offen lds
    s_add_u32 s44, s44, 128
    s_add_u32 m0, s46, 0x12000
    s_nop 0
    buffer_load_dwordx4 v192, s[32:35], s45 offen lds
    s_add_u32 m0, s46, 0x14000
    s_nop 0
    buffer_load_dwordx4 v193, s[32:35], s45 offen lds
    s_add_u32 m0, s46, 0x16000
    s_nop 0
    buffer_load_dwordx4 v194, s[32:35], s45 offen lds
    s_add_u32 s45, s45, 122880
    ds_read_b128 v[144:147], v198 offset:0
    ds_read_b64_tr_b16 v[152:153], v199 offset:24576
    ds_read_b64_tr_b16 v[154:155], v199 offset:25088
    ds_read_b128 v[148:151], v198 offset:2048
    ds_read_b64_tr_b16 v[156:157], v201 offset:24576
    ds_read_b64_tr_b16 v[158:159], v201 offset:25088
    ds_read_b64_tr_b16 v[160:161], v203 offset:24576
    ds_read_b64_tr_b16 v[162:163], v203 offset:25088
    ds_read_b64_tr_b16 v[164:165], v205 offset:24576
    ds_read_b64_tr_b16 v[166:167], v205 offset:25088
    ds_read_b64_tr_b16 v[168:169], v199 offset:28672
    ds_read_b64_tr_b16 v[170:171], v199 offset:29184
    s_waitcnt lgkmcnt(15)
    v_mfma_f32_16x16x32_bf16 v[0:3], v[104:107], v[96:99], v[0:3]
    s_waitcnt lgkmcnt(15)
    v_mfma_f32_16x16x32_bf16 v[4:7], v[104:107], v[100:103], v[4:7]
    s_waitcnt lgkmcnt(15)
    v_mfma_f32_16x16x32_bf16 v[8:11], v[108:111], v[96:99], v[8:11]
    v_mfma_f32_16x16x32_bf16 v[12:15], v[108:111], v[100:103], v[12:15]
    s_waitcnt lgkmcnt(15)
    v_mfma_f32_16x16x32_bf16 v[16:19], v[112:115], v[96:99], v[16:19]
    v_mfma_f32_16x16x32_bf16 v[20:23], v[112:115], v[100:103], v[20:23]
    s_waitcnt lgkmcnt(14)
    v_mfma_f32_16x16x32_bf16 v[24:27], v[116:119], v[96:99], v[24:27]
    v_mfma_f32_16x16x32_bf16 v[28:31], v[116:119], v[100:103], v[28:31]
    s_waitcnt lgkmcnt(12)
    v_mfma_f32_16x16x32_bf16 v[32:35], v[120:123], v[96:99], v[32:35]
    v_mfma_f32_16x16x32_bf16 v[36:39], v[120:123], v[100:103], v[36:39]
    s_waitcnt vmcnt(5)
    s_barrier
    s_add_u32 m0, s46, 0x0
    s_nop 0
    buffer_load_dwordx4 v192, s[32:35], s45 offen lds
    s_add_u32 m0, s46, 0x2000
    s_nop 0
    buffer_load_dwordx4 v193, s[32:35], s45 offen lds
    s_add_u32 m0, s46, 0x4000
    s_nop 0
    buffer_load_dwordx4 v194, s[32:35], s45 offen lds
    s_add_u32 s45, s45, 122880
    ds_read_b128 v[96:99], v197 offset:16384
    ds_read_b64_tr_b16 v[104:105], v199 offset:49152
    ds_read_b64_tr_b16 v[106:107], v199 offset:49664
    ds_read_b128 v[100:103], v197 offset:18432
    ds_read_b64_tr_b16 v[108:109], v201 offset:49152
    ds_read_b64_tr_b16 v[110:111], v201 offset:49664
    ds_read_b64_tr_b16 v[112:113], v203 offset:49152
    ds_read_b64_tr_b16 v[114:115], v203 offset:49664
    ds_read_b64_tr_b16 v[116:117], v205 offset:49152
    ds_read_b64_tr_b16 v[118:119], v205 offset:49664
    ds_read_b64_tr_b16 v[120:121], v199 offset:53248
    ds_read_b64_tr_b16 v[122:123], v199 offset:53760
    s_waitcnt lgkmcnt(15)
    v_mfma_f32_16x16x32_bf16 v[0:3], v[152:155], v[144:147], v[0:3]
    s_waitcnt lgkmcnt(15)
    v_mfma_f32_16x16x32_bf16 v[4:7], v[152:155], v[148:151], v[4:7]
    s_waitcnt lgkmcnt(15)
    v_mfma_f32_16x16x32_bf16 v[8:11], v[156:159], v[144:147], v[8:11]
    v_mfma_f32_16x16x32_bf16 v[12:15], v[156:159], v[148:151], v[12:15]
    s_waitcnt lgkmcnt(15)
    v_mfma_f32_16x16x32_bf16 v[16:19], v[160:163], v[144:147], v[16:19]
    v_mfma_f32_16x16x32_bf16 v[20:23], v[160:163], v[148:151], v[20:23]
    s_waitcnt lgkmcnt(14)
    v_mfma_f32_16x16x32_bf16 v[24:27], v[164:167], v[144:147], v[24:27]
    v_mfma_f32_16x16x32_bf16 v[28:31], v[164:167], v[148:151], v[28:31]
    s_waitcnt lgkmcnt(12)
    v_mfma_f32_16x16x32_bf16 v[32:35], v[168:171], v[144:147], v[32:35]
    v_mfma_f32_16x16x32_bf16 v[36:39], v[168:171], v[148:151], v[36:39]
    s_waitcnt vmcnt(3)
    s_barrier
    s_add_u32 m0, s46, 0x18000
    s_nop 0
    buffer_load_dwordx4 v195, s[28:31], s44 offen lds
    s_add_u32 m0, s46, 0x1a000
    s_nop 0
    buffer_load_dwordx4 v196, s[28:31], s44 offen lds
    s_add_u32 s44, s44, 128
    s_add_u32 m0, s46, 0x6000
    s_nop 0
    buffer_load_dwordx4 v192, s[32:35], s45 offen lds
    s_add_u32 m0, s46, 0x8000
    s_nop 0
    buffer_load_dwordx4 v193, s[32:35], s45 offen lds
    s_add_u32 m0, s46, 0xa000
    s_nop 0
    buffer_load_dwordx4 v194, s[32:35], s45 offen lds
    s_add_u32 s45, s45, 122880
    ds_read_b128 v[144:147], v198 offset:16384
    ds_read_b64_tr_b16 v[152:153], v200 offset:8192
    ds_read_b64_tr_b16 v[154:155], v200 offset:8704
    ds_read_b128 v[148:151], v198 offset:18432
    ds_read_b64_tr_b16 v[156:157], v202 offset:8192
    ds_read_b64_tr_b16 v[158:159], v202 offset:8704
    ds_read_b64_tr_b16 v[160:161], v204 offset:8192
    ds_read_b64_tr_b16 v[162:163], v204 offset:8704
    ds_read_b64_tr_b16 v[164:165], v206 offset:8192
    ds_read_b64_tr_b16 v[166:167], v206 offset:8704
    ds_read_b64_tr_b16 v[168:169], v200 offset:12288
    ds_read_b64_tr_b16 v[170:171], v200 offset:12800
    s_waitcnt lgkmcnt(15)
    v_mfma_f32_16x16x32_bf16 v[0:3], v[104:107], v[96:99], v[0:3]
    s_waitcnt lgkmcnt(15)
    v_mfma_f32_16x16x32_bf16 v[4:7], v[104:107], v[100:103], v[4:7]
    s_waitcnt lgkmcnt(15)
    v_mfma_f32_16x16x32_bf16 v[8:11], v[108:111], v[96:99], v[8:11]
    v_mfma_f32_16x16x32_bf16 v[12:15], v[108:111], v[100:103], v[12:15]
    s_waitcnt lgkmcnt(15)
    v_mfma_f32_16x16x32_bf16 v[16:19], v[112:115], v[96:99], v[16:19]
    v_mfma_f32_16x16x32_bf16 v[20:23], v[112:115], v[100:103], v[20:23]
    s_waitcnt lgkmcnt(14)
    v_mfma_f32_16x16x32_bf16 v[24:27], v[116:119], v[96:99], v[24:27]
    v_mfma_f32_16x16x32_bf16 v[28:31], v[116:119], v[100:103], v[28:31]
    s_waitcnt lgkmcnt(12)
    v_mfma_f32_16x16x32_bf16 v[32:35], v[120:123], v[96:99], v[32:35]
    v_mfma_f32_16x16x32_bf16 v[36:39], v[120:123], v[100:103], v[36:39]
    s_waitcnt vmcnt(5)
    s_barrier
    s_add_u32 m0, s46, 0xc000
    s_nop 0
    buffer_load_dwordx4 v192, s[32:35], s45 offen lds
    s_add_u32 m0, s46, 0xe000
    s_nop 0
    buffer_load_dwordx4 v193, s[32:35], s45 offen lds
    s_add_u32 m0, s46, 0x10000
    s_nop 0
    buffer_load_dwordx4 v194, s[32:35], s45 offen lds
    s_add_u32 s45, s45, 122880
    v_mov_b32 v210, 0
    buffer_load_dword v211, v210, s[60:63], 0 offen sc1
    ds_read_b128 v[96:99], v197 offset:32768
    ds_read_b64_tr_b16 v[104:105], v199 offset:0
    ds_read_b64_tr_b16 v[106:107], v199 offset:512
    ds_read_b128 v[100:103], v197 offset:34816
    ds_read_b64_tr_b16 v[108:109], v201 offset:0
    ds_read_b64_tr_b16 v[110:111], v201 offset:512
    ds_read_b64_tr_b16 v[112:113], v203 offset:0
    ds_read_b64_tr_b16 v[114:115], v203 offset:512
    ds_read_b64_tr_b16 v[116:117], v205 offset:0
    ds_read_b64_tr_b16 v[118:119], v205 offset:512
    ds_read_b64_tr_b16 v[120:121], v199 offset:4096
    ds_read_b64_tr_b16 v[122:123], v199 offset:4608
    s_waitcnt lgkmcnt(15)
    v_mfma_f32_16x16x32_bf16 v[0:3], v[152:155], v[144:147], v[0:3]
    s_waitcnt lgkmcnt(15)
    v_mfma_f32_16x16x32_bf16 v[4:7], v[152:155], v[148:151], v[4:7]
    s_waitcnt lgkmcnt(15)
    v_mfma_f32_16x16x32_bf16 v[8:11], v[156:159], v[144:147], v[8:11]
    v_mfma_f32_16x16x32_bf16 v[12:15], v[156:159], v[148:151], v[12:15]
    s_waitcnt lgkmcnt(15)
    v_mfma_f32_16x16x32_bf16 v[16:19], v[160:163], v[144:147], v[16:19]
    v_mfma_f32_16x16x32_bf16 v[20:23], v[160:163], v[148:151], v[20:23]
    s_waitcnt lgkmcnt(14)
    v_mfma_f32_16x16x32_bf16 v[24:27], v[164:167], v[144:147], v[24:27]
    v_mfma_f32_16x16x32_bf16 v[28:31], v[164:167], v[148:151], v[28:31]
    s_waitcnt lgkmcnt(12)
    v_mfma_f32_16x16x32_bf16 v[32:35], v[168:171], v[144:147], v[32:35]
    v_mfma_f32_16x16x32_bf16 v[36:39], v[168:171], v[148:151], v[36:39]
    s_waitcnt vmcnt(4)
    s_barrier
    s_add_u32 m0, s46, 0x12000
    s_nop 0
    buffer_load_dwordx4 v192, s[32:35], s45 offen lds
    s_add_u32 m0, s46, 0x14000
    s_nop 0
    buffer_load_dwordx4 v193, s[32:35], s45 offen lds
    s_add_u32 m0, s46, 0x16000
    s_nop 0
    buffer_load_dwordx4 v194, s[32:35], s45 offen lds
    s_add_u32 s45, s45, 122880
    ds_read_b128 v[144:147], v198 offset:32768
    ds_read_b64_tr_b16 v[152:153], v199 offset:24576
    ds_read_b64_tr_b16 v[154:155], v199 offset:25088
    ds_read_b128 v[148:151], v198 offset:34816
    ds_read_b64_tr_b16 v[156:157], v201 offset:24576
    ds_read_b64_tr_b16 v[158:159], v201 offset:25088
    ds_read_b64_tr_b16 v[160:161], v203 offset:24576
    ds_read_b64_tr_b16 v[162:163], v203 offset:25088
    ds_read_b64_tr_b16 v[164:165], v205 offset:24576
    ds_read_b64_tr_b16 v[166:167], v205 offset:25088
    ds_read_b64_tr_b16 v[168:169], v199 offset:28672
    ds_read_b64_tr_b16 v[170:171], v199 offset:29184
    s_waitcnt lgkmcnt(15)
    v_mfma_f32_16x16x32_bf16 v[0:3], v[104:107], v[96:99], v[0:3]
    s_waitcnt lgkmcnt(15)
    v_mfma_f32_16x16x32_bf16 v[4:7], v[104:107], v[100:103], v[4:7]
    s_waitcnt lgkmcnt(15)
    v_mfma_f32_16x16x32_bf16 v[8:11], v[108:111], v[96:99], v[8:11]
    v_mfma_f32_16x16x32_bf16 v[12:15], v[108:111], v[100:103], v[12:15]
    s_waitcnt lgkmcnt(15)
    v_mfma_f32_16x16x32_bf16 v[16:19], v[112:115], v[96:99], v[16:19]
    v_mfma_f32_16x16x32_bf16 v[20:23], v[112:115], v[100:103], v[20:23]
    s_waitcnt lgkmcnt(14)
    v_mfma_f32_16x16x32_bf16 v[24:27], v[116:119], v[96:99], v[24:27]
    v_mfma_f32_16x16x32_bf16 v[28:31], v[116:119], v[100:103], v[28:31]
    s_waitcnt lgkmcnt(12)
    v_mfma_f32_16x16x32_bf16 v[32:35], v[120:123], v[96:99], v[32:35]
    v_mfma_f32_16x16x32_bf16 v[36:39], v[120:123], v[100:103], v[36:39]
    s_waitcnt vmcnt(4)
    s_barrier
    ds_read_b128 v[96:99], v197 offset:0
    ds_read_b64_tr_b16 v[104:105], v199 offset:49152
    ds_read_b64_tr_b16 v[106:107], v199 offset:49664
    ds_read_b128 v[100:103], v197 offset:2048
    ds_read_b64_tr_b16 v[108:109], v201 offset:49152
    ds_read_b64_tr_b16 v[110:111], v201 offset:49664
    ds_read_b64_tr_b16 v[112:113], v203 offset:49152
    ds_read_b64_tr_b16 v[114:115], v203 offset:49664
    ds_read_b64_tr_b16 v[116:117], v205 offset:49152
    ds_read_b64_tr_b16 v[118:119], v205 offset:49664
    ds_read_b64_tr_b16 v[120:121], v199 offset:53248
    ds_read_b64_tr_b16 v[122:123], v199 offset:53760
    s_waitcnt lgkmcnt(15)
    v_mfma_f32_16x16x32_bf16 v[0:3], v[152:155], v[144:147], v[0:3]
    s_waitcnt lgkmcnt(15)
    v_mfma_f32_16x16x32_bf16 v[4:7], v[152:155], v[148:151], v[4:7]
    s_waitcnt lgkmcnt(15)
    v_mfma_f32_16x16x32_bf16 v[8:11], v[156:159], v[144:147], v[8:11]
    v_mfma_f32_16x16x32_bf16 v[12:15], v[156:159], v[148:151], v[12:15]
    s_waitcnt lgkmcnt(15)
    v_mfma_f32_16x16x32_bf16 v[16:19], v[160:163], v[144:147], v[16:19]
    v_mfma_f32_16x16x32_bf16 v[20:23], v[160:163], v[148:151], v[20:23]
    s_waitcnt lgkmcnt(14)
    v_mfma_f32_16x16x32_bf16 v[24:27], v[164:167], v[144:147], v[24:27]
    v_mfma_f32_16x16x32_bf16 v[28:31], v[164:167], v[148:151], v[28:31]
    s_waitcnt lgkmcnt(12)
    v_mfma_f32_16x16x32_bf16 v[32:35], v[168:171], v[144:147], v[32:35]
    v_mfma_f32_16x16x32_bf16 v[36:39], v[168:171], v[148:151], v[36:39]
    s_waitcnt vmcnt(0)
    s_cmp_lg_u32 s47, 0
    s_cbranch_scc1 LQ_wf_ok
    v_readfirstlane_b32 s48, v211
    s_cmp_ge_u32 s48, 220
    s_cbranch_scc1 LQ_wf_ok
    v_mov_b32 v210, 0
    s_mov_b32 s49, 0
LQ_wf:
    buffer_load_dword v211, v210, s[60:63], 0 offen sc1
    s_waitcnt vmcnt(0)
    v_readfirstlane_b32 s48, v211
    s_cmp_ge_u32 s48, 220
    s_cbranch_scc1 LQ_wf_ok
    s_sleep 8
    s_add_u32 s49, s49, 1
    s_cmp_lt_u32 s49, 0x10000
    s_cbranch_scc1 LQ_wf
LQ_wf_ok:
    s_barrier
    s_add_u32 s56, s24, 0x1120000
    s_addc_u32 s57, s25, 0
    s_and_b32 s57, s57, 0xffff
    s_mov_b32 s58, 0x4000
    s_mov_b32 s59, 0x00020000
    s_add_u32 s64, s24, 0x1128000
    s_addc_u32 s65, s25, 0
    s_and_b32 s65, s65, 0xffff
    s_mov_b32 s66, 0x4e00
    s_mov_b32 s67, 0x00020000
    v_and_b32 v210, 15, v207
    v_lshrrev_b32 v213, 0, v208
    v_and_b32 v213, 3, v213
    v_and_b32 v214, 0, v208
    v_mul_u32_u24 v215, 32, v213
    v_add_u32 v215, v215, v210
    s_lshl_b32 s48, s51, 7
    v_add_u32 v215, s48, v215
    v_lshlrev_b32 v215, 3, v215
    buffer_load_dwordx2 v[230:231], v215, s[56:59], 0 offen offset:0 sc1
    buffer_load_dwordx2 v[232:233], v215, s[56:59], 0 offen offset:128 sc1
    s_mul_i32 s48, s52, 80
    v_mul_u32_u24 v216, 80, v214
    v_add3_u32 v216, v216, v210, s48
    v_lshlrev_b32 v216, 2, v216
    buffer_load_dword v238, v216, s[64:67], 0 offen offset:0 sc1
    buffer_load_dword v239, v216, s[64:67], 0 offen offset:64 sc1
    buffer_load_dword v240, v216, s[64:67], 0 offen offset:128 sc1
    buffer_load_dword v241, v216, s[64:67], 0 offen offset:192 sc1
    buffer_load_dword v242, v216, s[64:67], 0 offen offset:256 sc1
    ds_read_b128 v[144:147], v198 offset:0
    ds_read_b64_tr_b16 v[152:153], v200 offset:8192
    ds_read_b64_tr_b16 v[154:155], v200 offset:8704
    ds_read_b128 v[148:151], v198 offset:2048
    ds_read_b64_tr_b16 v[156:157], v202 offset:8192
    ds_read_b64_tr_b16 v[158:159], v202 offset:8704
    ds_read_b64_tr_b16 v[160:161], v204 offset:8192
    ds_read_b64_tr_b16 v[162:163], v204 offset:8704
    ds_read_b64_tr_b16 v[164:165], v206 offset:8192
    ds_read_b64_tr_b16 v[166:167], v206 offset:8704
    ds_read_b64_tr_b16 v[168:169], v200 offset:12288
    ds_read_b64_tr_b16 v[170:171], v200 offset:12800
    s_waitcnt lgkmcnt(15)
    v_mfma_f32_16x16x32_bf16 v[0:3], v[104:107], v[96:99], v[0:3]
    s_waitcnt lgkmcnt(15)
    v_mfma_f32_16x16x32_bf16 v[4:7], v[104:107], v[100:103], v[4:7]
    s_waitcnt lgkmcnt(15)
    v_mfma_f32_16x16x32_bf16 v[8:11], v[108:111], v[96:99], v[8:11]
    v_mfma_f32_16x16x32_bf16 v[12:15], v[108:111], v[100:103], v[12:15]
    s_waitcnt lgkmcnt(15)
    v_mfma_f32_16x16x32_bf16 v[16:19], v[112:115], v[96:99], v[16:19]
    v_mfma_f32_16x16x32_bf16 v[20:23], v[112:115], v[100:103], v[20:23]
    s_waitcnt lgkmcnt(14)
    v_mfma_f32_16x16x32_bf16 v[24:27], v[116:119], v[96:99], v[24:27]
    v_mfma_f32_16x16x32_bf16 v[28:31], v[116:119], v[100:103], v[28:31]
    s_waitcnt lgkmcnt(12)
    v_mfma_f32_16x16x32_bf16 v[32:35], v[120:123], v[96:99], v[32:35]
    v_mfma_f32_16x16x32_bf16 v[36:39], v[120:123], v[100:103], v[36:39]
    s_waitcnt lgkmcnt(9)
    v_mfma_f32_16x16x32_bf16 v[0:3], v[152:155], v[144:147], v[0:3]
    s_waitcnt lgkmcnt(8)
    v_mfma_f32_16x16x32_bf16 v[4:7], v[152:155], v[148:151], v[4:7]
    s_waitcnt lgkmcnt(6)
    v_mfma_f32_16x16x32_bf16 v[8:11], v[156:159], v[144:147], v[8:11]
    v_mfma_f32_16x16x32_bf16 v[12:15], v[156:159], v[148:151], v[12:15]
    s_waitcnt lgkmcnt(4)
    v_mfma_f32_16x16x32_bf16 v[16:19], v[160:163], v[144:147], v[16:19]
    v_mfma_f32_16x16x32_bf16 v[20:23], v[160:163], v[148:151], v[20:23]
    s_waitcnt lgkmcnt(2)
    v_mfma_f32_16x16x32_bf16 v[24:27], v[164:167], v[144:147], v[24:27]
    v_mfma_f32_16x16x32_bf16 v[28:31], v[164:167], v[148:151], v[28:31]
    s_waitcnt lgkmcnt(0)
    v_mfma_f32_16x16x32_bf16 v[32:35], v[168:171], v[144:147], v[32:35]
    v_mfma_f32_16x16x32_bf16 v[36:39], v[168:171], v[148:151], v[36:39]
    s_barrier
    s_waitcnt vmcnt(0)
    s_sub_u32 s48, s47, 4
    s_lshl_b32 s48, s48, 7
    s_sub_u32 s64, s2, 128
    s_add_u32 s64, s64, s48
    s_mov_b32 s69, s64
    s_mov_b32 s65, 0
    s_mov_b32 s66, 0
    s_mov_b32 s68, 0
    s_cmp_ge_u32 s64, 192
    s_cbranch_scc1 Lrj_idone
    s_and_b32 s65, s64, 7
    s_lshr_b32 s64, s64, 3
    s_lshl_b32 s66, s47, 14
    s_mov_b32 s88, s18
    s_and_b32 s89, s19, 0xffff
    s_mov_b32 s90, 0x1e0000
    s_mov_b32 s91, 0x00020000
    s_mul_i32 s67, s64, 122880
    s_mul_i32 s68, s64, 15360
    s_cmp_lt_u32 s64, 16
    s_cbranch_scc1 Lrj_h
    s_mov_b32 s88, s10
    s_and_b32 s89, s11, 0xffff
    s_mov_b32 s90, 0xc8000
    s_mov_b32 s91, 0x00020000
    s_sub_u32 s49, s64, 16
    s_mul_i32 s67, s49, 102400
Lrj_h:
    s_mul_i32 s48, s65, 160
    s_add_u32 s67, s67, s48
    s_mov_b32 s49, 0x1999999a
    v_add_u32 v220, 0, v207
    v_mul_hi_u32 v221, v220, s49
    v_mul_u32_u24 v222, 10, v221
    v_sub_u32 v222, v220, v222
    v_mul_u32_u24 v221, 1280, v221
    v_lshl_add_u32 v221, v222, 4, v221
    s_add_u32 m0, s66, 0
    s_nop 0
    buffer_load_dwordx4 v221, s[88:91], s67 offen lds
    v_add_u32 v220, 64, v207
    v_mul_hi_u32 v221, v220, s49
    v_mul_u32_u24 v222, 10, v221
    v_sub_u32 v222, v220, v222
    v_mul_u32_u24 v221, 1280, v221
    v_lshl_add_u32 v221, v222, 4, v221
    s_add_u32 m0, s66, 1024
    s_nop 0
    buffer_load_dwordx4 v221, s[88:91], s67 offen lds
    v_add_u32 v220, 128, v207
    v_mul_hi_u32 v221, v220, s49
    v_mul_u32_u24 v222, 10, v221
    v_sub_u32 v222, v220, v222
    v_mul_u32_u24 v221, 1280, v221
    v_lshl_add_u32 v221, v222, 4, v221
    s_add_u32 m0, s66, 2048
    s_nop 0
    buffer_load_dwordx4 v221, s[88:91], s67 offen lds
    v_add_u32 v220, 192, v207
    v_mul_hi_u32 v221, v220, s49
    v_mul_u32_u24 v222, 10, v221
    v_sub_u32 v222, v220, v222
    v_mul_u32_u24 v221, 1280, v221
    v_lshl_add_u32 v221, v222, 4, v221
    s_add_u32 m0, s66, 3072
    s_nop 0
    buffer_load_dwordx4 v221, s[88:91], s67 offen lds
    v_add_u32 v220, 256, v207
    v_mul_hi_u32 v221, v220, s49
    v_mul_u32_u24 v222, 10, v221
    v_sub_u32 v222, v220, v222
    v_mul_u32_u24 v221, 1280, v221
    v_lshl_add_u32 v221, v222, 4, v221
    s_add_u32 m0, s66, 4096
    s_nop 0
    buffer_load_dwordx4 v221, s[88:91], s67 offen lds
    v_add_u32 v220, 320, v207
    v_mul_hi_u32 v221, v220, s49
    v_mul_u32_u24 v222, 10, v221
    v_sub_u32 v222, v220, v222
    v_mul_u32_u24 v221, 1280, v221
    v_lshl_add_u32 v221, v222, 4, v221
    s_add_u32 m0, s66, 5120
    s_nop 0
    buffer_load_dwordx4 v221, s[88:91], s67 offen lds
    v_add_u32 v220, 384, v207
    v_mul_hi_u32 v221, v220, s49
    v_mul_u32_u24 v222, 10, v221
    v_sub_u32 v222, v220, v222
    v_mul_u32_u24 v221, 1280, v221
    v_lshl_add_u32 v221, v222, 4, v221
    s_add_u32 m0, s66, 6144
    s_nop 0
    buffer_load_dwordx4 v221, s[88:91], s67 offen lds
    v_add_u32 v220, 448, v207
    v_mul_hi_u32 v221, v220, s49
    v_mul_u32_u24 v222, 10, v221
    v_sub_u32 v222, v220, v222
    v_mul_u32_u24 v221, 1280, v221
    v_lshl_add_u32 v221, v222, 4, v221
    s_add_u32 m0, s66, 7168
    s_nop 0
    buffer_load_dwordx4 v221, s[88:91], s67 offen lds
    v_add_u32 v220, 512, v207
    v_mul_hi_u32 v221, v220, s49
    v_mul_u32_u24 v222, 10, v221
    v_sub_u32 v222, v220, v222
    v_mul_u32_u24 v221, 1280, v221
    v_lshl_add_u32 v221, v222, 4, v221
    s_add_u32 m0, s66, 8192
    s_nop 0
    buffer_load_dwordx4 v221, s[88:91], s67 offen lds
    v_add_u32 v220, 576, v207
    v_mul_hi_u32 v221, v220, s49
    v_mul_u32_u24 v222, 10, v221
    v_sub_u32 v222, v220, v222
    v_mul_u32_u24 v221, 1280, v221
    v_lshl_add_u32 v221, v222, 4, v221
    s_add_u32 m0, s66, 9216
    s_nop 0
    buffer_load_dwordx4 v221, s[88:91], s67 offen lds
    v_add_u32 v220, 640, v207
    v_mul_hi_u32 v221, v220, s49
    v_mul_u32_u24 v222, 10, v221
    v_sub_u32 v222, v220, v222
    v_mul_u32_u24 v221, 1280, v221
    v_lshl_add_u32 v221, v222, 4, v221
    s_add_u32 m0, s66, 10240
    s_nop 0
    buffer_load_dwordx4 v221, s[88:91], s67 offen lds
    v_add_u32 v220, 704, v207
    v_mul_hi_u32 v221, v220, s49
    v_mul_u32_u24 v222, 10, v221
    v_sub_u32 v222, v220, v222
    v_mul_u32_u24 v221, 1280, v221
    v_lshl_add_u32 v221, v222, 4, v221
    s_add_u32 m0, s66, 11264
    s_nop 0
    buffer_load_dwordx4 v221, s[88:91], s67 offen lds
    v_add_u32 v220, 768, v207
    v_mul_hi_u32 v221, v220, s49
    v_mul_u32_u24 v222, 10, v221
    v_sub_u32 v222, v220, v222
    v_mul_u32_u24 v221, 1280, v221
    v_lshl_add_u32 v221, v222, 4, v221
    s_add_u32 m0, s66, 12288
    s_nop 0
    buffer_load_dwordx4 v221, s[88:91], s67 offen lds
    v_add_u32 v220, 832, v207
    v_mul_hi_u32 v221, v220, s49
    v_mul_u32_u24 v222, 10, v221
    v_sub_u32 v222, v220, v222
    v_mul_u32_u24 v221, 1280, v221
    v_lshl_add_u32 v221, v222, 4, v221
    s_add_u32 m0, s66, 13312
    s_nop 0
    buffer_load_dwordx4 v221, s[88:91], s67 offen lds
    v_add_u32 v220, 896, v207
    v_mul_hi_u32 v221, v220, s49
    v_mul_u32_u24 v222, 10, v221
    v_sub_u32 v222, v220, v222
    v_mul_u32_u24 v221, 1280, v221
    v_lshl_add_u32 v221, v222, 4, v221
    s_add_u32 m0, s66, 14336
    s_nop 0
    buffer_load_dwordx4 v221, s[88:91], s67 offen lds
Lrj_idone:
    v_cmp_gt_u32 vcc, 16, v207
    v_lshrrev_b32 v212, 16, v231
    v_xor_b32 v212, 0x8000, v212
    v_lshl_or_b32 v213, v212, 16, v212
    v_cndmask_b32 v136, 0, v213, vcc
    v_cndmask_b32 v137, 0, v212, vcc
    v_mov_b32 v138, 0
    v_mov_b32 v139, 0
    v_lshrrev_b32 v212, 16, v233
    v_xor_b32 v212, 0x8000, v212
    v_lshl_or_b32 v213, v212, 16, v212
    v_cndmask_b32 v140, 0, v213, vcc
    v_cndmask_b32 v141, 0, v212, vcc
    v_mov_b32 v142, 0
    v_mov_b32 v143, 0
    v_cvt_pk_bf16_f32 v210, v238, v238
    v_lshlrev_b32 v212, 16, v210
    v_sub_f32 v238, v238, v212
    v_cvt_pk_bf16_f32 v211, v238, v238
    v_lshlrev_b32 v212, 16, v211
    v_sub_f32 v238, v238, v212
    v_cvt_pk_bf16_f32 v212, v238, v238
    v_and_b32 v210, 0xffff, v210
    v_lshl_or_b32 v210, v211, 16, v210
    v_and_b32 v212, 0xffff, v212
    v_cndmask_b32 v96, 0, v210, vcc
    v_cndmask_b32 v97, 0, v212, vcc
    v_mov_b32 v98, 0
    v_mov_b32 v99, 0
    v_cvt_pk_bf16_f32 v213, v239, v239
    v_lshlrev_b32 v215, 16, v213
    v_sub_f32 v239, v239, v215
    v_cvt_pk_bf16_f32 v214, v239, v239
    v_lshlrev_b32 v215, 16, v214
    v_sub_f32 v239, v239, v215
    v_cvt_pk_bf16_f32 v215, v239, v239
    v_and_b32 v213, 0xffff, v213
    v_lshl_or_b32 v213, v214, 16, v213
    v_and_b32 v215, 0xffff, v215
    v_cndmask_b32 v100, 0, v213, vcc
    v_cndmask_b32 v101, 0, v215, vcc
    v_mov_b32 v102, 0
    v_mov_b32 v103, 0
    v_cvt_pk_bf16_f32 v216, v240, v240
    v_lshlrev_b32 v218, 16, v216
    v_sub_f32 v240, v240, v218
    v_cvt_pk_bf16_f32 v217, v240, v240
    v_lshlrev_b32 v218, 16, v217
    v_sub_f32 v240, v240, v218
    v_cvt_pk_bf16_f32 v218, v240, v240
    v_and_b32 v216, 0xffff, v216
    v_lshl_or_b32 v216, v217, 16, v216
    v_and_b32 v218, 0xffff, v218
    v_cndmask_b32 v104, 0, v216, vcc
    v_cndmask_b32 v105, 0, v218, vcc
    v_mov_b32 v106, 0
    v_mov_b32 v107, 0
    v_cvt_pk_bf16_f32 v210, v241, v241
    v_lshlrev_b32 v212, 16, v210
    v_sub_f32 v241, v241, v212
    v_cvt_pk_bf16_f32 v211, v241, v241
    v_lshlrev_b32 v212, 16, v211
    v_sub_f32 v241, v241, v212
    v_cvt_pk_bf16_f32 v212, v241, v241
    v_and_b32 v210, 0xffff, v210
    v_lshl_or_b32 v210, v211, 16, v210
    v_and_b32 v212, 0xffff, v212
    v_cndmask_b32 v108, 0, v210, vcc
    v_cndmask_b32 v109, 0, v212, vcc
    v_mov_b32 v110, 0
    v_mov_b32 v111, 0
    v_cvt_pk_bf16_f32 v213, v242, v242
    v_lshlrev_b32 v215, 16, v213
    v_sub_f32 v242, v242, v215
    v_cvt_pk_bf16_f32 v214, v242, v242
    v_lshlrev_b32 v215, 16, v214
    v_sub_f32 v242, v242, v215
    v_cvt_pk_bf16_f32 v215, v242, v242
    v_and_b32 v213, 0xffff, v213
    v_lshl_or_b32 v213, v214, 16, v213
    v_and_b32 v215, 0xffff, v215
    v_cndmask_b32 v112, 0, v213, vcc
    v_cndmask_b32 v113, 0, v215, vcc
    v_mov_b32 v114, 0
    v_mov_b32 v115, 0
    v_mfma_f32_16x16x32_bf16 v[0:3], v[96:99], v[136:139], v[0:3]
    v_mfma_f32_16x16x32_bf16 v[4:7], v[96:99], v[140:143], v[4:7]
    v_mfma_f32_16x16x32_bf16 v[8:11], v[100:103], v[136:139], v[8:11]
    v_mfma_f32_16x16x32_bf16 v[12:15], v[100:103], v[140:143], v[12:15]
    v_mfma_f32_16x16x32_bf16 v[16:19], v[104:107], v[136:139], v[16:19]
    v_mfma_f32_16x16x32_bf16 v[20:23], v[104:107], v[140:143], v[20:23]
    v_mfma_f32_16x16x32_bf16 v[24:27], v[108:111], v[136:139], v[24:27]
    v_mfma_f32_16x16x32_bf16 v[28:31], v[108:111], v[140:143], v[28:31]
    v_mfma_f32_16x16x32_bf16 v[32:35], v[112:115], v[136:139], v[32:35]
    v_mfma_f32_16x16x32_bf16 v[36:39], v[112:115], v[140:143], v[36:39]
    s_add_u32 s40, s24, 0x600000
    s_addc_u32 s41, s25, 0
    s_and_b32 s41, s41, 0xffff
    s_mov_b32 s42, 0x500000
    s_mov_b32 s43, 0x00020000
    v_and_b32 v210, 3, v207
    v_bfe_u32 v211, v207, 2, 2
    v_lshrrev_b32 v212, 4, v207
    v_and_b32 v213, 0, v208
    v_lshl_add_u32 v213, v213, 2, v210
    v_mul_u32_u24 v213, 800, v213
    v_add_u32 v213, 147456, v213
    v_mul_u32_u24 v214, 20, v210
    v_lshlrev_b32 v215, 2, v212
    v_sub_u32 v215, v215, v214
    v_mov_b32 v218, 160256
    v_add_u32 v216, 0, v215
    v_cmp_gt_u32 vcc, 20, v216
    v_add_u32 v216, v216, v211
    v_mul_u32_u24 v216, 40, v216
    v_add_u32 v216, v216, v213
    v_cndmask_b32 v156, v218, v216, vcc
    v_add_u32 v216, 16, v215
    v_cmp_gt_u32 vcc, 20, v216
    v_add_u32 v216, v216, v211
    v_mul_u32_u24 v216, 40, v216
    v_add_u32 v216, v216, v213
    v_cndmask_b32 v157, v218, v216, vcc
    v_add_u32 v216, 32, v215
    v_cmp_gt_u32 vcc, 20, v216
    v_add_u32 v216, v216, v211
    v_mul_u32_u24 v216, 40, v216
    v_add_u32 v216, v216, v213
    v_cndmask_b32 v158, v218, v216, vcc
    v_add_u32 v216, 48, v215
    v_cmp_gt_u32 vcc, 20, v216
    v_add_u32 v216, v216, v211
    v_mul_u32_u24 v216, 40, v216
    v_add_u32 v216, v216, v213
    v_cndmask_b32 v159, v218, v216, vcc
    v_add_u32 v216, 64, v215
    v_cmp_gt_u32 vcc, 20, v216
    v_add_u32 v216, v216, v211
    v_mul_u32_u24 v216, 40, v216
    v_add_u32 v216, v216, v213
    v_cndmask_b32 v160, v218, v216, vcc
    ds_read_b64_tr_b16 v[96:97], v156 offset:0
    ds_read_b64_tr_b16 v[98:99], v157 offset:0
    ds_read_b64_tr_b16 v[100:101], v158 offset:0
    ds_read_b64_tr_b16 v[102:103], v159 offset:0
    ds_read_b64_tr_b16 v[104:105], v160 offset:0
    v_mov_b32 v106, 0
    v_mov_b32 v107, 0
    ds_read_b64_tr_b16 v[108:109], v156 offset:8
    ds_read_b64_tr_b16 v[110:111], v157 offset:8
    ds_read_b64_tr_b16 v[112:113], v158 offset:8
    ds_read_b64_tr_b16 v[114:115], v159 offset:8
    ds_read_b64_tr_b16 v[116:117], v160 offset:8
    v_mov_b32 v118, 0
    v_mov_b32 v119, 0
    ds_read_b64_tr_b16 v[120:121], v156 offset:16
    ds_read_b64_tr_b16 v[122:123], v157 offset:16
    ds_read_b64_tr_b16 v[124:125], v158 offset:16
    ds_read_b64_tr_b16 v[126:127], v159 offset:16
    ds_read_b64_tr_b16 v[128:129], v160 offset:16
    v_mov_b32 v130, 0
    v_mov_b32 v131, 0
    ds_read_b64_tr_b16 v[132:133], v156 offset:24
    ds_read_b64_tr_b16 v[134:135], v157 offset:24
    ds_read_b64_tr_b16 v[136:137], v158 offset:24
    ds_read_b64_tr_b16 v[138:139], v159 offset:24
    ds_read_b64_tr_b16 v[140:141], v160 offset:24
    v_mov_b32 v142, 0
    v_mov_b32 v143, 0
    ds_read_b64_tr_b16 v[144:145], v156 offset:32
    ds_read_b64_tr_b16 v[146:147], v157 offset:32
    ds_read_b64_tr_b16 v[148:149], v158 offset:32
    ds_read_b64_tr_b16 v[150:151], v159 offset:32
    ds_read_b64_tr_b16 v[152:153], v160 offset:32
    v_mov_b32 v154, 0
    v_mov_b32 v155, 0
    v_and_b32 v210, 3, v208
    v_lshlrev_b32 v210, 4, v210
    s_lshl_b32 s48, s51, 6
    s_add_u32 s48, s48, s52
    v_add_u32 v210, s48, v210
    v_mul_u32_u24 v210, 3072, v210
    v_lshl_add_u32 v161, v207, 4, v210
    s_mov_b32 s49, 24576
    s_movk_i32 s50, 4096
    v_pk_mul_f32 v[0:1], v[0:1], v[230:231] op_sel_hi:[1,0]
    v_pk_mul_f32 v[4:5], v[4:5], v[232:233] op_sel_hi:[1,0]
    v_pk_mul_f32 v[2:3], v[2:3], v[230:231] op_sel_hi:[1,0]
    v_pk_mul_f32 v[6:7], v[6:7], v[232:233] op_sel_hi:[1,0]
    v_cvt_pk_bf16_f32 v80, v0, v1
    v_cvt_pk_bf16_f32 v92, v4, v5
    v_cvt_pk_bf16_f32 v81, v2, v3
    v_cvt_pk_bf16_f32 v93, v6, v7
    v_pk_mul_f32 v[8:9], v[8:9], v[230:231] op_sel_hi:[1,0]
    v_pk_mul_f32 v[12:13], v[12:13], v[232:233] op_sel_hi:[1,0]
    v_pk_mul_f32 v[10:11], v[10:11], v[230:231] op_sel_hi:[1,0]
    v_pk_mul_f32 v[14:15], v[14:15], v[232:233] op_sel_hi:[1,0]
    v_cvt_pk_bf16_f32 v82, v8, v9
    v_cvt_pk_bf16_f32 v94, v12, v13
    v_cvt_pk_bf16_f32 v83, v10, v11
    v_cvt_pk_bf16_f32 v95, v14, v15
    v_pk_mul_f32 v[16:17], v[16:17], v[230:231] op_sel_hi:[1,0]
    v_pk_mul_f32 v[20:21], v[20:21], v[232:233] op_sel_hi:[1,0]
    v_pk_mul_f32 v[18:19], v[18:19], v[230:231] op_sel_hi:[1,0]
    v_pk_mul_f32 v[22:23], v[22:23], v[232:233] op_sel_hi:[1,0]
    v_cvt_pk_bf16_f32 v84, v16, v17
    v_cvt_pk_bf16_f32 v156, v20, v21
    v_cvt_pk_bf16_f32 v85, v18, v19
    v_cvt_pk_bf16_f32 v157, v22, v23
    v_pk_mul_f32 v[24:25], v[24:25], v[230:231] op_sel_hi:[1,0]
    v_pk_mul_f32 v[28:29], v[28:29], v[232:233] op_sel_hi:[1,0]
    v_pk_mul_f32 v[26:27], v[26:27], v[230:231] op_sel_hi:[1,0]
    v_pk_mul_f32 v[30:31], v[30:31], v[232:233] op_sel_hi:[1,0]
    v_cvt_pk_bf16_f32 v86, v24, v25
    v_cvt_pk_bf16_f32 v158, v28, v29
    v_cvt_pk_bf16_f32 v87, v26, v27
    v_cvt_pk_bf16_f32 v159, v30, v31
    v_pk_mul_f32 v[32:33], v[32:33], v[230:231] op_sel_hi:[1,0]
    v_pk_mul_f32 v[36:37], v[36:37], v[232:233] op_sel_hi:[1,0]
    v_pk_mul_f32 v[34:35], v[34:35], v[230:231] op_sel_hi:[1,0]
    v_pk_mul_f32 v[38:39], v[38:39], v[232:233] op_sel_hi:[1,0]
    v_cvt_pk_bf16_f32 v88, v32, v33
    v_cvt_pk_bf16_f32 v238, v36, v37
    v_cvt_pk_bf16_f32 v89, v34, v35
    v_cvt_pk_bf16_f32 v239, v38, v39
    v_mov_b32 v90, 0
    v_mov_b32 v240, 0
    v_mov_b32 v91, 0
    v_mov_b32 v241, 0
    s_waitcnt lgkmcnt(15)
    v_mfma_f32_16x16x32_bf16 v[164:167], v[96:99], v[80:83], 0
    v_mfma_f32_16x16x32_bf16 v[0:3], v[96:99], v[92:95], 0
    s_waitcnt lgkmcnt(15)
    v_mfma_f32_16x16x32_bf16 v[168:171], v[108:111], v[80:83], 0
    v_mfma_f32_16x16x32_bf16 v[8:11], v[108:111], v[92:95], 0
    s_waitcnt lgkmcnt(13)
    v_mfma_f32_16x16x32_bf16 v[172:175], v[120:123], v[80:83], 0
    v_mfma_f32_16x16x32_bf16 v[16:19], v[120:123], v[92:95], 0
    s_waitcnt lgkmcnt(8)
    v_mfma_f32_16x16x32_bf16 v[176:179], v[132:135], v[80:83], 0
    v_mfma_f32_16x16x32_bf16 v[24:27], v[132:135], v[92:95], 0
    s_waitcnt lgkmcnt(3)
    v_mfma_f32_16x16x32_bf16 v[180:183], v[144:147], v[80:83], 0
    v_mfma_f32_16x16x32_bf16 v[32:35], v[144:147], v[92:95], 0
    v_mfma_f32_16x16x32_bf16 v[164:167], v[100:103], v[84:87], v[164:167]
    v_mfma_f32_16x16x32_bf16 v[0:3], v[100:103], v[156:159], v[0:3]
    v_mfma_f32_16x16x32_bf16 v[168:171], v[112:115], v[84:87], v[168:171]
    v_mfma_f32_16x16x32_bf16 v[8:11], v[112:115], v[156:159], v[8:11]
    v_mfma_f32_16x16x32_bf16 v[172:175], v[124:127], v[84:87], v[172:175]
    v_mfma_f32_16x16x32_bf16 v[16:19], v[124:127], v[156:159], v[16:19]
    v_mfma_f32_16x16x32_bf16 v[176:179], v[136:139], v[84:87], v[176:179]
    v_mfma_f32_16x16x32_bf16 v[24:27], v[136:139], v[156:159], v[24:27]
    s_waitcnt lgkmcnt(1)
    v_mfma_f32_16x16x32_bf16 v[180:183], v[148:151], v[84:87], v[180:183]
    v_mfma_f32_16x16x32_bf16 v[32:35], v[148:151], v[156:159], v[32:35]
    v_mfma_f32_16x16x32_bf16 v[164:167], v[104:107], v[88:91], v[164:167]
    v_mfma_f32_16x16x32_bf16 v[0:3], v[104:107], v[238:241], v[0:3]
    v_mfma_f32_16x16x32_bf16 v[168:171], v[116:119], v[88:91], v[168:171]
    v_mfma_f32_16x16x32_bf16 v[8:11], v[116:119], v[238:241], v[8:11]
    v_mfma_f32_16x16x32_bf16 v[172:175], v[128:131], v[88:91], v[172:175]
    v_mfma_f32_16x16x32_bf16 v[16:19], v[128:131], v[238:241], v[16:19]
    v_mfma_f32_16x16x32_bf16 v[176:179], v[140:143], v[88:91], v[176:179]
    v_mfma_f32_16x16x32_bf16 v[24:27], v[140:143], v[238:241], v[24:27]
    s_waitcnt lgkmcnt(0)
    v_mfma_f32_16x16x32_bf16 v[180:183], v[152:155], v[88:91], v[180:183]
    v_mfma_f32_16x16x32_bf16 v[32:35], v[152:155], v[238:241], v[32:35]
    v_cvt_pk_bf16_f32 v184, v164, v165
    v_cvt_pk_bf16_f32 v4, v0, v1
    v_cvt_pk_bf16_f32 v185, v166, v167
    v_cvt_pk_bf16_f32 v5, v2, v3
    v_cvt_pk_bf16_f32 v186, v168, v169
    v_cvt_pk_bf16_f32 v6, v8, v9
    v_cvt_pk_bf16_f32 v187, v170, v171
    v_cvt_pk_bf16_f32 v7, v10, v11
    v_cvt_pk_bf16_f32 v188, v172, v173
    v_cvt_pk_bf16_f32 v12, v16, v17
    v_cvt_pk_bf16_f32 v189, v174, v175
    v_cvt_pk_bf16_f32 v13, v18, v19
    v_cvt_pk_bf16_f32 v190, v176, v177
    v_cvt_pk_bf16_f32 v14, v24, v25
    v_cvt_pk_bf16_f32 v191, v178, v179
    v_cvt_pk_bf16_f32 v15, v26, v27
    v_cvt_pk_bf16_f32 v192, v180, v181
    v_cvt_pk_bf16_f32 v20, v32, v33
    v_cvt_pk_bf16_f32 v193, v182, v183
    v_cvt_pk_bf16_f32 v21, v34, v35
    v_mov_b32 v194, 0
    v_mov_b32 v22, 0
    v_mov_b32 v195, 0
    v_mov_b32 v23, 0
    buffer_store_dwordx4 v[184:187], v161, s[40:43], 0 offen offset:0
    buffer_store_dwordx4 v[188:191], v161, s[40:43], 0 offen offset:1024
    buffer_store_dwordx4 v[192:195], v161, s[40:43], 0 offen offset:2048
    s_nop 1
    v_add_u32 v161, s49, v161
    buffer_store_dwordx4 v[4:7], v161, s[40:43], 0 offen offset:0
    buffer_store_dwordx4 v[12:15], v161, s[40:43], 0 offen offset:1024
    buffer_store_dwordx4 v[20:23], v161, s[40:43], 0 offen offset:2048
    s_nop 1
    v_add_u32 v161, s49, v161
    s_cmp_ge_u32 s69, 192
    s_cbranch_scc1 Lrj_done
    s_add_u32 s84, s24, 0xe00000
    s_addc_u32 s85, s25, 0
    s_and_b32 s85, s85, 0xffff
    s_mov_b32 s86, 0x2d0000
    s_mov_b32 s87, 0x00020000
    v_and_b32 v3, 15, v207
    v_lshrrev_b32 v4, 4, v207
    v_and_b32 v6, 3, v3
    v_lshlrev_b32 v6, 3, v6
    v_add_u32 v6, s66, v6
    v_lshrrev_b32 v7, 2, v3
    s_mul_i32 s48, s65, 368640
    s_add_u32 s48, s48, s68
    v_lshlrev_b32 v8, 4, v207
    s_cmp_lt_u32 s64, 16
    s_cbranch_scc0 Lrj_o
    v_lshl_add_u32 v9, v4, 2, v7
    v_mul_u32_u24 v9, 160, v9
    v_add_u32 v9, v9, v6
    s_waitcnt vmcnt(0)
    ds_read_b64_tr_b16 v[16:17], v9 offset:0
    ds_read_b64_tr_b16 v[18:19], v9 offset:2560
    ds_read_b64_tr_b16 v[20:21], v9 offset:32
    ds_read_b64_tr_b16 v[22:23], v9 offset:2592
    ds_read_b64_tr_b16 v[24:25], v9 offset:64
    ds_read_b64_tr_b16 v[26:27], v9 offset:2624
    ds_read_b64_tr_b16 v[28:29], v9 offset:96
    ds_read_b64_tr_b16 v[30:31], v9 offset:2656
    ds_read_b64_tr_b16 v[32:33], v9 offset:128
    ds_read_b64_tr_b16 v[34:35], v9 offset:2688
    ds_read_b64_tr_b16 v[36:37], v9 offset:7680
    ds_read_b64_tr_b16 v[38:39], v9 offset:10240
    ds_read_b64_tr_b16 v[40:41], v9 offset:7712
    ds_read_b64_tr_b16 v[42:43], v9 offset:10272
    ds_read_b64_tr_b16 v[44:45], v9 offset:7744
    ds_read_b64_tr_b16 v[46:47], v9 offset:10304
    ds_read_b64_tr_b16 v[48:49], v9 offset:7776
    ds_read_b64_tr_b16 v[50:51], v9 offset:10336
    ds_read_b64_tr_b16 v[52:53], v9 offset:7808
    ds_read_b64_tr_b16 v[54:55], v9 offset:10368
    ds_read_b64_tr_b16 v[56:57], v9 offset:5120
    ds_read_b64_tr_b16 v[58:59], v9 offset:12800
    ds_read_b64_tr_b16 v[60:61], v9 offset:5152
    ds_read_b64_tr_b16 v[62:63], v9 offset:12832
    ds_read_b64_tr_b16 v[64:65], v9 offset:5184
    ds_read_b64_tr_b16 v[66:67], v9 offset:12864
    ds_read_b64_tr_b16 v[68:69], v9 offset:5216
    ds_read_b64_tr_b16 v[70:71], v9 offset:12896
    ds_read_b64_tr_b16 v[72:73], v9 offset:5248
    ds_read_b64_tr_b16 v[74:75], v9 offset:12928
    s_branch Lrj_st
Lrj_o:
    v_mul_u32_u24 v9, 20, v4
    v_add_u32 v9, v9, v7
    v_mul_u32_u24 v9, 160, v9
    v_add_u32 v9, v9, v6
    s_waitcnt vmcnt(0)
    ds_read_b64_tr_b16 v[16:17], v9 offset:0
    ds_read_b64_tr_b16 v[18:19], v9 offset:640
    ds_read_b64_tr_b16 v[20:21], v9 offset:32
    ds_read_b64_tr_b16 v[22:23], v9 offset:672
    ds_read_b64_tr_b16 v[24:25], v9 offset:64
    ds_read_b64_tr_b16 v[26:27], v9 offset:704
    ds_read_b64_tr_b16 v[28:29], v9 offset:96
    ds_read_b64_tr_b16 v[30:31], v9 offset:736
    ds_read_b64_tr_b16 v[32:33], v9 offset:128
    ds_read_b64_tr_b16 v[34:35], v9 offset:768
    ds_read_b64_tr_b16 v[36:37], v9 offset:1280
    ds_read_b64_tr_b16 v[38:39], v9 offset:1920
    ds_read_b64_tr_b16 v[40:41], v9 offset:1312
    ds_read_b64_tr_b16 v[42:43], v9 offset:1952
    ds_read_b64_tr_b16 v[44:45], v9 offset:1344
    ds_read_b64_tr_b16 v[46:47], v9 offset:1984
    ds_read_b64_tr_b16 v[48:49], v9 offset:1376
    ds_read_b64_tr_b16 v[50:51], v9 offset:2016
    ds_read_b64_tr_b16 v[52:53], v9 offset:1408
    ds_read_b64_tr_b16 v[54:55], v9 offset:2048
    ds_read_b64_tr_b16 v[56:57], v9 offset:2560
    v_mov_b32 v58, 0
    v_mov_b32 v59, 0
    ds_read_b64_tr_b16 v[60:61], v9 offset:2592
    v_mov_b32 v62, 0
    v_mov_b32 v63, 0
    ds_read_b64_tr_b16 v[64:65], v9 offset:2624
    v_mov_b32 v66, 0
    v_mov_b32 v67, 0
    ds_read_b64_tr_b16 v[68:69], v9 offset:2656
    v_mov_b32 v70, 0
    v_mov_b32 v71, 0
    ds_read_b64_tr_b16 v[72:73], v9 offset:2688
    v_mov_b32 v74, 0
    v_mov_b32 v75, 0
Lrj_st:
    s_waitcnt lgkmcnt(0)
    buffer_store_dwordx4 v[16:19], v8, s[84:87], s48 offen offset:0
    buffer_store_dwordx4 v[20:23], v8, s[84:87], s48 offen offset:1024
    buffer_store_dwordx4 v[24:27], v8, s[84:87], s48 offen offset:2048
    buffer_store_dwordx4 v[28:31], v8, s[84:87], s48 offen offset:3072
    s_add_u32 s48, s48, 4096
    buffer_store_dwordx4 v[32:35], v8, s[84:87], s48 offen offset:0
    buffer_store_dwordx4 v[36:39], v8, s[84:87], s48 offen offset:1024
    buffer_store_dwordx4 v[40:43], v8, s[84:87], s48 offen offset:2048
    buffer_store_dwordx4 v[44:47], v8, s[84:87], s48 offen offset:3072
    s_add_u32 s48, s48, 4096
    buffer_store_dwordx4 v[48:51], v8, s[84:87], s48 offen offset:0
    buffer_store_dwordx4 v[52:55], v8, s[84:87], s48 offen offset:1024
    buffer_store_dwordx4 v[56:59], v8, s[84:87], s48 offen offset:2048
    buffer_store_dwordx4 v[60:63], v8, s[84:87], s48 offen offset:3072
    s_add_u32 s48, s48, 4096
    buffer_store_dwordx4 v[64:67], v8, s[84:87], s48 offen offset:0
    buffer_store_dwordx4 v[68:71], v8, s[84:87], s48 offen offset:1024
    buffer_store_dwordx4 v[72:75], v8, s[84:87], s48 offen offset:2048
Lrj_done:
    s_waitcnt vmcnt(0)
    s_endpgm
Lk1_exit:
    s_endpgm

.globl k2_kernel
.p2align 8
.type k2_kernel,@function
k2_kernel:
    s_load_dwordx16 s[4:19], s[0:1], 0
    s_load_dwordx4 s[20:23], s[0:1], 64
    s_load_dwordx2 s[24:25], s[0:1], 80
    s_cmp_ge_u32 s2, 256
    s_cbranch_scc1 Lk2_exit
    s_waitcnt lgkmcnt(0)
    s_and_b32 s51, s2, 31
    s_lshr_b32 s52, s2, 5
    s_mov_b32 s28, s24
    s_and_b32 s29, s25, 0xffff
    s_mov_b32 s30, 0x600000
    s_mov_b32 s31, 0x00020000
    s_add_u32 s32, s24, 0xb00000
    s_addc_u32 s33, s25, 0
    s_and_b32 s33, s33, 0xffff
    s_mov_b32 s34, 0x300000
    s_mov_b32 s35, 0x00020000
    s_add_u32 s36, s24, 0xe00000
    s_addc_u32 s37, s25, 0
    s_and_b32 s37, s37, 0xffff
    s_mov_b32 s38, 0x2d0000
    s_mov_b32 s39, 0x00020000
    s_add_u32 s40, s24, 0x600000
    s_addc_u32 s41, s25, 0
    s_and_b32 s41, s41, 0xffff
    s_mov_b32 s42, 0x500000
    s_mov_b32 s43, 0x00020000
    s_add_u32 s56, s24, 0x1100000
    s_addc_u32 s57, s25, 0
    s_and_b32 s57, s57, 0xffff
    s_mov_b32 s58, 0x1a400
    s_mov_b32 s59, 0x00020000
    s_add_u32 s60, s24, 0x1130000
    s_addc_u32 s61, s25, 0
    s_and_b32 s61, s61, 0xffff
    s_mov_b32 s62, 0x1000
    s_mov_b32 s63, 0x00020000
    v_mov_b32 v229, v0
    v_and_b32 v227, 63, v0
    v_lshrrev_b32 v228, 6, v0
    s_nop 0
    v_readfirstlane_b32 s47, v228
    s_mul_i32 s48, s51, 196608
    v_lshlrev_b32 v230, 4, v227
    v_lshl_add_u32 v231, v228, 10, v230
    v_add_u32 v224, s48, v231
    s_mul_i32 s48, s51, 98304
    v_add_u32 v225, s48, v231
    s_mul_i32 s48, s52, 368640
    v_mul_u32_u24 v232, 5120, v228
    v_add3_u32 v226, v232, v230, s48
    s_mul_i32 s53, s51, 0x5556
    s_lshr_b32 s53, s53, 18
    s_mul_i32 s53, s53, 12
    s_sub_u32 s53, s51, s53
    s_mul_i32 s48, s52, 13440
    v_lshlrev_b32 v233, 4, v229
    v_add_u32 v234, s48, v233
    v_mov_b32 v235, 0x7fffff00
    v_cmp_gt_u32 vcc, 72, v229
    s_nop 1
    v_cndmask_b32 v235, v235, v234, vcc
    buffer_load_dwordx4 v[0:3], v234, s[56:59], 0 offen offset:0
    s_mov_b32 s49, 4096
    buffer_load_dwordx4 v[4:7], v234, s[56:59], s49 offen
    s_mov_b32 s49, 8192
    buffer_load_dwordx4 v[8:11], v234, s[56:59], s49 offen
    s_mov_b32 s49, 12288
    buffer_load_dwordx4 v[12:15], v235, s[56:59], s49 offen
    s_lshl_b32 s48, s51, 5
    s_add_u32 s48, s48, s52
    s_mul_i32 s48, s48, 3072
    v_mul_u32_u24 v236, 24576, v228
    v_add3_u32 v236, v236, v230, s48
    buffer_load_dwordx4 v[60:63], v236, s[40:43], 0 offen offset:0
    buffer_load_dwordx4 v[64:67], v236, s[40:43], 0 offen offset:1024
    buffer_load_dwordx4 v[68:71], v236, s[40:43], 0 offen offset:2048
    s_mul_i32 s48, s53, 20480
    s_add_u32 s49, s48, 4096
    buffer_load_dwordx4 v[80:83], v226, s[36:39], s48 offen offset:0
    buffer_load_dwordx4 v[84:87], v226, s[36:39], s48 offen offset:1024
    buffer_load_dwordx4 v[88:91], v226, s[36:39], s48 offen offset:2048
    buffer_load_dwordx4 v[92:95], v226, s[36:39], s48 offen offset:3072
    buffer_load_dwordx4 v[96:99], v226, s[36:39], s49 offen
    s_lshl_b32 s48, s53, 12
    buffer_load_dwordx4 v[100:103], v224, s[28:31], s48 offen
    s_add_u32 s48, s48, 49152
    buffer_load_dwordx4 v[104:107], v224, s[28:31], s48 offen
    s_add_u32 s48, s48, 49152
    buffer_load_dwordx4 v[108:111], v224, s[28:31], s48 offen
    s_add_u32 s48, s48, 49152
    buffer_load_dwordx4 v[112:115], v224, s[28:31], s48 offen
    s_add_u32 s48, s48, 49152
    s_add_u32 s53, s53, 1
    s_cmp_ge_u32 s53, 12
    s_cselect_b32 s53, 0, s53
    s_mul_i32 s48, s53, 20480
    s_add_u32 s49, s48, 4096
    buffer_load_dwordx4 v[116:119], v226, s[36:39], s48 offen offset:0
    buffer_load_dwordx4 v[120:123], v226, s[36:39], s48 offen offset:1024
    buffer_load_dwordx4 v[124:127], v226, s[36:39], s48 offen offset:2048
    buffer_load_dwordx4 v[128:131], v226, s[36:39], s48 offen offset:3072
    buffer_load_dwordx4 v[132:135], v226, s[36:39], s49 offen
    s_lshl_b32 s48, s53, 12
    buffer_load_dwordx4 v[136:139], v224, s[28:31], s48 offen
    s_add_u32 s48, s48, 49152
    buffer_load_dwordx4 v[140:143], v224, s[28:31], s48 offen
    s_add_u32 s48, s48, 49152
    buffer_load_dwordx4 v[144:147], v224, s[28:31], s48 offen
    s_add_u32 s48, s48, 49152
    buffer_load_dwordx4 v[148:151], v224, s[28:31], s48 offen
    s_add_u32 s48, s48, 49152
    s_add_u32 s53, s53, 1
    s_cmp_ge_u32 s53, 12
    s_cselect_b32 s53, 0, s53
    s_mul_i32 s48, s53, 20480
    s_add_u32 s49, s48, 4096
    buffer_load_dwordx4 v[152:155], v226, s[36:39], s48 offen offset:0
    buffer_load_dwordx4 v[156:159], v226, s[36:39], s48 offen offset:1024
    buffer_load_dwordx4 v[160:163], v226, s[36:39], s48 offen offset:2048
    buffer_load_dwordx4 v[164:167], v226, s[36:39], s48 offen offset:3072
    buffer_load_dwordx4 v[168:171], v226, s[36:39], s49 offen
    s_lshl_b32 s48, s53, 12
    buffer_load_dwordx4 v[172:175], v224, s[28:31], s48 offen
    s_add_u32 s48, s48, 49152
    buffer_load_dwordx4 v[176:179], v224, s[28:31], s48 offen
    s_add_u32 s48, s48, 49152
    buffer_load_dwordx4 v[180:183], v224, s[28:31], s48 offen
    s_add_u32 s48, s48, 49152
    buffer_load_dwordx4 v[184:187], v224, s[28:31], s48 offen
    s_add_u32 s48, s48, 49152
    s_add_u32 s53, s53, 1
    s_cmp_ge_u32 s53, 12
    s_cselect_b32 s53, 0, s53
    s_mul_i32 s48, s53, 20480
    s_add_u32 s49, s48, 4096
    buffer_load_dwordx4 v[188:191], v226, s[36:39], s48 offen offset:0
    buffer_load_dwordx4 v[192:195], v226, s[36:39], s48 offen offset:1024
    buffer_load_dwordx4 v[196:199], v226, s[36:39], s48 offen offset:2048
    buffer_load_dwordx4 v[200:203], v226, s[36:39], s48 offen offset:3072
    buffer_load_dwordx4 v[204:207], v226, s[36:39], s49 offen
    s_lshl_b32 s48, s53, 12
    buffer_load_dwordx4 v[208:211], v224, s[28:31], s48 offen
    s_add_u32 s48, s48, 49152
    buffer_load_dwordx4 v[212:215], v224, s[28:31], s48 offen
    s_add_u32 s48, s48, 49152
    buffer_load_dwordx4 v[216:219], v224, s[28:31], s48 offen
    s_add_u32 s48, s48, 49152
    buffer_load_dwordx4 v[220:223], v224, s[28:31], s48 offen
    s_add_u32 s48, s48, 49152
    s_add_u32 s53, s53, 1
    s_cmp_ge_u32 s53, 12
    s_cselect_b32 s53, 0, s53
    v_lshlrev_b32 v233, 3, v229
    s_waitcnt vmcnt(42)
    v_cvt_pk_bf16_f32 v0, v0, v1
    v_cvt_pk_bf16_f32 v1, v2, v3
    ds_write_b64 v233, v[0:1] offset:0
    s_waitcnt vmcnt(41)
    v_cvt_pk_bf16_f32 v4, v4, v5
    v_cvt_pk_bf16_f32 v5, v6, v7
    ds_write_b64 v233, v[4:5] offset:2048
    s_waitcnt vmcnt(40)
    v_cvt_pk_bf16_f32 v8, v8, v9
    v_cvt_pk_bf16_f32 v9, v10, v11
    ds_write_b64 v233, v[8:9] offset:4096
    s_waitcnt vmcnt(39)
    v_cvt_pk_bf16_f32 v12, v12, v13
    v_cvt_pk_bf16_f32 v13, v14, v15
    ds_write_b64 v233, v[12:13] offset:6144
    s_waitcnt vmcnt(38)
    v_lshlrev_b32 v36, 16, v60
    v_and_b32 v37, 0xffff0000, v60
    v_lshlrev_b32 v38, 16, v61
    v_and_b32 v39, 0xffff0000, v61
    v_lshlrev_b32 v40, 16, v62
    v_and_b32 v41, 0xffff0000, v62
    v_lshlrev_b32 v42, 16, v63
    v_and_b32 v43, 0xffff0000, v63
    s_waitcnt vmcnt(37)
    v_lshlrev_b32 v44, 16, v64
    v_and_b32 v45, 0xffff0000, v64
    v_lshlrev_b32 v46, 16, v65
    v_and_b32 v47, 0xffff0000, v65
    v_lshlrev_b32 v48, 16, v66
    v_and_b32 v49, 0xffff0000, v66
    v_lshlrev_b32 v50, 16, v67
    v_and_b32 v51, 0xffff0000, v67
    s_waitcnt vmcnt(36)
    v_lshlrev_b32 v52, 16, v68
    v_and_b32 v53, 0xffff0000, v68
    v_lshlrev_b32 v54, 16, v69
    v_and_b32 v55, 0xffff0000, v69
    v_max3_f32 v0, v36, v37, v38
    v_min3_f32 v2, v36, v37, v38
    v_max3_f32 v0, v0, v39, v40
    v_min3_f32 v2, v2, v39, v40
    v_max3_f32 v0, v0, v41, v42
    v_min3_f32 v2, v2, v41, v42
    v_max3_f32 v0, v0, v43, v44
    v_min3_f32 v2, v2, v43, v44
    v_max3_f32 v0, v0, v45, v46
    v_min3_f32 v2, v2, v45, v46
    v_max3_f32 v0, v0, v47, v48
    v_min3_f32 v2, v2, v47, v48
    v_max3_f32 v0, v0, v49, v50
    v_min3_f32 v2, v2, v49, v50
    v_max3_f32 v0, v0, v51, v52
    v_min3_f32 v2, v2, v51, v52
    v_max3_f32 v0, v0, v53, v54
    v_min3_f32 v2, v2, v53, v54
    v_max_f32 v0, v0, v55
    v_min_f32 v2, v2, v55
    v_mov_b32 v4, 0x3fb8aa3b
    v_mul_f32 v0, v0, v4
    v_mul_f32 v2, v2, v4
    v_pk_fma_f32 v[16:17], v[36:37], v[4:5], v[0:1] op_sel_hi:[1,0,0] neg_lo:[0,0,1] neg_hi:[0,0,1]
    v_pk_fma_f32 v[36:37], v[36:37], v[4:5], v[2:3] op_sel_hi:[1,0,0] neg_lo:[1,0,0] neg_hi:[1,0,0]
    v_pk_fma_f32 v[18:19], v[38:39], v[4:5], v[0:1] op_sel_hi:[1,0,0] neg_lo:[0,0,1] neg_hi:[0,0,1]
    v_pk_fma_f32 v[38:39], v[38:39], v[4:5], v[2:3] op_sel_hi:[1,0,0] neg_lo:[1,0,0] neg_hi:[1,0,0]
    v_pk_fma_f32 v[20:21], v[40:41], v[4:5], v[0:1] op_sel_hi:[1,0,0] neg_lo:[0,0,1] neg_hi:[0,0,1]
    v_pk_fma_f32 v[40:41], v[40:41], v[4:5], v[2:3] op_sel_hi:[1,0,0] neg_lo:[1,0,0] neg_hi:[1,0,0]
    v_pk_fma_f32 v[22:23], v[42:43], v[4:5], v[0:1] op_sel_hi:[1,0,0] neg_lo:[0,0,1] neg_hi:[0,0,1]
    v_pk_fma_f32 v[42:43], v[42:43], v[4:5], v[2:3] op_sel_hi:[1,0,0] neg_lo:[1,0,0] neg_hi:[1,0,0]
    v_pk_fma_f32 v[24:25], v[44:45], v[4:5], v[0:1] op_sel_hi:[1,0,0] neg_lo:[0,0,1] neg_hi:[0,0,1]
    v_pk_fma_f32 v[44:45], v[44:45], v[4:5], v[2:3] op_sel_hi:[1,0,0] neg_lo:[1,0,0] neg_hi:[1,0,0]
    v_pk_fma_f32 v[26:27], v[46:47], v[4:5], v[0:1] op_sel_hi:[1,0,0] neg_lo:[0,0,1] neg_hi:[0,0,1]
    v_pk_fma_f32 v[46:47], v[46:47], v[4:5], v[2:3] op_sel_hi:[1,0,0] neg_lo:[1,0,0] neg_hi:[1,0,0]
    v_pk_fma_f32 v[28:29], v[48:49], v[4:5], v[0:1] op_sel_hi:[1,0,0] neg_lo:[0,0,1] neg_hi:[0,0,1]
    v_pk_fma_f32 v[48:49], v[48:49], v[4:5], v[2:3] op_sel_hi:[1,0,0] neg_lo:[1,0,0] neg_hi:[1,0,0]
    v_pk_fma_f32 v[30:31], v[50:51], v[4:5], v[0:1] op_sel_hi:[1,0,0] neg_lo:[0,0,1] neg_hi:[0,0,1]
    v_pk_fma_f32 v[50:51], v[50:51], v[4:5], v[2:3] op_sel_hi:[1,0,0] neg_lo:[1,0,0] neg_hi:[1,0,0]
    v_pk_fma_f32 v[32:33], v[52:53], v[4:5], v[0:1] op_sel_hi:[1,0,0] neg_lo:[0,0,1] neg_hi:[0,0,1]
    v_pk_fma_f32 v[52:53], v[52:53], v[4:5], v[2:3] op_sel_hi:[1,0,0] neg_lo:[1,0,0] neg_hi:[1,0,0]
    v_pk_fma_f32 v[34:35], v[54:55], v[4:5], v[0:1] op_sel_hi:[1,0,0] neg_lo:[0,0,1] neg_hi:[0,0,1]
    v_pk_fma_f32 v[54:55], v[54:55], v[4:5], v[2:3] op_sel_hi:[1,0,0] neg_lo:[1,0,0] neg_hi:[1,0,0]
    v_exp_f32 v16, v16
    v_exp_f32 v36, v36
    v_exp_f32 v17, v17
    v_exp_f32 v37, v37
    v_exp_f32 v18, v18
    v_exp_f32 v38, v38
    v_exp_f32 v19, v19
    v_exp_f32 v39, v39
    v_exp_f32 v20, v20
    v_exp_f32 v40, v40
    v_exp_f32 v21, v21
    v_exp_f32 v41, v41
    v_exp_f32 v22, v22
    v_exp_f32 v42, v42
    v_exp_f32 v23, v23
    v_exp_f32 v43, v43
    v_exp_f32 v24, v24
    v_exp_f32 v44, v44
    v_exp_f32 v25, v25
    v_exp_f32 v45, v45
    v_exp_f32 v26, v26
    v_exp_f32 v46, v46
    v_exp_f32 v27, v27
    v_exp_f32 v47, v47
    v_exp_f32 v28, v28
    v_exp_f32 v48, v48
    v_exp_f32 v29, v29
    v_exp_f32 v49, v49
    v_exp_f32 v30, v30
    v_exp_f32 v50, v50
    v_exp_f32 v31, v31
    v_exp_f32 v51, v51
    v_exp_f32 v32, v32
    v_exp_f32 v52, v52
    v_exp_f32 v33, v33
    v_exp_f32 v53, v53
    v_exp_f32 v34, v34
    v_exp_f32 v54, v54
    v_exp_f32 v35, v35
    v_exp_f32 v55, v55
    v_pk_add_f32 v[6:7], v[16:17], v[18:19]
    v_pk_add_f32 v[8:9], v[36:37], v[38:39]
    v_pk_add_f32 v[6:7], v[6:7], v[20:21]
    v_pk_add_f32 v[8:9], v[8:9], v[40:41]
    v_pk_add_f32 v[6:7], v[6:7], v[22:23]
    v_pk_add_f32 v[8:9], v[8:9], v[42:43]
    v_pk_add_f32 v[6:7], v[6:7], v[24:25]
    v_pk_add_f32 v[8:9], v[8:9], v[44:45]
    v_pk_add_f32 v[6:7], v[6:7], v[26:27]
    v_pk_add_f32 v[8:9], v[8:9], v[46:47]
    v_pk_add_f32 v[6:7], v[6:7], v[28:29]
    v_pk_add_f32 v[8:9], v[8:9], v[48:49]
    v_pk_add_f32 v[6:7], v[6:7], v[30:31]
    v_pk_add_f32 v[8:9], v[8:9], v[50:51]
    v_pk_add_f32 v[6:7], v[6:7], v[32:33]
    v_pk_add_f32 v[8:9], v[8:9], v[52:53]
    v_pk_add_f32 v[6:7], v[6:7], v[34:35]
    v_pk_add_f32 v[8:9], v[8:9], v[54:55]
    v_add_f32 v6, v6, v7
    v_add_f32 v8, v8, v9
    v_rcp_f32 v6, v6
    v_rcp_f32 v8, v8
    v_pk_mul_f32 v[16:17], v[16:17], v[6:7] op_sel_hi:[1,0]
    v_pk_mul_f32 v[36:37], v[36:37], v[8:9] op_sel_hi:[1,0]
    v_pk_mul_f32 v[18:19], v[18:19], v[6:7] op_sel_hi:[1,0]
    v_pk_mul_f32 v[38:39], v[38:39], v[8:9] op_sel_hi:[1,0]
    v_pk_mul_f32 v[20:21], v[20:21], v[6:7] op_sel_hi:[1,0]
    v_pk_mul_f32 v[40:41], v[40:41], v[8:9] op_sel_hi:[1,0]
    v_pk_mul_f32 v[22:23], v[22:23], v[6:7] op_sel_hi:[1,0]
    v_pk_mul_f32 v[42:43], v[42:43], v[8:9] op_sel_hi:[1,0]
    v_pk_mul_f32 v[24:25], v[24:25], v[6:7] op_sel_hi:[1,0]
    v_pk_mul_f32 v[44:45], v[44:45], v[8:9] op_sel_hi:[1,0]
    v_pk_mul_f32 v[26:27], v[26:27], v[6:7] op_sel_hi:[1,0]
    v_pk_mul_f32 v[46:47], v[46:47], v[8:9] op_sel_hi:[1,0]
    v_pk_mul_f32 v[28:29], v[28:29], v[6:7] op_sel_hi:[1,0]
    v_pk_mul_f32 v[48:49], v[48:49], v[8:9] op_sel_hi:[1,0]
    v_pk_mul_f32 v[30:31], v[30:31], v[6:7] op_sel_hi:[1,0]
    v_pk_mul_f32 v[50:51], v[50:51], v[8:9] op_sel_hi:[1,0]
    v_pk_mul_f32 v[32:33], v[32:33], v[6:7] op_sel_hi:[1,0]
    v_pk_mul_f32 v[52:53], v[52:53], v[8:9] op_sel_hi:[1,0]
    v_pk_mul_f32 v[34:35], v[34:35], v[6:7] op_sel_hi:[1,0]
    v_pk_mul_f32 v[54:55], v[54:55], v[8:9] op_sel_hi:[1,0]
    v_cvt_pk_bf16_f32 v16, v16, v17
    v_cvt_pk_bf16_f32 v17, v18, v19
    v_cvt_pk_bf16_f32 v18, v20, v21
    v_cvt_pk_bf16_f32 v19, v22, v23
    v_cvt_pk_bf16_f32 v20, v24, v25
    v_cvt_pk_bf16_f32 v21, v26, v27
    v_cvt_pk_bf16_f32 v22, v28, v29
    v_cvt_pk_bf16_f32 v23, v30, v31
    v_cvt_pk_bf16_f32 v24, v32, v33
    v_cvt_pk_bf16_f32 v25, v34, v35
    v_cvt_pk_bf16_f32 v26, v36, v37
    v_cvt_pk_bf16_f32 v27, v38, v39
    v_cvt_pk_bf16_f32 v28, v40, v41
    v_cvt_pk_bf16_f32 v29, v42, v43
    v_cvt_pk_bf16_f32 v30, v44, v45
    v_cvt_pk_bf16_f32 v31, v46, v47
    v_cvt_pk_bf16_f32 v32, v48, v49
    v_cvt_pk_bf16_f32 v33, v50, v51
    v_cvt_pk_bf16_f32 v34, v52, v53
    v_cvt_pk_bf16_f32 v35, v54, v55
    s_waitcnt lgkmcnt(0)
    s_barrier
    v_bfe_u32 v233, v227, 2, 2
    v_and_b32 v234, 3, v227
    v_lshrrev_b32 v235, 4, v227
    v_mul_u32_u24 v237, 1680, v233
    v_mul_u32_u24 v234, 80, v234
    v_add_u32 v234, v234, v237
    v_add_u32 v237, 1600, v237
    v_cmp_eq_u32 vcc, v233, v235
    v_mov_b32 v238, 6720
    s_nop 0
    v_cndmask_b32 v237, v238, v237, vcc
    v_add_u32 v239, 0, v234
    v_cndmask_b32 v240, v238, v239, vcc
    v_add_u32 v239, 320, v234
    v_cndmask_b32 v241, v238, v239, vcc
    v_add_u32 v239, 640, v234
    v_cndmask_b32 v242, v238, v239, vcc
    v_add_u32 v239, 960, v234
    v_cndmask_b32 v243, v238, v239, vcc
    v_add_u32 v239, 1280, v234
    v_cndmask_b32 v244, v238, v239, vcc
    ds_read_b128 v[60:63], v240 offset:0
    ds_read_b128 v[64:67], v240 offset:16
    ds_read_b128 v[68:71], v240 offset:32
    ds_read_b128 v[72:75], v240 offset:48
    ds_read_b128 v[76:79], v240 offset:64
    s_waitcnt lgkmcnt(4)
    v_mfma_f32_16x16x32_bf16 v[36:39], v[60:63], v[16:19], 0
    s_waitcnt lgkmcnt(3)
    v_mfma_f32_16x16x32_bf16 v[36:39], v[64:67], v[20:23], v[36:39]
    s_waitcnt lgkmcnt(2)
    v_mfma_f32_16x16x32_bf16 v[36:39], v[68:71], v[24:27], v[36:39]
    s_waitcnt lgkmcnt(1)
    v_mfma_f32_16x16x32_bf16 v[36:39], v[72:75], v[28:31], v[36:39]
    s_waitcnt lgkmcnt(0)
    v_mfma_f32_16x16x32_bf16 v[36:39], v[76:79], v[32:35], v[36:39]
    ds_read_b128 v[60:63], v241 offset:0
    ds_read_b128 v[64:67], v241 offset:16
    ds_read_b128 v[68:71], v241 offset:32
    ds_read_b128 v[72:75], v241 offset:48
    ds_read_b128 v[76:79], v241 offset:64
    s_waitcnt lgkmcnt(4)
    v_mfma_f32_16x16x32_bf16 v[40:43], v[60:63], v[16:19], 0
    s_waitcnt lgkmcnt(3)
    v_mfma_f32_16x16x32_bf16 v[40:43], v[64:67], v[20:23], v[40:43]
    s_waitcnt lgkmcnt(2)
    v_mfma_f32_16x16x32_bf16 v[40:43], v[68:71], v[24:27], v[40:43]
    s_waitcnt lgkmcnt(1)
    v_mfma_f32_16x16x32_bf16 v[40:43], v[72:75], v[28:31], v[40:43]
    s_waitcnt lgkmcnt(0)
    v_mfma_f32_16x16x32_bf16 v[40:43], v[76:79], v[32:35], v[40:43]
    ds_read_b128 v[60:63], v242 offset:0
    ds_read_b128 v[64:67], v242 offset:16
    ds_read_b128 v[68:71], v242 offset:32
    ds_read_b128 v[72:75], v242 offset:48
    ds_read_b128 v[76:79], v242 offset:64
    s_waitcnt lgkmcnt(4)
    v_mfma_f32_16x16x32_bf16 v[44:47], v[60:63], v[16:19], 0
    s_waitcnt lgkmcnt(3)
    v_mfma_f32_16x16x32_bf16 v[44:47], v[64:67], v[20:23], v[44:47]
    s_waitcnt lgkmcnt(2)
    v_mfma_f32_16x16x32_bf16 v[44:47], v[68:71], v[24:27], v[44:47]
    s_waitcnt lgkmcnt(1)
    v_mfma_f32_16x16x32_bf16 v[44:47], v[72:75], v[28:31], v[44:47]
    s_waitcnt lgkmcnt(0)
    v_mfma_f32_16x16x32_bf16 v[44:47], v[76:79], v[32:35], v[44:47]
    ds_read_b128 v[60:63], v243 offset:0
    ds_read_b128 v[64:67], v243 offset:16
    ds_read_b128 v[68:71], v243 offset:32
    ds_read_b128 v[72:75], v243 offset:48
    ds_read_b128 v[76:79], v243 offset:64
    s_waitcnt lgkmcnt(4)
    v_mfma_f32_16x16x32_bf16 v[48:51], v[60:63], v[16:19], 0
    s_waitcnt lgkmcnt(3)
    v_mfma_f32_16x16x32_bf16 v[48:51], v[64:67], v[20:23], v[48:51]
    s_waitcnt lgkmcnt(2)
    v_mfma_f32_16x16x32_bf16 v[48:51], v[68:71], v[24:27], v[48:51]
    s_waitcnt lgkmcnt(1)
    v_mfma_f32_16x16x32_bf16 v[48:51], v[72:75], v[28:31], v[48:51]
    s_waitcnt lgkmcnt(0)
    v_mfma_f32_16x16x32_bf16 v[48:51], v[76:79], v[32:35], v[48:51]
    ds_read_b128 v[60:63], v244 offset:0
    ds_read_b128 v[64:67], v244 offset:16
    ds_read_b128 v[68:71], v244 offset:32
    ds_read_b128 v[72:75], v244 offset:48
    ds_read_b128 v[76:79], v244 offset:64
    s_waitcnt lgkmcnt(4)
    v_mfma_f32_16x16x32_bf16 v[52:55], v[60:63], v[16:19], 0
    s_waitcnt lgkmcnt(3)
    v_mfma_f32_16x16x32_bf16 v[52:55], v[64:67], v[20:23], v[52:55]
    s_waitcnt lgkmcnt(2)
    v_mfma_f32_16x16x32_bf16 v[52:55], v[68:71], v[24:27], v[52:55]
    s_waitcnt lgkmcnt(1)
    v_mfma_f32_16x16x32_bf16 v[52:55], v[72:75], v[28:31], v[52:55]
    s_waitcnt lgkmcnt(0)
    v_mfma_f32_16x16x32_bf16 v[52:55], v[76:79], v[32:35], v[52:55]
    ds_read_b128 v[60:63], v237 offset:0
    ds_read_b128 v[64:67], v237 offset:16
    ds_read_b128 v[68:71], v237 offset:32
    ds_read_b128 v[72:75], v237 offset:48
    ds_read_b128 v[76:79], v237 offset:64
    s_waitcnt lgkmcnt(4)
    v_mfma_f32_16x16x32_bf16 v[56:59], v[60:63], v[16:19], 0
    s_waitcnt lgkmcnt(3)
    v_mfma_f32_16x16x32_bf16 v[56:59], v[64:67], v[20:23], v[56:59]
    s_waitcnt lgkmcnt(2)
    v_mfma_f32_16x16x32_bf16 v[56:59], v[68:71], v[24:27], v[56:59]
    s_waitcnt lgkmcnt(1)
    v_mfma_f32_16x16x32_bf16 v[56:59], v[72:75], v[28:31], v[56:59]
    s_waitcnt lgkmcnt(0)
    v_mfma_f32_16x16x32_bf16 v[56:59], v[76:79], v[32:35], v[56:59]
    s_nop 7
    v_cvt_pk_bf16_f32 v233, v56, v56
    v_lshlrev_b32 v233, 16, v233
    v_add_f32 v233, 0x358637bd, v233
    v_cvt_pk_bf16_f32 v233, v233, v233
    v_lshlrev_b32 v233, 16, v233
    v_rcp_f32 v234, v233
    v_cvt_pk_bf16_f32 v235, v36, v37
    v_lshlrev_b32 v36, 16, v235
    v_and_b32 v37, 0xffff0000, v235
    v_cvt_pk_bf16_f32 v235, v38, v39
    v_lshlrev_b32 v38, 16, v235
    v_and_b32 v39, 0xffff0000, v235
    v_cvt_pk_bf16_f32 v235, v40, v41
    v_lshlrev_b32 v40, 16, v235
    v_and_b32 v41, 0xffff0000, v235
    v_cvt_pk_bf16_f32 v235, v42, v43
    v_lshlrev_b32 v42, 16, v235
    v_and_b32 v43, 0xffff0000, v235
    v_cvt_pk_bf16_f32 v235, v44, v45
    v_lshlrev_b32 v44, 16, v235
    v_and_b32 v45, 0xffff0000, v235
    v_cvt_pk_bf16_f32 v235, v46, v47
    v_lshlrev_b32 v46, 16, v235
    v_and_b32 v47, 0xffff0000, v235
    v_cvt_pk_bf16_f32 v235, v48, v49
    v_lshlrev_b32 v48, 16, v235
    v_and_b32 v49, 0xffff0000, v235
    v_cvt_pk_bf16_f32 v235, v50, v51
    v_lshlrev_b32 v50, 16, v235
    v_and_b32 v51, 0xffff0000, v235
    v_cvt_pk_bf16_f32 v235, v52, v53
    v_lshlrev_b32 v52, 16, v235
    v_and_b32 v53, 0xffff0000, v235
    v_cvt_pk_bf16_f32 v235, v54, v55
    v_lshlrev_b32 v54, 16, v235
    v_and_b32 v55, 0xffff0000, v235
    v_pk_mul_f32 v[36:37], v[36:37], v[234:235] op_sel_hi:[1,0]
    v_pk_mul_f32 v[38:39], v[38:39], v[234:235] op_sel_hi:[1,0]
    v_pk_mul_f32 v[40:41], v[40:41], v[234:235] op_sel_hi:[1,0]
    v_pk_mul_f32 v[42:43], v[42:43], v[234:235] op_sel_hi:[1,0]
    v_pk_mul_f32 v[44:45], v[44:45], v[234:235] op_sel_hi:[1,0]
    v_pk_mul_f32 v[46:47], v[46:47], v[234:235] op_sel_hi:[1,0]
    v_pk_mul_f32 v[48:49], v[48:49], v[234:235] op_sel_hi:[1,0]
    v_pk_mul_f32 v[50:51], v[50:51], v[234:235] op_sel_hi:[1,0]
    v_pk_mul_f32 v[52:53], v[52:53], v[234:235] op_sel_hi:[1,0]
    v_pk_mul_f32 v[54:55], v[54:55], v[234:235] op_sel_hi:[1,0]
    v_cvt_pk_bf16_f32 v60, v36, v37
    v_cvt_pk_bf16_f32 v61, v38, v39
    v_cvt_pk_bf16_f32 v62, v40, v41
    v_cvt_pk_bf16_f32 v63, v42, v43
    v_cvt_pk_bf16_f32 v64, v44, v45
    v_cvt_pk_bf16_f32 v65, v46, v47
    v_cvt_pk_bf16_f32 v66, v48, v49
    v_cvt_pk_bf16_f32 v67, v50, v51
    v_cvt_pk_bf16_f32 v68, v52, v53
    v_cvt_pk_bf16_f32 v69, v54, v55
    v_mov_b32 v70, 0
    v_mov_b32 v71, 0
    s_lshl_b32 s48, s51, 5
    s_add_u32 s48, s48, s52
    s_mul_i32 s48, s48, 3072
    v_mul_u32_u24 v236, 24576, v228
    v_add3_u32 v236, v236, v230, s48
    buffer_store_dwordx4 v[60:63], v236, s[32:35], 0 offen offset:0 sc1
    buffer_store_dwordx4 v[64:67], v236, s[32:35], 0 offen offset:1024 sc1
    buffer_store_dwordx4 v[68:71], v236, s[32:35], 0 offen offset:2048 sc1
    s_waitcnt vmcnt(0)
    v_mov_b32 v233, 1
    s_lshl_b32 s48, s51, 7
    s_lshl_b32 s49, s52, 4
    s_add_u32 s48, s48, s49
    s_lshl_b32 s49, s47, 2
    s_add_u32 s48, s48, s49
    v_mov_b32 v234, s48
    s_mov_b64 exec, 1
    buffer_store_dword v233, v234, s[60:63], 0 offen sc1
    s_mov_b64 exec, -1
    v_mov_b32 v0, 0
    v_mov_b32 v1, 0
    v_mov_b32 v2, 0
    v_mov_b32 v3, 0
    v_mov_b32 v4, 0
    v_mov_b32 v5, 0
    v_mov_b32 v6, 0
    v_mov_b32 v7, 0
    v_mov_b32 v8, 0
    v_mov_b32 v9, 0
    v_mov_b32 v10, 0
    v_mov_b32 v11, 0
    v_mov_b32 v12, 0
    v_mov_b32 v13, 0
    v_mov_b32 v14, 0
    v_mov_b32 v15, 0
    v_mov_b32 v16, 0
    v_mov_b32 v17, 0
    v_mov_b32 v18, 0
    v_mov_b32 v19, 0
    v_mov_b32 v20, 0
    v_mov_b32 v21, 0
    v_mov_b32 v22, 0
    v_mov_b32 v23, 0
    v_mov_b32 v24, 0
    v_mov_b32 v25, 0
    v_mov_b32 v26, 0
    v_mov_b32 v27, 0
    v_mov_b32 v28, 0
    v_mov_b32 v29, 0
    v_mov_b32 v30, 0
    v_mov_b32 v31, 0
    v_mov_b32 v32, 0
    v_mov_b32 v33, 0
    v_mov_b32 v34, 0
    v_mov_b32 v35, 0
    v_mov_b32 v36, 0
    v_mov_b32 v37, 0
    v_mov_b32 v38, 0
    v_mov_b32 v39, 0
    v_mov_b32 v40, 0
    v_mov_b32 v41, 0
    v_mov_b32 v42, 0
    v_mov_b32 v43, 0
    v_mov_b32 v44, 0
    v_mov_b32 v45, 0
    v_mov_b32 v46, 0
    v_mov_b32 v47, 0
    v_mov_b32 v48, 0
    v_mov_b32 v49, 0
    v_mov_b32 v50, 0
    v_mov_b32 v51, 0
    v_mov_b32 v52, 0
    v_mov_b32 v53, 0
    v_mov_b32 v54, 0
    v_mov_b32 v55, 0
    v_mov_b32 v56, 0
    v_mov_b32 v57, 0
    v_mov_b32 v58, 0
    v_mov_b32 v59, 0
    v_mov_b32 v60, 0
    v_mov_b32 v61, 0
    v_mov_b32 v62, 0
    v_mov_b32 v63, 0
    v_mov_b32 v64, 0
    v_mov_b32 v65, 0
    v_mov_b32 v66, 0
    v_mov_b32 v67, 0
    v_mov_b32 v68, 0
    v_mov_b32 v69, 0
    v_mov_b32 v70, 0
    v_mov_b32 v71, 0
    v_mov_b32 v72, 0
    v_mov_b32 v73, 0
    v_mov_b32 v74, 0
    v_mov_b32 v75, 0
    v_mov_b32 v76, 0
    v_mov_b32 v77, 0
    v_mov_b32 v78, 0
    v_mov_b32 v79, 0
    v_mfma_f32_16x16x32_bf16 v[0:3], v[80:83], v[100:103], v[0:3]
    v_mfma_f32_16x16x32_bf16 v[4:7], v[80:83], v[104:107], v[4:7]
    v_mfma_f32_16x16x32_bf16 v[8:11], v[80:83], v[108:111], v[8:11]
    v_mfma_f32_16x16x32_bf16 v[12:15], v[80:83], v[112:115], v[12:15]
    v_mfma_f32_16x16x32_bf16 v[16:19], v[84:87], v[100:103], v[16:19]
    v_mfma_f32_16x16x32_bf16 v[20:23], v[84:87], v[104:107], v[20:23]
    v_mfma_f32_16x16x32_bf16 v[24:27], v[84:87], v[108:111], v[24:27]
    v_mfma_f32_16x16x32_bf16 v[28:31], v[84:87], v[112:115], v[28:31]
    v_mfma_f32_16x16x32_bf16 v[32:35], v[88:91], v[100:103], v[32:35]
    v_mfma_f32_16x16x32_bf16 v[36:39], v[88:91], v[104:107], v[36:39]
    v_mfma_f32_16x16x32_bf16 v[40:43], v[88:91], v[108:111], v[40:43]
    v_mfma_f32_16x16x32_bf16 v[44:47], v[88:91], v[112:115], v[44:47]
    v_mfma_f32_16x16x32_bf16 v[48:51], v[92:95], v[100:103], v[48:51]
    v_mfma_f32_16x16x32_bf16 v[52:55], v[92:95], v[104:107], v[52:55]
    v_mfma_f32_16x16x32_bf16 v[56:59], v[92:95], v[108:111], v[56:59]
    v_mfma_f32_16x16x32_bf16 v[60:63], v[92:95], v[112:115], v[60:63]
    v_mfma_f32_16x16x32_bf16 v[64:67], v[96:99], v[100:103], v[64:67]
    v_mfma_f32_16x16x32_bf16 v[68:71], v[96:99], v[104:107], v[68:71]
    v_mfma_f32_16x16x32_bf16 v[72:75], v[96:99], v[108:111], v[72:75]
    v_mfma_f32_16x16x32_bf16 v[76:79], v[96:99], v[112:115], v[76:79]
    s_mul_i32 s48, s53, 20480
    s_add_u32 s49, s48, 4096
    buffer_load_dwordx4 v[80:83], v226, s[36:39], s48 offen offset:0
    buffer_load_dwordx4 v[84:87], v226, s[36:39], s48 offen offset:1024
    buffer_load_dwordx4 v[88:91], v226, s[36:39], s48 offen offset:2048
    buffer_load_dwordx4 v[92:95], v226, s[36:39], s48 offen offset:3072
    buffer_load_dwordx4 v[96:99], v226, s[36:39], s49 offen
    s_lshl_b32 s48, s53, 12
    buffer_load_dwordx4 v[100:103], v224, s[28:31], s48 offen
    s_add_u32 s48, s48, 49152
    buffer_load_dwordx4 v[104:107], v224, s[28:31], s48 offen
    s_add_u32 s48, s48, 49152
    buffer_load_dwordx4 v[108:111], v224, s[28:31], s48 offen
    s_add_u32 s48, s48, 49152
    buffer_load_dwordx4 v[112:115], v224, s[28:31], s48 offen
    s_add_u32 s48, s48, 49152
    s_add_u32 s53, s53, 1
    s_cmp_ge_u32 s53, 12
    s_cselect_b32 s53, 0, s53
    v_mfma_f32_16x16x32_bf16 v[0:3], v[116:119], v[136:139], v[0:3]
    v_mfma_f32_16x16x32_bf16 v[4:7], v[116:119], v[140:143], v[4:7]
    v_mfma_f32_16x16x32_bf16 v[8:11], v[116:119], v[144:147], v[8:11]
    v_mfma_f32_16x16x32_bf16 v[12:15], v[116:119], v[148:151], v[12:15]
    v_mfma_f32_16x16x32_bf16 v[16:19], v[120:123], v[136:139], v[16:19]
    v_mfma_f32_16x16x32_bf16 v[20:23], v[120:123], v[140:143], v[20:23]
    v_mfma_f32_16x16x32_bf16 v[24:27], v[120:123], v[144:147], v[24:27]
    v_mfma_f32_16x16x32_bf16 v[28:31], v[120:123], v[148:151], v[28:31]
    v_mfma_f32_16x16x32_bf16 v[32:35], v[124:127], v[136:139], v[32:35]
    v_mfma_f32_16x16x32_bf16 v[36:39], v[124:127], v[140:143], v[36:39]
    v_mfma_f32_16x16x32_bf16 v[40:43], v[124:127], v[144:147], v[40:43]
    v_mfma_f32_16x16x32_bf16 v[44:47], v[124:127], v[148:151], v[44:47]
    v_mfma_f32_16x16x32_bf16 v[48:51], v[128:131], v[136:139], v[48:51]
    v_mfma_f32_16x16x32_bf16 v[52:55], v[128:131], v[140:143], v[52:55]
    v_mfma_f32_16x16x32_bf16 v[56:59], v[128:131], v[144:147], v[56:59]
    v_mfma_f32_16x16x32_bf16 v[60:63], v[128:131], v[148:151], v[60:63]
    v_mfma_f32_16x16x32_bf16 v[64:67], v[132:135], v[136:139], v[64:67]
    v_mfma_f32_16x16x32_bf16 v[68:71], v[132:135], v[140:143], v[68:71]
    v_mfma_f32_16x16x32_bf16 v[72:75], v[132:135], v[144:147], v[72:75]
    v_mfma_f32_16x16x32_bf16 v[76:79], v[132:135], v[148:151], v[76:79]
    s_mul_i32 s48, s53, 20480
    s_add_u32 s49, s48, 4096
    buffer_load_dwordx4 v[116:119], v226, s[36:39], s48 offen offset:0
    buffer_load_dwordx4 v[120:123], v226, s[36:39], s48 offen offset:1024
    buffer_load_dwordx4 v[124:127], v226, s[36:39], s48 offen offset:2048
    buffer_load_dwordx4 v[128:131], v226, s[36:39], s48 offen offset:3072
    buffer_load_dwordx4 v[132:135], v226, s[36:39], s49 offen
    s_lshl_b32 s48, s53, 12
    buffer_load_dwordx4 v[136:139], v224, s[28:31], s48 offen
    s_add_u32 s48, s48, 49152
    buffer_load_dwordx4 v[140:143], v224, s[28:31], s48 offen
    s_add_u32 s48, s48, 49152
    buffer_load_dwordx4 v[144:147], v224, s[28:31], s48 offen
    s_add_u32 s48, s48, 49152
    buffer_load_dwordx4 v[148:151], v224, s[28:31], s48 offen
    s_add_u32 s48, s48, 49152
    s_add_u32 s53, s53, 1
    s_cmp_ge_u32 s53, 12
    s_cselect_b32 s53, 0, s53
    v_mfma_f32_16x16x32_bf16 v[0:3], v[152:155], v[172:175], v[0:3]
    v_mfma_f32_16x16x32_bf16 v[4:7], v[152:155], v[176:179], v[4:7]
    v_mfma_f32_16x16x32_bf16 v[8:11], v[152:155], v[180:183], v[8:11]
    v_mfma_f32_16x16x32_bf16 v[12:15], v[152:155], v[184:187], v[12:15]
    v_mfma_f32_16x16x32_bf16 v[16:19], v[156:159], v[172:175], v[16:19]
    v_mfma_f32_16x16x32_bf16 v[20:23], v[156:159], v[176:179], v[20:23]
    v_mfma_f32_16x16x32_bf16 v[24:27], v[156:159], v[180:183], v[24:27]
    v_mfma_f32_16x16x32_bf16 v[28:31], v[156:159], v[184:187], v[28:31]
    v_mfma_f32_16x16x32_bf16 v[32:35], v[160:163], v[172:175], v[32:35]
    v_mfma_f32_16x16x32_bf16 v[36:39], v[160:163], v[176:179], v[36:39]
    v_mfma_f32_16x16x32_bf16 v[40:43], v[160:163], v[180:183], v[40:43]
    v_mfma_f32_16x16x32_bf16 v[44:47], v[160:163], v[184:187], v[44:47]
    v_mfma_f32_16x16x32_bf16 v[48:51], v[164:167], v[172:175], v[48:51]
    v_mfma_f32_16x16x32_bf16 v[52:55], v[164:167], v[176:179], v[52:55]
    v_mfma_f32_16x16x32_bf16 v[56:59], v[164:167], v[180:183], v[56:59]
    v_mfma_f32_16x16x32_bf16 v[60:63], v[164:167], v[184:187], v[60:63]
    v_mfma_f32_16x16x32_bf16 v[64:67], v[168:171], v[172:175], v[64:67]
    v_mfma_f32_16x16x32_bf16 v[68:71], v[168:171], v[176:179], v[68:71]
    v_mfma_f32_16x16x32_bf16 v[72:75], v[168:171], v[180:183], v[72:75]
    v_mfma_f32_16x16x32_bf16 v[76:79], v[168:171], v[184:187], v[76:79]
    s_mul_i32 s48, s53, 20480
    s_add_u32 s49, s48, 4096
    buffer_load_dwordx4 v[152:155], v226, s[36:39], s48 offen offset:0
    buffer_load_dwordx4 v[156:159], v226, s[36:39], s48 offen offset:1024
    buffer_load_dwordx4 v[160:163], v226, s[36:39], s48 offen offset:2048
    buffer_load_dwordx4 v[164:167], v226, s[36:39], s48 offen offset:3072
    buffer_load_dwordx4 v[168:171], v226, s[36:39], s49 offen
    s_lshl_b32 s48, s53, 12
    buffer_load_dwordx4 v[172:175], v224, s[28:31], s48 offen
    s_add_u32 s48, s48, 49152
    buffer_load_dwordx4 v[176:179], v224, s[28:31], s48 offen
    s_add_u32 s48, s48, 49152
    buffer_load_dwordx4 v[180:183], v224, s[28:31], s48 offen
    s_add_u32 s48, s48, 49152
    buffer_load_dwordx4 v[184:187], v224, s[28:31], s48 offen
    s_add_u32 s48, s48, 49152
    s_add_u32 s53, s53, 1
    s_cmp_ge_u32 s53, 12
    s_cselect_b32 s53, 0, s53
    v_mfma_f32_16x16x32_bf16 v[0:3], v[188:191], v[208:211], v[0:3]
    v_mfma_f32_16x16x32_bf16 v[4:7], v[188:191], v[212:215], v[4:7]
    v_mfma_f32_16x16x32_bf16 v[8:11], v[188:191], v[216:219], v[8:11]
    v_mfma_f32_16x16x32_bf16 v[12:15], v[188:191], v[220:223], v[12:15]
    v_mfma_f32_16x16x32_bf16 v[16:19], v[192:195], v[208:211], v[16:19]
    v_mfma_f32_16x16x32_bf16 v[20:23], v[192:195], v[212:215], v[20:23]
    v_mfma_f32_16x16x32_bf16 v[24:27], v[192:195], v[216:219], v[24:27]
    v_mfma_f32_16x16x32_bf16 v[28:31], v[192:195], v[220:223], v[28:31]
    v_mfma_f32_16x16x32_bf16 v[32:35], v[196:199], v[208:211], v[32:35]
    v_mfma_f32_16x16x32_bf16 v[36:39], v[196:199], v[212:215], v[36:39]
    v_mfma_f32_16x16x32_bf16 v[40:43], v[196:199], v[216:219], v[40:43]
    v_mfma_f32_16x16x32_bf16 v[44:47], v[196:199], v[220:223], v[44:47]
    v_mfma_f32_16x16x32_bf16 v[48:51], v[200:203], v[208:211], v[48:51]
    v_mfma_f32_16x16x32_bf16 v[52:55], v[200:203], v[212:215], v[52:55]
    v_mfma_f32_16x16x32_bf16 v[56:59], v[200:203], v[216:219], v[56:59]
    v_mfma_f32_16x16x32_bf16 v[60:63], v[200:203], v[220:223], v[60:63]
    v_mfma_f32_16x16x32_bf16 v[64:67], v[204:207], v[208:211], v[64:67]
    v_mfma_f32_16x16x32_bf16 v[68:71], v[204:207], v[212:215], v[68:71]
    v_mfma_f32_16x16x32_bf16 v[72:75], v[204:207], v[216:219], v[72:75]
    v_mfma_f32_16x16x32_bf16 v[76:79], v[204:207], v[220:223], v[76:79]
    s_mul_i32 s48, s53, 20480
    s_add_u32 s49, s48, 4096
    buffer_load_dwordx4 v[188:191], v226, s[36:39], s48 offen offset:0
    buffer_load_dwordx4 v[192:195], v226, s[36:39], s48 offen offset:1024
    buffer_load_dwordx4 v[196:199], v226, s[36:39], s48 offen offset:2048
    buffer_load_dwordx4 v[200:203], v226, s[36:39], s48 offen offset:3072
    buffer_load_dwordx4 v[204:207], v226, s[36:39], s49 offen
    s_lshl_b32 s48, s53, 12
    buffer_load_dwordx4 v[208:211], v224, s[28:31], s48 offen
    s_add_u32 s48, s48, 49152
    buffer_load_dwordx4 v[212:215], v224, s[28:31], s48 offen
    s_add_u32 s48, s48, 49152
    buffer_load_dwordx4 v[216:219], v224, s[28:31], s48 offen
    s_add_u32 s48, s48, 49152
    buffer_load_dwordx4 v[220:223], v224, s[28:31], s48 offen
    s_add_u32 s48, s48, 49152
    s_add_u32 s53, s53, 1
    s_cmp_ge_u32 s53, 12
    s_cselect_b32 s53, 0, s53
    s_waitcnt vmcnt(27)
    v_mfma_f32_16x16x32_bf16 v[0:3], v[80:83], v[100:103], v[0:3]
    v_mfma_f32_16x16x32_bf16 v[4:7], v[80:83], v[104:107], v[4:7]
    v_mfma_f32_16x16x32_bf16 v[8:11], v[80:83], v[108:111], v[8:11]
    v_mfma_f32_16x16x32_bf16 v[12:15], v[80:83], v[112:115], v[12:15]
    v_mfma_f32_16x16x32_bf16 v[16:19], v[84:87], v[100:103], v[16:19]
    v_mfma_f32_16x16x32_bf16 v[20:23], v[84:87], v[104:107], v[20:23]
    v_mfma_f32_16x16x32_bf16 v[24:27], v[84:87], v[108:111], v[24:27]
    v_mfma_f32_16x16x32_bf16 v[28:31], v[84:87], v[112:115], v[28:31]
    v_mfma_f32_16x16x32_bf16 v[32:35], v[88:91], v[100:103], v[32:35]
    v_mfma_f32_16x16x32_bf16 v[36:39], v[88:91], v[104:107], v[36:39]
    v_mfma_f32_16x16x32_bf16 v[40:43], v[88:91], v[108:111], v[40:43]
    v_mfma_f32_16x16x32_bf16 v[44:47], v[88:91], v[112:115], v[44:47]
    v_mfma_f32_16x16x32_bf16 v[48:51], v[92:95], v[100:103], v[48:51]
    v_mfma_f32_16x16x32_bf16 v[52:55], v[92:95], v[104:107], v[52:55]
    v_mfma_f32_16x16x32_bf16 v[56:59], v[92:95], v[108:111], v[56:59]
    v_mfma_f32_16x16x32_bf16 v[60:63], v[92:95], v[112:115], v[60:63]
    v_mfma_f32_16x16x32_bf16 v[64:67], v[96:99], v[100:103], v[64:67]
    v_mfma_f32_16x16x32_bf16 v[68:71], v[96:99], v[104:107], v[68:71]
    v_mfma_f32_16x16x32_bf16 v[72:75], v[96:99], v[108:111], v[72:75]
    v_mfma_f32_16x16x32_bf16 v[76:79], v[96:99], v[112:115], v[76:79]
    s_lshl_b32 s48, s51, 7
    v_and_b32 v233, 31, v227
    v_lshlrev_b32 v233, 2, v233
    v_add_u32 v233, s48, v233
    buffer_load_dword v234, v233, s[60:63], 0 offen sc1
    s_mul_i32 s48, s53, 20480
    s_add_u32 s49, s48, 4096
    buffer_load_dwordx4 v[80:83], v226, s[36:39], s48 offen offset:0
    buffer_load_dwordx4 v[84:87], v226, s[36:39], s48 offen offset:1024
    buffer_load_dwordx4 v[88:91], v226, s[36:39], s48 offen offset:2048
    buffer_load_dwordx4 v[92:95], v226, s[36:39], s48 offen offset:3072
    buffer_load_dwordx4 v[96:99], v226, s[36:39], s49 offen
    s_lshl_b32 s48, s53, 12
    buffer_load_dwordx4 v[100:103], v224, s[28:31], s48 offen
    s_add_u32 s48, s48, 49152
    buffer_load_dwordx4 v[104:107], v224, s[28:31], s48 offen
    s_add_u32 s48, s48, 49152
    buffer_load_dwordx4 v[108:111], v224, s[28:31], s48 offen
    s_add_u32 s48, s48, 49152
    buffer_load_dwordx4 v[112:115], v224, s[28:31], s48 offen
    s_add_u32 s48, s48, 49152
    s_add_u32 s53, s53, 1
    s_cmp_ge_u32 s53, 12
    s_cselect_b32 s53, 0, s53
    s_waitcnt vmcnt(27)
    v_mfma_f32_16x16x32_bf16 v[0:3], v[116:119], v[136:139], v[0:3]
    v_mfma_f32_16x16x32_bf16 v[4:7], v[116:119], v[140:143], v[4:7]
    v_mfma_f32_16x16x32_bf16 v[8:11], v[116:119], v[144:147], v[8:11]
    v_mfma_f32_16x16x32_bf16 v[12:15], v[116:119], v[148:151], v[12:15]
    v_mfma_f32_16x16x32_bf16 v[16:19], v[120:123], v[136:139], v[16:19]
    v_mfma_f32_16x16x32_bf16 v[20:23], v[120:123], v[140:143], v[20:23]
    v_mfma_f32_16x16x32_bf16 v[24:27], v[120:123], v[144:147], v[24:27]
    v_mfma_f32_16x16x32_bf16 v[28:31], v[120:123], v[148:151], v[28:31]
    v_mfma_f32_16x16x32_bf16 v[32:35], v[124:127], v[136:139], v[32:35]
    v_mfma_f32_16x16x32_bf16 v[36:39], v[124:127], v[140:143], v[36:39]
    v_mfma_f32_16x16x32_bf16 v[40:43], v[124:127], v[144:147], v[40:43]
    v_mfma_f32_16x16x32_bf16 v[44:47], v[124:127], v[148:151], v[44:47]
    v_mfma_f32_16x16x32_bf16 v[48:51], v[128:131], v[136:139], v[48:51]
    v_mfma_f32_16x16x32_bf16 v[52:55], v[128:131], v[140:143], v[52:55]
    v_mfma_f32_16x16x32_bf16 v[56:59], v[128:131], v[144:147], v[56:59]
    v_mfma_f32_16x16x32_bf16 v[60:63], v[128:131], v[148:151], v[60:63]
    v_mfma_f32_16x16x32_bf16 v[64:67], v[132:135], v[136:139], v[64:67]
    v_mfma_f32_16x16x32_bf16 v[68:71], v[132:135], v[140:143], v[68:71]
    v_mfma_f32_16x16x32_bf16 v[72:75], v[132:135], v[144:147], v[72:75]
    v_mfma_f32_16x16x32_bf16 v[76:79], v[132:135], v[148:151], v[76:79]
    s_mul_i32 s48, s53, 20480
    s_add_u32 s49, s48, 4096
    buffer_load_dwordx4 v[116:119], v226, s[36:39], s48 offen offset:0
    buffer_load_dwordx4 v[120:123], v226, s[36:39], s48 offen offset:1024
    buffer_load_dwordx4 v[124:127], v226, s[36:39], s48 offen offset:2048
    buffer_load_dwordx4 v[128:131], v226, s[36:39], s48 offen offset:3072
    buffer_load_dwordx4 v[132:135], v226, s[36:39], s49 offen
    s_lshl_b32 s48, s53, 12
    buffer_load_dwordx4 v[136:139], v224, s[28:31], s48 offen
    s_add_u32 s48, s48, 49152
    buffer_load_dwordx4 v[140:143], v224, s[28:31], s48 offen
    s_add_u32 s48, s48, 49152
    buffer_load_dwordx4 v[144:147], v224, s[28:31], s48 offen
    s_add_u32 s48, s48, 49152
    buffer_load_dwordx4 v[148:151], v224, s[28:31], s48 offen
    s_add_u32 s48, s48, 49152
    s_add_u32 s53, s53, 1
    s_cmp_ge_u32 s53, 12
    s_cselect_b32 s53, 0, s53
    s_waitcnt vmcnt(27)
    v_mfma_f32_16x16x32_bf16 v[0:3], v[152:155], v[172:175], v[0:3]
    v_mfma_f32_16x16x32_bf16 v[4:7], v[152:155], v[176:179], v[4:7]
    v_mfma_f32_16x16x32_bf16 v[8:11], v[152:155], v[180:183], v[8:11]
    v_mfma_f32_16x16x32_bf16 v[12:15], v[152:155], v[184:187], v[12:15]
    v_mfma_f32_16x16x32_bf16 v[16:19], v[156:159], v[172:175], v[16:19]
    v_mfma_f32_16x16x32_bf16 v[20:23], v[156:159], v[176:179], v[20:23]
    v_mfma_f32_16x16x32_bf16 v[24:27], v[156:159], v[180:183], v[24:27]
    v_mfma_f32_16x16x32_bf16 v[28:31], v[156:159], v[184:187], v[28:31]
    v_mfma_f32_16x16x32_bf16 v[32:35], v[160:163], v[172:175], v[32:35]
    v_mfma_f32_16x16x32_bf16 v[36:39], v[160:163], v[176:179], v[36:39]
    v_mfma_f32_16x16x32_bf16 v[40:43], v[160:163], v[180:183], v[40:43]
    v_mfma_f32_16x16x32_bf16 v[44:47], v[160:163], v[184:187], v[44:47]
    v_mfma_f32_16x16x32_bf16 v[48:51], v[164:167], v[172:175], v[48:51]
    v_mfma_f32_16x16x32_bf16 v[52:55], v[164:167], v[176:179], v[52:55]
    v_mfma_f32_16x16x32_bf16 v[56:59], v[164:167], v[180:183], v[56:59]
    v_mfma_f32_16x16x32_bf16 v[60:63], v[164:167], v[184:187], v[60:63]
    v_mfma_f32_16x16x32_bf16 v[64:67], v[168:171], v[172:175], v[64:67]
    v_mfma_f32_16x16x32_bf16 v[68:71], v[168:171], v[176:179], v[68:71]
    v_mfma_f32_16x16x32_bf16 v[72:75], v[168:171], v[180:183], v[72:75]
    v_mfma_f32_16x16x32_bf16 v[76:79], v[168:171], v[184:187], v[76:79]
    s_mul_i32 s48, s53, 20480
    s_add_u32 s49, s48, 4096
    buffer_load_dwordx4 v[152:155], v226, s[36:39], s48 offen offset:0
    buffer_load_dwordx4 v[156:159], v226, s[36:39], s48 offen offset:1024
    buffer_load_dwordx4 v[160:163], v226, s[36:39], s48 offen offset:2048
    buffer_load_dwordx4 v[164:167], v226, s[36:39], s48 offen offset:3072
    buffer_load_dwordx4 v[168:171], v226, s[36:39], s49 offen
    s_lshl_b32 s48, s53, 12
    buffer_load_dwordx4 v[172:175], v224, s[28:31], s48 offen
    s_add_u32 s48, s48, 49152
    buffer_load_dwordx4 v[176:179], v224, s[28:31], s48 offen
    s_add_u32 s48, s48, 49152
    buffer_load_dwordx4 v[180:183], v224, s[28:31], s48 offen
    s_add_u32 s48, s48, 49152
    buffer_load_dwordx4 v[184:187], v224, s[28:31], s48 offen
    s_add_u32 s48, s48, 49152
    s_add_u32 s53, s53, 1
    s_cmp_ge_u32 s53, 12
    s_cselect_b32 s53, 0, s53
    s_waitcnt vmcnt(27)
    v_mfma_f32_16x16x32_bf16 v[0:3], v[188:191], v[208:211], v[0:3]
    v_mfma_f32_16x16x32_bf16 v[4:7], v[188:191], v[212:215], v[4:7]
    v_mfma_f32_16x16x32_bf16 v[8:11], v[188:191], v[216:219], v[8:11]
    v_mfma_f32_16x16x32_bf16 v[12:15], v[188:191], v[220:223], v[12:15]
    v_mfma_f32_16x16x32_bf16 v[16:19], v[192:195], v[208:211], v[16:19]
    v_mfma_f32_16x16x32_bf16 v[20:23], v[192:195], v[212:215], v[20:23]
    v_mfma_f32_16x16x32_bf16 v[24:27], v[192:195], v[216:219], v[24:27]
    v_mfma_f32_16x16x32_bf16 v[28:31], v[192:195], v[220:223], v[28:31]
    v_mfma_f32_16x16x32_bf16 v[32:35], v[196:199], v[208:211], v[32:35]
    v_mfma_f32_16x16x32_bf16 v[36:39], v[196:199], v[212:215], v[36:39]
    v_mfma_f32_16x16x32_bf16 v[40:43], v[196:199], v[216:219], v[40:43]
    v_mfma_f32_16x16x32_bf16 v[44:47], v[196:199], v[220:223], v[44:47]
    v_mfma_f32_16x16x32_bf16 v[48:51], v[200:203], v[208:211], v[48:51]
    v_mfma_f32_16x16x32_bf16 v[52:55], v[200:203], v[212:215], v[52:55]
    v_mfma_f32_16x16x32_bf16 v[56:59], v[200:203], v[216:219], v[56:59]
    v_mfma_f32_16x16x32_bf16 v[60:63], v[200:203], v[220:223], v[60:63]
    v_mfma_f32_16x16x32_bf16 v[64:67], v[204:207], v[208:211], v[64:67]
    v_mfma_f32_16x16x32_bf16 v[68:71], v[204:207], v[212:215], v[68:71]
    v_mfma_f32_16x16x32_bf16 v[72:75], v[204:207], v[216:219], v[72:75]
    v_mfma_f32_16x16x32_bf16 v[76:79], v[204:207], v[220:223], v[76:79]
    s_mul_i32 s48, s53, 20480
    s_add_u32 s49, s48, 4096
    buffer_load_dwordx4 v[188:191], v226, s[36:39], s48 offen offset:0
    buffer_load_dwordx4 v[192:195], v226, s[36:39], s48 offen offset:1024
    buffer_load_dwordx4 v[196:199], v226, s[36:39], s48 offen offset:2048
    buffer_load_dwordx4 v[200:203], v226, s[36:39], s48 offen offset:3072
    buffer_load_dwordx4 v[204:207], v226, s[36:39], s49 offen
    s_lshl_b32 s48, s53, 12
    buffer_load_dwordx4 v[208:211], v224, s[28:31], s48 offen
    s_add_u32 s48, s48, 49152
    buffer_load_dwordx4 v[212:215], v224, s[28:31], s48 offen
    s_add_u32 s48, s48, 49152
    buffer_load_dwordx4 v[216:219], v224, s[28:31], s48 offen
    s_add_u32 s48, s48, 49152
    buffer_load_dwordx4 v[220:223], v224, s[28:31], s48 offen
    s_add_u32 s48, s48, 49152
    s_add_u32 s53, s53, 1
    s_cmp_ge_u32 s53, 12
    s_cselect_b32 s53, 0, s53
    s_waitcnt vmcnt(27)
    v_mfma_f32_16x16x32_bf16 v[0:3], v[80:83], v[100:103], v[0:3]
    v_mfma_f32_16x16x32_bf16 v[4:7], v[80:83], v[104:107], v[4:7]
    v_mfma_f32_16x16x32_bf16 v[8:11], v[80:83], v[108:111], v[8:11]
    v_mfma_f32_16x16x32_bf16 v[12:15], v[80:83], v[112:115], v[12:15]
    v_mfma_f32_16x16x32_bf16 v[16:19], v[84:87], v[100:103], v[16:19]
    v_mfma_f32_16x16x32_bf16 v[20:23], v[84:87], v[104:107], v[20:23]
    v_mfma_f32_16x16x32_bf16 v[24:27], v[84:87], v[108:111], v[24:27]
    v_mfma_f32_16x16x32_bf16 v[28:31], v[84:87], v[112:115], v[28:31]
    v_mfma_f32_16x16x32_bf16 v[32:35], v[88:91], v[100:103], v[32:35]
    v_mfma_f32_16x16x32_bf16 v[36:39], v[88:91], v[104:107], v[36:39]
    v_mfma_f32_16x16x32_bf16 v[40:43], v[88:91], v[108:111], v[40:43]
    v_mfma_f32_16x16x32_bf16 v[44:47], v[88:91], v[112:115], v[44:47]
    v_mfma_f32_16x16x32_bf16 v[48:51], v[92:95], v[100:103], v[48:51]
    v_mfma_f32_16x16x32_bf16 v[52:55], v[92:95], v[104:107], v[52:55]
    v_mfma_f32_16x16x32_bf16 v[56:59], v[92:95], v[108:111], v[56:59]
    v_mfma_f32_16x16x32_bf16 v[60:63], v[92:95], v[112:115], v[60:63]
    v_mfma_f32_16x16x32_bf16 v[64:67], v[96:99], v[100:103], v[64:67]
    v_mfma_f32_16x16x32_bf16 v[68:71], v[96:99], v[104:107], v[68:71]
    v_mfma_f32_16x16x32_bf16 v[72:75], v[96:99], v[108:111], v[72:75]
    v_mfma_f32_16x16x32_bf16 v[76:79], v[96:99], v[112:115], v[76:79]
    v_cmp_ne_u32 vcc, 1, v234
    s_cmp_eq_u64 vcc, 0
    s_cbranch_scc1 Lk2_wf_ok
    s_mov_b32 s49, 0
Lk2_wf:
    s_add_u32 s49, s49, 1
    s_cmp_ge_u32 s49, 0x40000
    s_cbranch_scc1 Lk2_wf_ok
    s_sleep 1
    buffer_load_dword v234, v233, s[60:63], 0 offen sc1
    s_waitcnt vmcnt(0)
    v_cmp_ne_u32 vcc, 1, v234
    s_cmp_eq_u64 vcc, 0
    s_cbranch_scc0 Lk2_wf
Lk2_wf_ok:
    s_lshr_b32 s53, s53, 1
    s_mul_i32 s48, s53, 20480
    s_add_u32 s48, s48, 245760
    s_add_u32 s49, s48, 4096
    buffer_load_dwordx4 v[80:83], v226, s[36:39], s48 offen offset:0
    buffer_load_dwordx4 v[84:87], v226, s[36:39], s48 offen offset:1024
    buffer_load_dwordx4 v[88:91], v226, s[36:39], s48 offen offset:2048
    buffer_load_dwordx4 v[92:95], v226, s[36:39], s48 offen offset:3072
    buffer_load_dwordx4 v[96:99], v226, s[36:39], s49 offen
    s_lshl_b32 s48, s53, 12
    buffer_load_dwordx4 v[100:103], v225, s[32:35], s48 offen sc1
    s_add_u32 s48, s48, 24576
    buffer_load_dwordx4 v[104:107], v225, s[32:35], s48 offen sc1
    s_add_u32 s48, s48, 24576
    buffer_load_dwordx4 v[108:111], v225, s[32:35], s48 offen sc1
    s_add_u32 s48, s48, 24576
    buffer_load_dwordx4 v[112:115], v225, s[32:35], s48 offen sc1
    s_add_u32 s48, s48, 24576
    s_add_u32 s53, s53, 1
    s_cmp_ge_u32 s53, 6
    s_cselect_b32 s53, 0, s53
    s_waitcnt vmcnt(27)
    v_mfma_f32_16x16x32_bf16 v[0:3], v[116:119], v[136:139], v[0:3]
    v_mfma_f32_16x16x32_bf16 v[4:7], v[116:119], v[140:143], v[4:7]
    v_mfma_f32_16x16x32_bf16 v[8:11], v[116:119], v[144:147], v[8:11]
    v_mfma_f32_16x16x32_bf16 v[12:15], v[116:119], v[148:151], v[12:15]
    v_mfma_f32_16x16x32_bf16 v[16:19], v[120:123], v[136:139], v[16:19]
    v_mfma_f32_16x16x32_bf16 v[20:23], v[120:123], v[140:143], v[20:23]
    v_mfma_f32_16x16x32_bf16 v[24:27], v[120:123], v[144:147], v[24:27]
    v_mfma_f32_16x16x32_bf16 v[28:31], v[120:123], v[148:151], v[28:31]
    v_mfma_f32_16x16x32_bf16 v[32:35], v[124:127], v[136:139], v[32:35]
    v_mfma_f32_16x16x32_bf16 v[36:39], v[124:127], v[140:143], v[36:39]
    v_mfma_f32_16x16x32_bf16 v[40:43], v[124:127], v[144:147], v[40:43]
    v_mfma_f32_16x16x32_bf16 v[44:47], v[124:127], v[148:151], v[44:47]
    v_mfma_f32_16x16x32_bf16 v[48:51], v[128:131], v[136:139], v[48:51]
    v_mfma_f32_16x16x32_bf16 v[52:55], v[128:131], v[140:143], v[52:55]
    v_mfma_f32_16x16x32_bf16 v[56:59], v[128:131], v[144:147], v[56:59]
    v_mfma_f32_16x16x32_bf16 v[60:63], v[128:131], v[148:151], v[60:63]
    v_mfma_f32_16x16x32_bf16 v[64:67], v[132:135], v[136:139], v[64:67]
    v_mfma_f32_16x16x32_bf16 v[68:71], v[132:135], v[140:143], v[68:71]
    v_mfma_f32_16x16x32_bf16 v[72:75], v[132:135], v[144:147], v[72:75]
    v_mfma_f32_16x16x32_bf16 v[76:79], v[132:135], v[148:151], v[76:79]
    s_mul_i32 s48, s53, 20480
    s_add_u32 s48, s48, 245760
    s_add_u32 s49, s48, 4096
    buffer_load_dwordx4 v[116:119], v226, s[36:39], s48 offen offset:0
    buffer_load_dwordx4 v[120:123], v226, s[36:39], s48 offen offset:1024
    buffer_load_dwordx4 v[124:127], v226, s[36:39], s48 offen offset:2048
    buffer_load_dwordx4 v[128:131], v226, s[36:39], s48 offen offset:3072
    buffer_load_dwordx4 v[132:135], v226, s[36:39], s49 offen
    s_lshl_b32 s48, s53, 12
    buffer_load_dwordx4 v[136:139], v225, s[32:35], s48 offen sc1
    s_add_u32 s48, s48, 24576
    buffer_load_dwordx4 v[140:143], v225, s[32:35], s48 offen sc1
    s_add_u32 s48, s48, 24576
    buffer_load_dwordx4 v[144:147], v225, s[32:35], s48 offen sc1
    s_add_u32 s48, s48, 24576
    buffer_load_dwordx4 v[148:151], v225, s[32:35], s48 offen sc1
    s_add_u32 s48, s48, 24576
    s_add_u32 s53, s53, 1
    s_cmp_ge_u32 s53, 6
    s_cselect_b32 s53, 0, s53
    s_waitcnt vmcnt(27)
    v_mfma_f32_16x16x32_bf16 v[0:3], v[152:155], v[172:175], v[0:3]
    v_mfma_f32_16x16x32_bf16 v[4:7], v[152:155], v[176:179], v[4:7]
    v_mfma_f32_16x16x32_bf16 v[8:11], v[152:155], v[180:183], v[8:11]
    v_mfma_f32_16x16x32_bf16 v[12:15], v[152:155], v[184:187], v[12:15]
    v_mfma_f32_16x16x32_bf16 v[16:19], v[156:159], v[172:175], v[16:19]
    v_mfma_f32_16x16x32_bf16 v[20:23], v[156:159], v[176:179], v[20:23]
    v_mfma_f32_16x16x32_bf16 v[24:27], v[156:159], v[180:183], v[24:27]
    v_mfma_f32_16x16x32_bf16 v[28:31], v[156:159], v[184:187], v[28:31]
    v_mfma_f32_16x16x32_bf16 v[32:35], v[160:163], v[172:175], v[32:35]
    v_mfma_f32_16x16x32_bf16 v[36:39], v[160:163], v[176:179], v[36:39]
    v_mfma_f32_16x16x32_bf16 v[40:43], v[160:163], v[180:183], v[40:43]
    v_mfma_f32_16x16x32_bf16 v[44:47], v[160:163], v[184:187], v[44:47]
    v_mfma_f32_16x16x32_bf16 v[48:51], v[164:167], v[172:175], v[48:51]
    v_mfma_f32_16x16x32_bf16 v[52:55], v[164:167], v[176:179], v[52:55]
    v_mfma_f32_16x16x32_bf16 v[56:59], v[164:167], v[180:183], v[56:59]
    v_mfma_f32_16x16x32_bf16 v[60:63], v[164:167], v[184:187], v[60:63]
    v_mfma_f32_16x16x32_bf16 v[64:67], v[168:171], v[172:175], v[64:67]
    v_mfma_f32_16x16x32_bf16 v[68:71], v[168:171], v[176:179], v[68:71]
    v_mfma_f32_16x16x32_bf16 v[72:75], v[168:171], v[180:183], v[72:75]
    v_mfma_f32_16x16x32_bf16 v[76:79], v[168:171], v[184:187], v[76:79]
    s_mul_i32 s48, s53, 20480
    s_add_u32 s48, s48, 245760
    s_add_u32 s49, s48, 4096
    buffer_load_dwordx4 v[152:155], v226, s[36:39], s48 offen offset:0
    buffer_load_dwordx4 v[156:159], v226, s[36:39], s48 offen offset:1024
    buffer_load_dwordx4 v[160:163], v226, s[36:39], s48 offen offset:2048
    buffer_load_dwordx4 v[164:167], v226, s[36:39], s48 offen offset:3072
    buffer_load_dwordx4 v[168:171], v226, s[36:39], s49 offen
    s_lshl_b32 s48, s53, 12
    buffer_load_dwordx4 v[172:175], v225, s[32:35], s48 offen sc1
    s_add_u32 s48, s48, 24576
    buffer_load_dwordx4 v[176:179], v225, s[32:35], s48 offen sc1
    s_add_u32 s48, s48, 24576
    buffer_load_dwordx4 v[180:183], v225, s[32:35], s48 offen sc1
    s_add_u32 s48, s48, 24576
    buffer_load_dwordx4 v[184:187], v225, s[32:35], s48 offen sc1
    s_add_u32 s48, s48, 24576
    s_add_u32 s53, s53, 1
    s_cmp_ge_u32 s53, 6
    s_cselect_b32 s53, 0, s53
    s_waitcnt vmcnt(27)
    v_mfma_f32_16x16x32_bf16 v[0:3], v[188:191], v[208:211], v[0:3]
    v_mfma_f32_16x16x32_bf16 v[4:7], v[188:191], v[212:215], v[4:7]
    v_mfma_f32_16x16x32_bf16 v[8:11], v[188:191], v[216:219], v[8:11]
    v_mfma_f32_16x16x32_bf16 v[12:15], v[188:191], v[220:223], v[12:15]
    v_mfma_f32_16x16x32_bf16 v[16:19], v[192:195], v[208:211], v[16:19]
    v_mfma_f32_16x16x32_bf16 v[20:23], v[192:195], v[212:215], v[20:23]
    v_mfma_f32_16x16x32_bf16 v[24:27], v[192:195], v[216:219], v[24:27]
    v_mfma_f32_16x16x32_bf16 v[28:31], v[192:195], v[220:223], v[28:31]
    v_mfma_f32_16x16x32_bf16 v[32:35], v[196:199], v[208:211], v[32:35]
    v_mfma_f32_16x16x32_bf16 v[36:39], v[196:199], v[212:215], v[36:39]
    v_mfma_f32_16x16x32_bf16 v[40:43], v[196:199], v[216:219], v[40:43]
    v_mfma_f32_16x16x32_bf16 v[44:47], v[196:199], v[220:223], v[44:47]
    v_mfma_f32_16x16x32_bf16 v[48:51], v[200:203], v[208:211], v[48:51]
    v_mfma_f32_16x16x32_bf16 v[52:55], v[200:203], v[212:215], v[52:55]
    v_mfma_f32_16x16x32_bf16 v[56:59], v[200:203], v[216:219], v[56:59]
    v_mfma_f32_16x16x32_bf16 v[60:63], v[200:203], v[220:223], v[60:63]
    v_mfma_f32_16x16x32_bf16 v[64:67], v[204:207], v[208:211], v[64:67]
    v_mfma_f32_16x16x32_bf16 v[68:71], v[204:207], v[212:215], v[68:71]
    v_mfma_f32_16x16x32_bf16 v[72:75], v[204:207], v[216:219], v[72:75]
    v_mfma_f32_16x16x32_bf16 v[76:79], v[204:207], v[220:223], v[76:79]
    s_mul_i32 s48, s53, 20480
    s_add_u32 s48, s48, 245760
    s_add_u32 s49, s48, 4096
    buffer_load_dwordx4 v[188:191], v226, s[36:39], s48 offen offset:0
    buffer_load_dwordx4 v[192:195], v226, s[36:39], s48 offen offset:1024
    buffer_load_dwordx4 v[196:199], v226, s[36:39], s48 offen offset:2048
    buffer_load_dwordx4 v[200:203], v226, s[36:39], s48 offen offset:3072
    buffer_load_dwordx4 v[204:207], v226, s[36:39], s49 offen
    s_lshl_b32 s48, s53, 12
    buffer_load_dwordx4 v[208:211], v225, s[32:35], s48 offen sc1
    s_add_u32 s48, s48, 24576
    buffer_load_dwordx4 v[212:215], v225, s[32:35], s48 offen sc1
    s_add_u32 s48, s48, 24576
    buffer_load_dwordx4 v[216:219], v225, s[32:35], s48 offen sc1
    s_add_u32 s48, s48, 24576
    buffer_load_dwordx4 v[220:223], v225, s[32:35], s48 offen sc1
    s_add_u32 s48, s48, 24576
    s_add_u32 s53, s53, 1
    s_cmp_ge_u32 s53, 6
    s_cselect_b32 s53, 0, s53
    s_waitcnt vmcnt(27)
    v_mfma_f32_16x16x32_bf16 v[0:3], v[80:83], v[100:103], v[0:3]
    v_mfma_f32_16x16x32_bf16 v[4:7], v[80:83], v[104:107], v[4:7]
    v_mfma_f32_16x16x32_bf16 v[8:11], v[80:83], v[108:111], v[8:11]
    v_mfma_f32_16x16x32_bf16 v[12:15], v[80:83], v[112:115], v[12:15]
    v_mfma_f32_16x16x32_bf16 v[16:19], v[84:87], v[100:103], v[16:19]
    v_mfma_f32_16x16x32_bf16 v[20:23], v[84:87], v[104:107], v[20:23]
    v_mfma_f32_16x16x32_bf16 v[24:27], v[84:87], v[108:111], v[24:27]
    v_mfma_f32_16x16x32_bf16 v[28:31], v[84:87], v[112:115], v[28:31]
    v_mfma_f32_16x16x32_bf16 v[32:35], v[88:91], v[100:103], v[32:35]
    v_mfma_f32_16x16x32_bf16 v[36:39], v[88:91], v[104:107], v[36:39]
    v_mfma_f32_16x16x32_bf16 v[40:43], v[88:91], v[108:111], v[40:43]
    v_mfma_f32_16x16x32_bf16 v[44:47], v[88:91], v[112:115], v[44:47]
    v_mfma_f32_16x16x32_bf16 v[48:51], v[92:95], v[100:103], v[48:51]
    v_mfma_f32_16x16x32_bf16 v[52:55], v[92:95], v[104:107], v[52:55]
    v_mfma_f32_16x16x32_bf16 v[56:59], v[92:95], v[108:111], v[56:59]
    v_mfma_f32_16x16x32_bf16 v[60:63], v[92:95], v[112:115], v[60:63]
    v_mfma_f32_16x16x32_bf16 v[64:67], v[96:99], v[100:103], v[64:67]
    v_mfma_f32_16x16x32_bf16 v[68:71], v[96:99], v[104:107], v[68:71]
    v_mfma_f32_16x16x32_bf16 v[72:75], v[96:99], v[108:111], v[72:75]
    v_mfma_f32_16x16x32_bf16 v[76:79], v[96:99], v[112:115], v[76:79]
    s_mul_i32 s48, s53, 20480
    s_add_u32 s48, s48, 245760
    s_add_u32 s49, s48, 4096
    buffer_load_dwordx4 v[80:83], v226, s[36:39], s48 offen offset:0
    buffer_load_dwordx4 v[84:87], v226, s[36:39], s48 offen offset:1024
    buffer_load_dwordx4 v[88:91], v226, s[36:39], s48 offen offset:2048
    buffer_load_dwordx4 v[92:95], v226, s[36:39], s48 offen offset:3072
    buffer_load_dwordx4 v[96:99], v226, s[36:39], s49 offen
    s_lshl_b32 s48, s53, 12
    buffer_load_dwordx4 v[100:103], v225, s[32:35], s48 offen sc1
    s_add_u32 s48, s48, 24576
    buffer_load_dwordx4 v[104:107], v225, s[32:35], s48 offen sc1
    s_add_u32 s48, s48, 24576
    buffer_load_dwordx4 v[108:111], v225, s[32:35], s48 offen sc1
    s_add_u32 s48, s48, 24576
    buffer_load_dwordx4 v[112:115], v225, s[32:35], s48 offen sc1
    s_add_u32 s48, s48, 24576
    s_add_u32 s53, s53, 1
    s_cmp_ge_u32 s53, 6
    s_cselect_b32 s53, 0, s53
    s_waitcnt vmcnt(27)
    v_mfma_f32_16x16x32_bf16 v[0:3], v[116:119], v[136:139], v[0:3]
    v_mfma_f32_16x16x32_bf16 v[4:7], v[116:119], v[140:143], v[4:7]
    v_mfma_f32_16x16x32_bf16 v[8:11], v[116:119], v[144:147], v[8:11]
    v_mfma_f32_16x16x32_bf16 v[12:15], v[116:119], v[148:151], v[12:15]
    v_mfma_f32_16x16x32_bf16 v[16:19], v[120:123], v[136:139], v[16:19]
    v_mfma_f32_16x16x32_bf16 v[20:23], v[120:123], v[140:143], v[20:23]
    v_mfma_f32_16x16x32_bf16 v[24:27], v[120:123], v[144:147], v[24:27]
    v_mfma_f32_16x16x32_bf16 v[28:31], v[120:123], v[148:151], v[28:31]
    v_mfma_f32_16x16x32_bf16 v[32:35], v[124:127], v[136:139], v[32:35]
    v_mfma_f32_16x16x32_bf16 v[36:39], v[124:127], v[140:143], v[36:39]
    v_mfma_f32_16x16x32_bf16 v[40:43], v[124:127], v[144:147], v[40:43]
    v_mfma_f32_16x16x32_bf16 v[44:47], v[124:127], v[148:151], v[44:47]
    v_mfma_f32_16x16x32_bf16 v[48:51], v[128:131], v[136:139], v[48:51]
    v_mfma_f32_16x16x32_bf16 v[52:55], v[128:131], v[140:143], v[52:55]
    v_mfma_f32_16x16x32_bf16 v[56:59], v[128:131], v[144:147], v[56:59]
    v_mfma_f32_16x16x32_bf16 v[60:63], v[128:131], v[148:151], v[60:63]
    v_mfma_f32_16x16x32_bf16 v[64:67], v[132:135], v[136:139], v[64:67]
    v_mfma_f32_16x16x32_bf16 v[68:71], v[132:135], v[140:143], v[68:71]
    v_mfma_f32_16x16x32_bf16 v[72:75], v[132:135], v[144:147], v[72:75]
    v_mfma_f32_16x16x32_bf16 v[76:79], v[132:135], v[148:151], v[76:79]
    s_mul_i32 s48, s53, 20480
    s_add_u32 s48, s48, 245760
    s_add_u32 s49, s48, 4096
    buffer_load_dwordx4 v[116:119], v226, s[36:39], s48 offen offset:0
    buffer_load_dwordx4 v[120:123], v226, s[36:39], s48 offen offset:1024
    buffer_load_dwordx4 v[124:127], v226, s[36:39], s48 offen offset:2048
    buffer_load_dwordx4 v[128:131], v226, s[36:39], s48 offen offset:3072
    buffer_load_dwordx4 v[132:135], v226, s[36:39], s49 offen
    s_lshl_b32 s48, s53, 12
    buffer_load_dwordx4 v[136:139], v225, s[32:35], s48 offen sc1
    s_add_u32 s48, s48, 24576
    buffer_load_dwordx4 v[140:143], v225, s[32:35], s48 offen sc1
    s_add_u32 s48, s48, 24576
    buffer_load_dwordx4 v[144:147], v225, s[32:35], s48 offen sc1
    s_add_u32 s48, s48, 24576
    buffer_load_dwordx4 v[148:151], v225, s[32:35], s48 offen sc1
    s_add_u32 s48, s48, 24576
    s_add_u32 s53, s53, 1
    s_cmp_ge_u32 s53, 6
    s_cselect_b32 s53, 0, s53
    s_waitcnt vmcnt(27)
    v_mfma_f32_16x16x32_bf16 v[0:3], v[152:155], v[172:175], v[0:3]
    v_mfma_f32_16x16x32_bf16 v[4:7], v[152:155], v[176:179], v[4:7]
    v_mfma_f32_16x16x32_bf16 v[8:11], v[152:155], v[180:183], v[8:11]
    v_mfma_f32_16x16x32_bf16 v[12:15], v[152:155], v[184:187], v[12:15]
    v_mfma_f32_16x16x32_bf16 v[16:19], v[156:159], v[172:175], v[16:19]
    v_mfma_f32_16x16x32_bf16 v[20:23], v[156:159], v[176:179], v[20:23]
    v_mfma_f32_16x16x32_bf16 v[24:27], v[156:159], v[180:183], v[24:27]
    v_mfma_f32_16x16x32_bf16 v[28:31], v[156:159], v[184:187], v[28:31]
    v_mfma_f32_16x16x32_bf16 v[32:35], v[160:163], v[172:175], v[32:35]
    v_mfma_f32_16x16x32_bf16 v[36:39], v[160:163], v[176:179], v[36:39]
    v_mfma_f32_16x16x32_bf16 v[40:43], v[160:163], v[180:183], v[40:43]
    v_mfma_f32_16x16x32_bf16 v[44:47], v[160:163], v[184:187], v[44:47]
    v_mfma_f32_16x16x32_bf16 v[48:51], v[164:167], v[172:175], v[48:51]
    v_mfma_f32_16x16x32_bf16 v[52:55], v[164:167], v[176:179], v[52:55]
    v_mfma_f32_16x16x32_bf16 v[56:59], v[164:167], v[180:183], v[56:59]
    v_mfma_f32_16x16x32_bf16 v[60:63], v[164:167], v[184:187], v[60:63]
    v_mfma_f32_16x16x32_bf16 v[64:67], v[168:171], v[172:175], v[64:67]
    v_mfma_f32_16x16x32_bf16 v[68:71], v[168:171], v[176:179], v[68:71]
    v_mfma_f32_16x16x32_bf16 v[72:75], v[168:171], v[180:183], v[72:75]
    v_mfma_f32_16x16x32_bf16 v[76:79], v[168:171], v[184:187], v[76:79]
    s_waitcnt vmcnt(18)
    v_mfma_f32_16x16x32_bf16 v[0:3], v[188:191], v[208:211], v[0:3]
    v_mfma_f32_16x16x32_bf16 v[4:7], v[188:191], v[212:215], v[4:7]
    v_mfma_f32_16x16x32_bf16 v[8:11], v[188:191], v[216:219], v[8:11]
    v_mfma_f32_16x16x32_bf16 v[12:15], v[188:191], v[220:223], v[12:15]
    v_mfma_f32_16x16x32_bf16 v[16:19], v[192:195], v[208:211], v[16:19]
    v_mfma_f32_16x16x32_bf16 v[20:23], v[192:195], v[212:215], v[20:23]
    v_mfma_f32_16x16x32_bf16 v[24:27], v[192:195], v[216:219], v[24:27]
    v_mfma_f32_16x16x32_bf16 v[28:31], v[192:195], v[220:223], v[28:31]
    v_mfma_f32_16x16x32_bf16 v[32:35], v[196:199], v[208:211], v[32:35]
    v_mfma_f32_16x16x32_bf16 v[36:39], v[196:199], v[212:215], v[36:39]
    v_mfma_f32_16x16x32_bf16 v[40:43], v[196:199], v[216:219], v[40:43]
    v_mfma_f32_16x16x32_bf16 v[44:47], v[196:199], v[220:223], v[44:47]
    v_mfma_f32_16x16x32_bf16 v[48:51], v[200:203], v[208:211], v[48:51]
    v_mfma_f32_16x16x32_bf16 v[52:55], v[200:203], v[212:215], v[52:55]
    v_mfma_f32_16x16x32_bf16 v[56:59], v[200:203], v[216:219], v[56:59]
    v_mfma_f32_16x16x32_bf16 v[60:63], v[200:203], v[220:223], v[60:63]
    v_mfma_f32_16x16x32_bf16 v[64:67], v[204:207], v[208:211], v[64:67]
    v_mfma_f32_16x16x32_bf16 v[68:71], v[204:207], v[212:215], v[68:71]
    v_mfma_f32_16x16x32_bf16 v[72:75], v[204:207], v[216:219], v[72:75]
    v_mfma_f32_16x16x32_bf16 v[76:79], v[204:207], v[220:223], v[76:79]
    s_waitcnt vmcnt(9)
    v_mfma_f32_16x16x32_bf16 v[0:3], v[80:83], v[100:103], v[0:3]
    v_mfma_f32_16x16x32_bf16 v[4:7], v[80:83], v[104:107], v[4:7]
    v_mfma_f32_16x16x32_bf16 v[8:11], v[80:83], v[108:111], v[8:11]
    v_mfma_f32_16x16x32_bf16 v[12:15], v[80:83], v[112:115], v[12:15]
    v_mfma_f32_16x16x32_bf16 v[16:19], v[84:87], v[100:103], v[16:19]
    v_mfma_f32_16x16x32_bf16 v[20:23], v[84:87], v[104:107], v[20:23]
    v_mfma_f32_16x16x32_bf16 v[24:27], v[84:87], v[108:111], v[24:27]
    v_mfma_f32_16x16x32_bf16 v[28:31], v[84:87], v[112:115], v[28:31]
    v_mfma_f32_16x16x32_bf16 v[32:35], v[88:91], v[100:103], v[32:35]
    v_mfma_f32_16x16x32_bf16 v[36:39], v[88:91], v[104:107], v[36:39]
    v_mfma_f32_16x16x32_bf16 v[40:43], v[88:91], v[108:111], v[40:43]
    v_mfma_f32_16x16x32_bf16 v[44:47], v[88:91], v[112:115], v[44:47]
    v_mfma_f32_16x16x32_bf16 v[48:51], v[92:95], v[100:103], v[48:51]
    v_mfma_f32_16x16x32_bf16 v[52:55], v[92:95], v[104:107], v[52:55]
    v_mfma_f32_16x16x32_bf16 v[56:59], v[92:95], v[108:111], v[56:59]
    v_mfma_f32_16x16x32_bf16 v[60:63], v[92:95], v[112:115], v[60:63]
    v_mfma_f32_16x16x32_bf16 v[64:67], v[96:99], v[100:103], v[64:67]
    v_mfma_f32_16x16x32_bf16 v[68:71], v[96:99], v[104:107], v[68:71]
    v_mfma_f32_16x16x32_bf16 v[72:75], v[96:99], v[108:111], v[72:75]
    v_mfma_f32_16x16x32_bf16 v[76:79], v[96:99], v[112:115], v[76:79]
    s_waitcnt vmcnt(0)
    v_mfma_f32_16x16x32_bf16 v[0:3], v[116:119], v[136:139], v[0:3]
    v_mfma_f32_16x16x32_bf16 v[4:7], v[116:119], v[140:143], v[4:7]
    v_mfma_f32_16x16x32_bf16 v[8:11], v[116:119], v[144:147], v[8:11]
    v_mfma_f32_16x16x32_bf16 v[12:15], v[116:119], v[148:151], v[12:15]
    v_mfma_f32_16x16x32_bf16 v[16:19], v[120:123], v[136:139], v[16:19]
    v_mfma_f32_16x16x32_bf16 v[20:23], v[120:123], v[140:143], v[20:23]
    v_mfma_f32_16x16x32_bf16 v[24:27], v[120:123], v[144:147], v[24:27]
    v_mfma_f32_16x16x32_bf16 v[28:31], v[120:123], v[148:151], v[28:31]
    v_mfma_f32_16x16x32_bf16 v[32:35], v[124:127], v[136:139], v[32:35]
    v_mfma_f32_16x16x32_bf16 v[36:39], v[124:127], v[140:143], v[36:39]
    v_mfma_f32_16x16x32_bf16 v[40:43], v[124:127], v[144:147], v[40:43]
    v_mfma_f32_16x16x32_bf16 v[44:47], v[124:127], v[148:151], v[44:47]
    v_mfma_f32_16x16x32_bf16 v[48:51], v[128:131], v[136:139], v[48:51]
    v_mfma_f32_16x16x32_bf16 v[52:55], v[128:131], v[140:143], v[52:55]
    v_mfma_f32_16x16x32_bf16 v[56:59], v[128:131], v[144:147], v[56:59]
    v_mfma_f32_16x16x32_bf16 v[60:63], v[128:131], v[148:151], v[60:63]
    v_mfma_f32_16x16x32_bf16 v[64:67], v[132:135], v[136:139], v[64:67]
    v_mfma_f32_16x16x32_bf16 v[68:71], v[132:135], v[140:143], v[68:71]
    v_mfma_f32_16x16x32_bf16 v[72:75], v[132:135], v[144:147], v[72:75]
    v_mfma_f32_16x16x32_bf16 v[76:79], v[132:135], v[148:151], v[76:79]
    s_barrier
    v_and_b32 v230, 15, v227
    v_lshrrev_b32 v232, 4, v227
    v_mul_u32_u24 v234, 320, v230
    v_lshl_add_u32 v234, v232, 4, v234
    v_mul_u32_u24 v235, 20480, v228
    v_add_u32 v234, v234, v235
    ds_write_b128 v234, v[0:3] offset:0
    ds_write_b128 v234, v[4:7] offset:5120
    ds_write_b128 v234, v[8:11] offset:10240
    ds_write_b128 v234, v[12:15] offset:15360
    ds_write_b128 v234, v[16:19] offset:64
    ds_write_b128 v234, v[20:23] offset:5184
    ds_write_b128 v234, v[24:27] offset:10304
    ds_write_b128 v234, v[28:31] offset:15424
    ds_write_b128 v234, v[32:35] offset:128
    ds_write_b128 v234, v[36:39] offset:5248
    ds_write_b128 v234, v[40:43] offset:10368
    ds_write_b128 v234, v[44:47] offset:15488
    ds_write_b128 v234, v[48:51] offset:192
    ds_write_b128 v234, v[52:55] offset:5312
    ds_write_b128 v234, v[56:59] offset:10432
    ds_write_b128 v234, v[60:63] offset:15552
    ds_write_b128 v234, v[64:67] offset:256
    ds_write_b128 v234, v[68:71] offset:5376
    ds_write_b128 v234, v[72:75] offset:10496
    ds_write_b128 v234, v[76:79] offset:15616
    s_mov_b32 s28, s4
    s_and_b32 s29, s5, 0xffff
    s_mov_b32 s30, 0x280000
    s_mov_b32 s31, 0x00020000
    s_mov_b32 s32, s20
    s_and_b32 s33, s21, 0xffff
    s_mov_b32 s34, 0x280000
    s_mov_b32 s35, 0x00020000
    s_mov_b32 s49, 0x1999999a
    s_lshl_b32 s48, s51, 6
    s_mul_i32 s50, s52, 160
    v_add_u32 v230, 0, v229
    v_mul_hi_u32 v231, v230, s49
    v_mul_u32_u24 v232, 10, v231
    v_sub_u32 v232, v230, v232
    v_mul_u32_u24 v233, 320, v231
    v_lshl_add_u32 v100, v232, 5, v233
    v_add_u32 v231, s48, v231
    v_mul_u32_u24 v231, 1280, v231
    v_lshl_add_u32 v231, v232, 4, v231
    v_add_u32 v104, s50, v231
    buffer_load_dwordx4 v[108:111], v104, s[28:31], 0 offen
    v_add_u32 v230, 256, v229
    v_mul_hi_u32 v231, v230, s49
    v_mul_u32_u24 v232, 10, v231
    v_sub_u32 v232, v230, v232
    v_mul_u32_u24 v233, 320, v231
    v_lshl_add_u32 v101, v232, 5, v233
    v_add_u32 v231, s48, v231
    v_mul_u32_u24 v231, 1280, v231
    v_lshl_add_u32 v231, v232, 4, v231
    v_add_u32 v105, s50, v231
    buffer_load_dwordx4 v[112:115], v105, s[28:31], 0 offen
    v_add_u32 v230, 512, v229
    v_mul_hi_u32 v231, v230, s49
    v_mul_u32_u24 v232, 10, v231
    v_sub_u32 v232, v230, v232
    v_mul_u32_u24 v233, 320, v231
    v_lshl_add_u32 v102, v232, 5, v233
    v_add_u32 v231, s48, v231
    v_mul_u32_u24 v231, 1280, v231
    v_lshl_add_u32 v231, v232, 4, v231
    v_add_u32 v106, s50, v231
    v_cmp_gt_u32 vcc, 640, v230
    s_nop 1
    v_cndmask_b32 v102, 0, v102, vcc
    v_mov_b32 v234, 0x7fffff00
    v_cndmask_b32 v106, v234, v106, vcc
    buffer_load_dwordx4 v[116:119], v106, s[28:31], 0 offen
    s_waitcnt lgkmcnt(0)
    s_barrier
    ds_read_b128 v[128:131], v100 offset:0
    ds_read_b128 v[132:135], v100 offset:16
    ds_read_b128 v[136:139], v100 offset:20480
    ds_read_b128 v[140:143], v100 offset:20496
    ds_read_b128 v[144:147], v100 offset:40960
    ds_read_b128 v[148:151], v100 offset:40976
    ds_read_b128 v[152:155], v100 offset:61440
    ds_read_b128 v[156:159], v100 offset:61456
    ds_read_b128 v[160:163], v101 offset:0
    ds_read_b128 v[164:167], v101 offset:16
    ds_read_b128 v[168:171], v101 offset:20480
    ds_read_b128 v[172:175], v101 offset:20496
    ds_read_b128 v[176:179], v101 offset:40960
    ds_read_b128 v[180:183], v101 offset:40976
    ds_read_b128 v[184:187], v101 offset:61440
    ds_read_b128 v[188:191], v101 offset:61456
    ds_read_b128 v[192:195], v102 offset:0
    ds_read_b128 v[196:199], v102 offset:16
    ds_read_b128 v[200:203], v102 offset:20480
    ds_read_b128 v[204:207], v102 offset:20496
    ds_read_b128 v[208:211], v102 offset:40960
    ds_read_b128 v[212:215], v102 offset:40976
    ds_read_b128 v[216:219], v102 offset:61440
    ds_read_b128 v[220:223], v102 offset:61456
    s_waitcnt lgkmcnt(15)
    v_pk_add_f32 v[128:129], v[128:129], v[136:137]
    s_waitcnt lgkmcnt(15)
    v_pk_add_f32 v[144:145], v[144:145], v[152:153]
    v_pk_add_f32 v[130:131], v[130:131], v[138:139]
    v_pk_add_f32 v[146:147], v[146:147], v[154:155]
    v_pk_add_f32 v[132:133], v[132:133], v[140:141]
    s_waitcnt lgkmcnt(15)
    v_pk_add_f32 v[148:149], v[148:149], v[156:157]
    v_pk_add_f32 v[134:135], v[134:135], v[142:143]
    v_pk_add_f32 v[150:151], v[150:151], v[158:159]
    v_pk_add_f32 v[128:129], v[128:129], v[144:145]
    v_pk_add_f32 v[130:131], v[130:131], v[146:147]
    v_pk_add_f32 v[132:133], v[132:133], v[148:149]
    v_pk_add_f32 v[134:135], v[134:135], v[150:151]
    s_waitcnt vmcnt(2)
    v_lshlrev_b32 v136, 16, v108
    v_and_b32 v137, 0xffff0000, v108
    v_lshlrev_b32 v138, 16, v109
    v_and_b32 v139, 0xffff0000, v109
    v_lshlrev_b32 v140, 16, v110
    v_and_b32 v141, 0xffff0000, v110
    v_lshlrev_b32 v142, 16, v111
    v_and_b32 v143, 0xffff0000, v111
    v_pk_add_f32 v[128:129], v[128:129], v[136:137]
    v_pk_add_f32 v[130:131], v[130:131], v[138:139]
    v_pk_add_f32 v[132:133], v[132:133], v[140:141]
    v_pk_add_f32 v[134:135], v[134:135], v[142:143]
    v_cvt_pk_bf16_f32 v144, v128, v129
    v_cvt_pk_bf16_f32 v145, v130, v131
    v_cvt_pk_bf16_f32 v146, v132, v133
    v_cvt_pk_bf16_f32 v147, v134, v135
    buffer_store_dwordx4 v[144:147], v104, s[32:35], 0 offen
    s_waitcnt lgkmcnt(13)
    v_pk_add_f32 v[160:161], v[160:161], v[168:169]
    s_waitcnt lgkmcnt(9)
    v_pk_add_f32 v[176:177], v[176:177], v[184:185]
    v_pk_add_f32 v[162:163], v[162:163], v[170:171]
    v_pk_add_f32 v[178:179], v[178:179], v[186:187]
    v_pk_add_f32 v[164:165], v[164:165], v[172:173]
    s_waitcnt lgkmcnt(8)
    v_pk_add_f32 v[180:181], v[180:181], v[188:189]
    v_pk_add_f32 v[166:167], v[166:167], v[174:175]
    v_pk_add_f32 v[182:183], v[182:183], v[190:191]
    v_pk_add_f32 v[160:161], v[160:161], v[176:177]
    v_pk_add_f32 v[162:163], v[162:163], v[178:179]
    v_pk_add_f32 v[164:165], v[164:165], v[180:181]
    v_pk_add_f32 v[166:167], v[166:167], v[182:183]
    s_waitcnt vmcnt(2)
    v_lshlrev_b32 v168, 16, v112
    v_and_b32 v169, 0xffff0000, v112
    v_lshlrev_b32 v170, 16, v113
    v_and_b32 v171, 0xffff0000, v113
    v_lshlrev_b32 v172, 16, v114
    v_and_b32 v173, 0xffff0000, v114
    v_lshlrev_b32 v174, 16, v115
    v_and_b32 v175, 0xffff0000, v115
    v_pk_add_f32 v[160:161], v[160:161], v[168:169]
    v_pk_add_f32 v[162:163], v[162:163], v[170:171]
    v_pk_add_f32 v[164:165], v[164:165], v[172:173]
    v_pk_add_f32 v[166:167], v[166:167], v[174:175]
    v_cvt_pk_bf16_f32 v176, v160, v161
    v_cvt_pk_bf16_f32 v177, v162, v163
    v_cvt_pk_bf16_f32 v178, v164, v165
    v_cvt_pk_bf16_f32 v179, v166, v167
    buffer_store_dwordx4 v[176:179], v105, s[32:35], 0 offen
    s_waitcnt lgkmcnt(5)
    v_pk_add_f32 v[192:193], v[192:193], v[200:201]
    s_waitcnt lgkmcnt(1)
    v_pk_add_f32 v[208:209], v[208:209], v[216:217]
    v_pk_add_f32 v[194:195], v[194:195], v[202:203]
    v_pk_add_f32 v[210:211], v[210:211], v[218:219]
    v_pk_add_f32 v[196:197], v[196:197], v[204:205]
    s_waitcnt lgkmcnt(0)
    v_pk_add_f32 v[212:213], v[212:213], v[220:221]
    v_pk_add_f32 v[198:199], v[198:199], v[206:207]
    v_pk_add_f32 v[214:215], v[214:215], v[222:223]
    v_pk_add_f32 v[192:193], v[192:193], v[208:209]
    v_pk_add_f32 v[194:195], v[194:195], v[210:211]
    v_pk_add_f32 v[196:197], v[196:197], v[212:213]
    v_pk_add_f32 v[198:199], v[198:199], v[214:215]
    s_waitcnt vmcnt(2)
    v_lshlrev_b32 v200, 16, v116
    v_and_b32 v201, 0xffff0000, v116
    v_lshlrev_b32 v202, 16, v117
    v_and_b32 v203, 0xffff0000, v117
    v_lshlrev_b32 v204, 16, v118
    v_and_b32 v205, 0xffff0000, v118
    v_lshlrev_b32 v206, 16, v119
    v_and_b32 v207, 0xffff0000, v119
    v_pk_add_f32 v[192:193], v[192:193], v[200:201]
    v_pk_add_f32 v[194:195], v[194:195], v[202:203]
    v_pk_add_f32 v[196:197], v[196:197], v[204:205]
    v_pk_add_f32 v[198:199], v[198:199], v[206:207]
    v_cvt_pk_bf16_f32 v208, v192, v193
    v_cvt_pk_bf16_f32 v209, v194, v195
    v_cvt_pk_bf16_f32 v210, v196, v197
    v_cvt_pk_bf16_f32 v211, v198, v199
    buffer_store_dwordx4 v[208:211], v106, s[32:35], 0 offen
    s_waitcnt vmcnt(0)
Lk2_exit:
    s_endpgm

.section .rodata,"a"
.p2align 6
.amdhsa_kernel k1_kernel
  .amdhsa_next_free_vgpr 256
  .amdhsa_next_free_sgpr 96
  .amdhsa_accum_offset 256
  .amdhsa_group_segment_fixed_size 0
  .amdhsa_kernarg_size 88
  .amdhsa_user_sgpr_count 2
  .amdhsa_user_sgpr_kernarg_segment_ptr 1
  .amdhsa_system_sgpr_workgroup_id_x 1
  .amdhsa_float_denorm_mode_32 3
.end_amdhsa_kernel

.p2align 6
.amdhsa_kernel k2_kernel
  .amdhsa_next_free_vgpr 256
  .amdhsa_next_free_sgpr 96
  .amdhsa_accum_offset 256
  .amdhsa_group_segment_fixed_size 0
  .amdhsa_kernarg_size 88
  .amdhsa_user_sgpr_count 2
  .amdhsa_user_sgpr_kernarg_segment_ptr 1
  .amdhsa_system_sgpr_workgroup_id_x 1
  .amdhsa_float_denorm_mode_32 3
.end_amdhsa_kernel
```
